```python
import torch

def _softmax(x, axis=-1):
    return torch.softmax(x, dim=axis)
def _gelu(x):
    return torch.nn.functional.gelu(x, approximate="tanh")
def _silu(x):
    return torch.nn.functional.silu(x)
def _sigmoid(x):
    return torch.sigmoid(x)
def _layernorm(x, axis=-1, eps=1e-5):
    m = x.mean(dim=axis, keepdim=True)
    v = x.var(dim=axis, keepdim=True, unbiased=False)
    return (x - m) / torch.sqrt(v + eps)
def _scatter_add(tgt, idx, src, axis=0):
    return tgt.clone().index_add_(axis, idx, src)
def _segment_sum(src, seg, n):
    out = torch.zeros((n,) + src.shape[1:], dtype=src.dtype)
    return out.index_add_(0, seg, src)
def _pad(x, pw):
    flat = tuple(v for pair in reversed(pw) for v in pair)
    return torch.nn.functional.pad(x, flat)

kernel_name = 'concat_heads__gqa_block_cached__gqa_block_cached__near_ridge'

def setup_inputs():

    _w = (lambda a: (lambda t: t.to(torch.bfloat16) if t.is_floating_point() else t)(torch.as_tensor(a)))
    def _A_setup():
        B, Sq, D = 16, 96, 576
        Hq, Hkv, Sk, Dh = 32, 16, 1024, 128
        assert Hq % Hkv == 0, (Hq, Hkv)
        return {
            "x": _w((lambda *s: torch.randn(*s, dtype=torch.bfloat16) * 0.8)(B, Sq, D)),
            "k_cache": _w((lambda *s: torch.randn(*s, dtype=torch.bfloat16) * 0.8)(B, Hkv, Sk, Dh)),
            "v_cache": _w((lambda *s: torch.randn(*s, dtype=torch.bfloat16) * 0.05)(B, Hkv, Sk, Dh)),
            "wq": _w((lambda *s: torch.randn(*s, dtype=torch.bfloat16) * 0.8)(D, Hq * Dh) * (D ** -0.5)),
            "wo": _w((lambda *s: torch.randn(*s, dtype=torch.bfloat16) * 0.05)(Hq * Dh, D) * ((Hq * Dh) ** -0.5)),
        }
    _A_in = _A_setup()

    def _B_setup():
        B, Sq, D = 16, 96, 576
        Hq, Hkv, Sk, Dh = 32, 16, 1024, 128
        assert Hq % Hkv == 0, (Hq, Hkv)
        return {
            "x": _w((lambda *s: torch.randn(*s, dtype=torch.bfloat16) * 0.8)(B, Sq, D)),
            "k_cache": _w((lambda *s: torch.randn(*s, dtype=torch.bfloat16) * 0.8)(B, Hkv, Sk, Dh)),
            "v_cache": _w((lambda *s: torch.randn(*s, dtype=torch.bfloat16) * 0.05)(B, Hkv, Sk, Dh)),
            "wq": _w((lambda *s: torch.randn(*s, dtype=torch.bfloat16) * 0.8)(D, Hq * Dh) * (D ** -0.5)),
            "wo": _w((lambda *s: torch.randn(*s, dtype=torch.bfloat16) * 0.05)(Hq * Dh, D) * ((Hq * Dh) ** -0.5)),
        }
    _B_in = _B_setup()

    return {
        "A_x": _A_in["x"],
        "A_k_cache": _A_in["k_cache"],
        "A_v_cache": _A_in["v_cache"],
        "A_wq": _A_in["wq"],
        "A_wo": _A_in["wo"],
        "B_x": _B_in["x"],
        "B_k_cache": _B_in["k_cache"],
        "B_v_cache": _B_in["v_cache"],
        "B_wq": _B_in["wq"],
        "B_wo": _B_in["wo"],
    }

def reference(A_x, A_k_cache, A_v_cache, A_wq, A_wo, B_x, B_k_cache, B_v_cache, B_wq, B_wo):
    def _A_ref(x, k_cache, v_cache, wq, wo):
        B, Sq, D = x.shape
        Hq, Dh = 32, 128
        Hkv = k_cache.shape[1]
        rep = Hq // Hkv
        q = (lambda x, *d: x.permute(*d))((x @ wq).reshape(B, Sq, Hq, Dh), 0, 2, 1, 3)
        k = (lambda x, n, axis: torch.repeat_interleave(x, n, dim=axis))(k_cache, rep, axis=1)
        v = (lambda x, n, axis: torch.repeat_interleave(x, n, dim=axis))(v_cache, rep, axis=1)
        scores = torch.einsum("bhqd,bhkd->bhqk", q, k) * (Dh ** -0.5)
        p = _softmax(scores, axis=-1)
        o = torch.einsum("bhqk,bhkd->bhqd", p, v)
        return (lambda x, *d: x.permute(*d))(o, 0, 2, 1, 3).reshape(B, Sq, Hq * Dh) @ wo

    def _B_ref(x, k_cache, v_cache, wq, wo):
        B, Sq, D = x.shape
        Hq, Dh = 32, 128
        Hkv = k_cache.shape[1]
        rep = Hq // Hkv
        q = (lambda x, *d: x.permute(*d))((x @ wq).reshape(B, Sq, Hq, Dh), 0, 2, 1, 3)
        k = (lambda x, n, axis: torch.repeat_interleave(x, n, dim=axis))(k_cache, rep, axis=1)
        v = (lambda x, n, axis: torch.repeat_interleave(x, n, dim=axis))(v_cache, rep, axis=1)
        scores = torch.einsum("bhqd,bhkd->bhqk", q, k) * (Dh ** -0.5)
        p = _softmax(scores, axis=-1)
        o = torch.einsum("bhqk,bhkd->bhqd", p, v)
        return (lambda x, *d: x.permute(*d))(o, 0, 2, 1, 3).reshape(B, Sq, Hq * Dh) @ wo

    a = _A_ref(A_x, A_k_cache, A_v_cache, A_wq, A_wo)
    b = _B_ref(B_x, B_k_cache, B_v_cache, B_wq, B_wo)
    return torch.concatenate([a, b], axis=-1)
```

```asm
; @launch grid=(256,1,1) block=(256,1,1) lds=163840
.amdgcn_target "amdgcn-amd-amdhsa--gfx950"
.text
.globl concat_heads__gqa_block_cached__gqa_block_cached__near_ridge_kernel
.p2align 8
.type concat_heads__gqa_block_cached__gqa_block_cached__near_ridge_kernel,@function
concat_heads__gqa_block_cached__gqa_block_cached__near_ridge_kernel:
s_cmp_ge_u32 s2, 256
s_cbranch_scc1 L_end
s_mov_b32 s77, 0
s_getpc_b64 s[20:21]
L_pc:
s_lshr_b32 s3, s2, 3
s_mul_i32 s3, s3, 16
v_lshrrev_b32 v1, 6, v0
v_and_b32 v2, 63, v0
v_mad_u32_u24 v1, v1, 4, v2
v_add_u32 v1, s3, v1
v_lshlrev_b32 v1, 7, v1
v_min_u32 v1, L_codeend-L_pc-4, v1
v_mov_b32 v3, s21
v_add_co_u32 v2, vcc, s20, v1
s_nop 1
v_addc_co_u32 v3, vcc, 0, v3, vcc
s_mov_b64 exec, 15
global_load_dword a254, v[2:3], off
s_mov_b64 exec, -1
v_lshrrev_b32 v1, 6, v0
v_and_b32 v252, 63, v0
v_readfirstlane_b32 s28, v1
v_lshrrev_b32 v253, 4, v252
v_and_b32 v254, 15, v252
L_restart:
s_load_dwordx16 s[48:63], s[0:1], 0
s_load_dwordx4 s[64:67], s[0:1], 64
s_load_dwordx2 s[68:69], s[0:1], 96
s_load_dwordx2 s[96:97], s[0:1], 88
s_bfe_u32 s72, s2, 0x10002
s_and_b32 s71, s2, 3
s_lshl_b32 s71, s71, 1
s_bfe_u32 s34, s2, 0x10003
s_add_u32 s71, s71, s34
s_lshr_b32 s70, s2, 4
s_lshl_b32 s43, s28, 13
s_mul_i32 s44, s28, 3072
s_add_u32 s44, s44, 131072
s_mul_i32 s29, s70, 110592
s_lshl_b32 s30, s71, 10
s_lshl_b32 s34, s28, 8
s_add_u32 s30, s30, s34
s_and_b32 s3, s71, 1
s_mul_i32 s3, s3, 5
s_add_u32 s3, s3, s70
s_cmp_ge_u32 s3, 9
s_cselect_b32 s34, 9, 0
s_sub_u32 s3, s3, s34
s_cmp_ge_u32 s3, 9
s_cselect_b32 s34, 9, 0
s_sub_u32 s3, s3, s34
s_mul_i32 s3, s3, 128
s_lshr_b32 s3, s3, 8
s_mul_i32 s3, s3, 2
s_mov_b32 s75, s30
s_add_u32 s74, s30, 4718592
s_mov_b32 s73, s29
s_add_u32 s47, s29, 1152
s_lshl_b32 s34, s3, 19
s_add_u32 s30, s30, s34
s_lshl_b32 s34, s3, 7
s_add_u32 s29, s29, s34
v_lshrrev_b32 v4, 3, v252
v_and_b32 v5, 7, v252
s_mul_i32 s35, s28, 27648
v_mul_u32_u24 v4, 1152, v4
s_add_u32 s34, s28, 0
s_and_b32 s34, s34, 1
s_lshl_b32 s34, s34, 2
v_add_u32 v6, s34, v253
v_xor_b32 v6, v6, v5
v_lshlrev_b32 v6, 4, v6
v_add3_u32 v6, v6, v4, s35
v_add_u32 v214, 0, v6
s_add_u32 s34, s28, 1
s_and_b32 s34, s34, 1
s_lshl_b32 s34, s34, 2
v_add_u32 v6, s34, v253
v_xor_b32 v6, v6, v5
v_lshlrev_b32 v6, 4, v6
v_add3_u32 v6, v6, v4, s35
v_add_u32 v215, 8192, v6
s_add_u32 s34, s28, 2
s_and_b32 s34, s34, 1
s_lshl_b32 s34, s34, 2
v_add_u32 v6, s34, v253
v_xor_b32 v6, v6, v5
v_lshlrev_b32 v6, 4, v6
v_add3_u32 v6, v6, v4, s35
v_add_u32 v216, 16384, v6
v_lshlrev_b32 v4, 13, v253
v_or_b32 v6, 0, v253
v_lshlrev_b32 v6, 1, v6
v_xor_b32 v6, v6, v254
v_lshl_add_u32 v6, v6, 4, v4
v_add_u32 v210, 0, v6
v_or_b32 v6, 0, v253
v_lshlrev_b32 v6, 1, v6
v_xor_b32 v6, v6, v254
v_lshl_add_u32 v6, v6, 4, v4
v_add_u32 v211, 31744, v6
v_or_b32 v6, 4, v253
v_lshlrev_b32 v6, 1, v6
v_xor_b32 v6, v6, v254
v_lshl_add_u32 v6, v6, 4, v4
v_add_u32 v212, 63488, v6
v_or_b32 v6, 4, v253
v_lshlrev_b32 v6, 1, v6
v_xor_b32 v6, v6, v254
v_lshl_add_u32 v6, v6, 4, v4
v_add_u32 v213, 95232, v6
s_and_b32 s34, s28, 1
s_lshl_b32 s32, s70, 3
s_add_u32 s32, s32, s71
s_lshl_b32 s32, s32, 1
s_lshr_b32 s35, s28, 1
s_add_u32 s32, s32, s35
s_lshl_b32 s32, s32, 18
s_add_u32 s33, s32, 262144
s_lshl_b32 s45, s34, 12
s_lshl_b32 s46, s35, 14
s_add_u32 s46, s46, s45
s_add_u32 s46, s46, 106496
s_add_u32 s45, s45, s32
s_lshl_b32 s34, s34, 13
s_add_u32 s32, s32, s34
s_waitcnt lgkmcnt(0)
s_cmp_eq_u32 s72, 0
s_cselect_b32 s4, s48, s58
s_cselect_b32 s5, s49, s59
s_cselect_b32 s8, s54, s64
s_cselect_b32 s9, s55, s65
s_cselect_b32 s16, s50, s60
s_cselect_b32 s17, s51, s61
s_cselect_b32 s12, s52, s62
s_cselect_b32 s13, s53, s63
s_cselect_b32 s20, s56, s66
s_cselect_b32 s21, s57, s67
s_mov_b32 s6, 1769472
s_mov_b32 s7, 0x20000
s_mov_b32 s10, 4718592
s_mov_b32 s11, 0x20000
s_mov_b32 s18, 0x4000000
s_mov_b32 s19, 0x20000
s_mov_b32 s14, 0x4000000
s_mov_b32 s15, 0x20000
s_bitcmp1_b32 s28, 0
s_cselect_b32 s12, s16, s12
s_cselect_b32 s13, s17, s13
s_cselect_b64 s[100:101], -1, 0
s_add_u32 m0, s44, 0
s_nop 0
buffer_load_dwordx4 v214, s[4:7], s29 offen offset:0  lds
buffer_load_dwordx4 v215, s[4:7], s29 offen offset:1024  lds
buffer_load_dwordx4 v216, s[4:7], s29 offen offset:2048  lds
s_add_u32 s29, s29, 128
s_cmp_eq_u32 s29, s47
s_cselect_b32 s29, s73, s29
s_add_u32 m0, s43, 0
s_add_u32 s31, s30, 131072
buffer_load_dwordx4 v210, s[8:11], s30 offen offset:0  lds
buffer_load_dwordx4 v211, s[8:11], s30 offen offset:1024  lds
buffer_load_dwordx4 v212, s[8:11], s30 offen offset:2048  lds
buffer_load_dwordx4 v213, s[8:11], s30 offen offset:3072  lds
s_add_u32 m0, s43, 4096
s_nop 0
buffer_load_dwordx4 v210, s[8:11], s31 offen offset:0  lds
buffer_load_dwordx4 v211, s[8:11], s31 offen offset:1024  lds
buffer_load_dwordx4 v212, s[8:11], s31 offen offset:2048  lds
buffer_load_dwordx4 v213, s[8:11], s31 offen offset:3072  lds
s_add_u32 s30, s30, 262144
s_mov_b32 s22, 4718592
s_mov_b32 s23, 0x20000
s_mov_b32 s24, s68
s_mov_b32 s25, s69
s_mov_b32 s26, 0x4000000
s_mov_b32 s27, 0x20000
s_mov_b32 s36, 0x3e0293ee
s_mov_b32 s38, 0x3e0293ee
s_mov_b32 s39, 0x3e0293ee
s_mov_b32 s95, 0x53800000
s_mov_b32 s98, 256
s_mov_b32 s99, 0x20000
s_lshl_b32 s76, s71, 3
s_add_u32 s76, s76, s28
s_mul_i32 s76, s76, 73728
s_lshl_b32 s42, s72, 4
s_add_u32 s42, s42, s70
s_lshl_b32 s42, s42, 3
s_add_u32 s42, s42, s71
s_mul_i32 s42, s42, 110592
s_mul_i32 s34, s28, 3072
s_add_u32 s42, s42, s34
v_lshrrev_b32 v4, 2, v254
v_and_b32 v5, 3, v252
v_and_b32 v6, 1, v253
v_lshl_or_b32 v6, v6, 2, v4
v_lshl_add_u32 v7, v253, 3, v4
v_lshlrev_b32 v7, 8, v7
v_lshl_add_u32 v7, v5, 3, v7
v_add_u32 v7, s43, v7
v_xor_b32 v3, 0, v6
v_lshl_add_u32 v192, v3, 5, v7
v_add_u32 v200, 65536, v192
v_xor_b32 v3, 1, v6
v_lshl_add_u32 v193, v3, 5, v7
v_add_u32 v201, 65536, v193
v_xor_b32 v3, 2, v6
v_lshl_add_u32 v194, v3, 5, v7
v_add_u32 v202, 65536, v194
v_xor_b32 v3, 3, v6
v_lshl_add_u32 v195, v3, 5, v7
v_add_u32 v203, 65536, v195
v_xor_b32 v3, 4, v6
v_lshl_add_u32 v196, v3, 5, v7
v_add_u32 v204, 65536, v196
v_xor_b32 v3, 5, v6
v_lshl_add_u32 v197, v3, 5, v7
v_add_u32 v205, 65536, v197
v_xor_b32 v3, 6, v6
v_lshl_add_u32 v198, v3, 5, v7
v_add_u32 v206, 65536, v198
v_xor_b32 v3, 7, v6
v_lshl_add_u32 v199, v3, 5, v7
v_add_u32 v207, 65536, v199
v_lshrrev_b32 v6, 1, v254
v_lshlrev_b32 v7, 7, v254
v_add_u32 v7, 131072, v7
v_add_u32 v3, 0, v253
v_xor_b32 v3, v3, v6
v_lshl_add_u32 v208, v3, 4, v7
v_add_u32 v3, 4, v253
v_xor_b32 v3, v3, v6
v_lshl_add_u32 v209, v3, 4, v7
v_lshlrev_b32 v7, 8, v253
v_add_u32 v3, 0, v253
v_xor_b32 v3, v3, v254
v_lshl_add_u32 v217, v3, 4, v7
v_add_u32 v3, 0, v253
v_lshlrev_b32 v3, 1, v3
v_xor_b32 v3, v3, v254
v_lshl_add_u32 v2, v3, 4, v7
v_cndmask_b32 v248, v2, v217, s[100:101]
v_add_u32 v3, 4, v253
v_xor_b32 v3, v3, v254
v_lshl_add_u32 v218, v3, 4, v7
v_add_u32 v3, 4, v253
v_lshlrev_b32 v3, 1, v3
v_xor_b32 v3, v3, v254
v_lshl_add_u32 v2, v3, 4, v7
v_cndmask_b32 v249, v2, v218, s[100:101]
v_add_u32 v3, 8, v253
v_xor_b32 v3, v3, v254
v_lshl_add_u32 v219, v3, 4, v7
v_add_u32 v3, 0, v253
v_lshlrev_b32 v3, 1, v3
v_xor_b32 v3, v3, v254
v_lshl_add_u32 v2, v3, 4, v7
v_cndmask_b32 v250, v2, v219, s[100:101]
v_add_u32 v3, 12, v253
v_xor_b32 v3, v3, v254
v_lshl_add_u32 v220, v3, 4, v7
v_add_u32 v3, 4, v253
v_lshlrev_b32 v3, 1, v3
v_xor_b32 v3, v3, v254
v_lshl_add_u32 v2, v3, 4, v7
v_cndmask_b32 v251, v2, v220, s[100:101]
s_lshr_b32 s35, s28, 1
s_lshl_b32 s35, s35, 14
v_lshlrev_b32 v7, 8, v254
v_add_u32 v7, s35, v7
v_add_u32 v7, 8192, v7
v_and_b32 v6, 1, v253
v_lshrrev_b32 v3, 1, v253
v_lshl_or_b32 v6, v6, 1, v3
v_add_u32 v3, 0, v6
v_xor_b32 v3, v3, v254
v_lshl_add_u32 v224, v3, 4, v7
v_add_u32 v228, 65536, v224
v_add_u32 v3, 4, v6
v_xor_b32 v3, v3, v254
v_lshl_add_u32 v225, v3, 4, v7
v_add_u32 v229, 65536, v225
v_add_u32 v3, 8, v6
v_xor_b32 v3, v3, v254
v_lshl_add_u32 v226, v3, 4, v7
v_add_u32 v230, 65536, v226
v_add_u32 v3, 12, v6
v_xor_b32 v3, v3, v254
v_lshl_add_u32 v227, v3, 4, v7
v_add_u32 v231, 65536, v227
v_lshl_add_u32 v6, v253, 2, v4
v_lshlrev_b32 v7, 8, v6
v_and_b32 v6, 7, v6
v_lshl_add_u32 v7, v5, 3, v7
v_add_u32 v7, s35, v7
v_xor_b32 v3, 0, v6
v_lshl_add_u32 v232, v3, 5, v7
v_add_u32 v240, 65536, v232
v_xor_b32 v3, 1, v6
v_lshl_add_u32 v233, v3, 5, v7
v_add_u32 v241, 65536, v233
v_xor_b32 v3, 2, v6
v_lshl_add_u32 v234, v3, 5, v7
v_add_u32 v242, 65536, v234
v_xor_b32 v3, 3, v6
v_lshl_add_u32 v235, v3, 5, v7
v_add_u32 v243, 65536, v235
v_xor_b32 v3, 4, v6
v_lshl_add_u32 v236, v3, 5, v7
v_add_u32 v244, 65536, v236
v_xor_b32 v3, 5, v6
v_lshl_add_u32 v237, v3, 5, v7
v_add_u32 v245, 65536, v237
v_xor_b32 v3, 6, v6
v_lshl_add_u32 v238, v3, 5, v7
v_add_u32 v246, 65536, v238
v_xor_b32 v3, 7, v6
v_lshl_add_u32 v239, v3, 5, v7
v_add_u32 v247, 65536, v239
s_add_u32 m0, s43, 32768
s_add_u32 s31, s30, 131072
buffer_load_dwordx4 v210, s[8:11], s30 offen offset:0  lds
buffer_load_dwordx4 v211, s[8:11], s30 offen offset:1024  lds
buffer_load_dwordx4 v212, s[8:11], s30 offen offset:2048  lds
buffer_load_dwordx4 v213, s[8:11], s30 offen offset:3072  lds
s_add_u32 m0, s43, 36864
s_nop 0
buffer_load_dwordx4 v210, s[8:11], s31 offen offset:0  lds
buffer_load_dwordx4 v211, s[8:11], s31 offen offset:1024  lds
buffer_load_dwordx4 v212, s[8:11], s31 offen offset:2048  lds
buffer_load_dwordx4 v213, s[8:11], s31 offen offset:3072  lds
s_add_u32 s30, s30, 262144
s_cmp_eq_u32 s30, s74
s_cselect_b32 s30, s75, s30
s_lshl_b32 s34, s72, 4
s_add_u32 s34, s34, s70
s_lshl_b32 s34, s34, 9
s_lshl_b32 s35, s28, 3
s_add_u32 s35, s35, s71
s_lshl_b32 s35, s35, 2
s_add_u32 s34, s34, s35
s_add_u32 s34, s34, 32505856
s_bitcmp1_b32 s77, 1
s_cselect_b32 s34, 2146435072, s34
s_lshl_b32 s35, s28, 5
v_lshrrev_b32 v3, 1, v252
v_mul_u32_u24 v3, s35, v3
v_lshlrev_b32 v2, 7, v252
v_sub_u32 v2, v2, v3
v_cmp_gt_u32 vcc, 3, v252
v_mov_b32 v3, 2146435072
v_mov_b32 v4, 0
v_cndmask_b32 v2, v3, v2, vcc
buffer_store_dword v4, v2, s[24:27], s34 offen sc1
s_waitcnt vmcnt(9)
s_barrier
ds_read_b128 a[128:131], v208 offset:0
ds_read_b128 a[132:135], v208 offset:2048
ds_read_b128 a[136:139], v208 offset:4096
ds_read_b128 a[140:143], v208 offset:6144
ds_read_b128 a[144:147], v208 offset:8192
ds_read_b128 a[148:151], v208 offset:10240
ds_read_b64_tr_b16 a[0:1], v192 offset:0
ds_read_b64_tr_b16 a[4:5], v193 offset:0
ds_read_b64_tr_b16 a[8:9], v194 offset:0
ds_read_b64_tr_b16 a[12:13], v195 offset:0
ds_read_b64_tr_b16 a[16:17], v196 offset:0
ds_read_b64_tr_b16 a[20:21], v197 offset:0
ds_read_b64_tr_b16 a[24:25], v198 offset:0
ds_read_b64_tr_b16 a[28:29], v199 offset:0
ds_read_b64_tr_b16 a[2:3], v192 offset:1024
ds_read_b64_tr_b16 a[6:7], v193 offset:1024
ds_read_b64_tr_b16 a[10:11], v194 offset:1024
ds_read_b64_tr_b16 a[14:15], v195 offset:1024
ds_read_b64_tr_b16 a[18:19], v196 offset:1024
ds_read_b64_tr_b16 a[22:23], v197 offset:1024
ds_read_b64_tr_b16 a[26:27], v198 offset:1024
ds_read_b64_tr_b16 a[30:31], v199 offset:1024
s_add_u32 m0, s44, 12288
s_nop 0
buffer_load_dwordx4 v214, s[4:7], s29 offen offset:0  lds
s_waitcnt lgkmcnt(7)
v_mfma_f32_16x16x32_bf16 v[0:3], a[0:3], a[128:131], 0
s_waitcnt vmcnt(2)
v_mfma_f32_16x16x32_bf16 v[8:11], a[0:3], a[132:135], 0
ds_read_b64_tr_b16 a[32:33], v192 offset:32768
buffer_load_dwordx4 v215, s[4:7], s29 offen offset:1024  lds
v_mfma_f32_16x16x32_bf16 v[16:19], a[0:3], a[136:139], 0
ds_read_b64_tr_b16 a[36:37], v193 offset:32768
v_mfma_f32_16x16x32_bf16 v[24:27], a[0:3], a[140:143], 0
ds_read_b64_tr_b16 a[40:41], v194 offset:32768
buffer_load_dwordx4 v216, s[4:7], s29 offen offset:2048  lds
v_mfma_f32_16x16x32_bf16 v[32:35], a[0:3], a[144:147], 0
ds_read_b64_tr_b16 a[44:45], v195 offset:32768
s_add_u32 s29, s29, 128
v_mfma_f32_16x16x32_bf16 v[40:43], a[0:3], a[148:151], 0
ds_read_b64_tr_b16 a[48:49], v196 offset:32768
s_cmp_eq_u32 s29, s47
s_cselect_b32 s29, s73, s29
s_add_u32 m0, s43, 65536
s_add_u32 s31, s30, 131072
buffer_load_dwordx4 v210, s[8:11], s30 offen offset:0  lds
s_waitcnt lgkmcnt(11)
v_mfma_f32_16x16x32_bf16 v[4:7], a[4:7], a[128:131], 0
ds_read_b64_tr_b16 a[52:53], v197 offset:32768
v_mfma_f32_16x16x32_bf16 v[12:15], a[4:7], a[132:135], 0
ds_read_b64_tr_b16 a[56:57], v198 offset:32768
buffer_load_dwordx4 v211, s[8:11], s30 offen offset:1024  lds
v_mfma_f32_16x16x32_bf16 v[20:23], a[4:7], a[136:139], 0
ds_read_b64_tr_b16 a[60:61], v199 offset:32768
v_mfma_f32_16x16x32_bf16 v[28:31], a[4:7], a[140:143], 0
ds_read_b64_tr_b16 a[34:35], v192 offset:33792
buffer_load_dwordx4 v212, s[8:11], s30 offen offset:2048  lds
v_mfma_f32_16x16x32_bf16 v[36:39], a[4:7], a[144:147], 0
ds_read_b64_tr_b16 a[38:39], v193 offset:33792
v_mfma_f32_16x16x32_bf16 v[44:47], a[4:7], a[148:151], 0
ds_read_b64_tr_b16 a[42:43], v194 offset:33792
buffer_load_dwordx4 v213, s[8:11], s30 offen offset:3072  lds
s_waitcnt lgkmcnt(15)
v_mfma_f32_16x16x32_bf16 v[48:51], a[8:11], a[128:131], 0
ds_read_b64_tr_b16 a[46:47], v195 offset:33792
s_add_u32 m0, s43, 69632
v_mfma_f32_16x16x32_bf16 v[56:59], a[8:11], a[132:135], 0
ds_read_b64_tr_b16 a[50:51], v196 offset:33792
buffer_load_dwordx4 v210, s[8:11], s31 offen offset:0  lds
v_mfma_f32_16x16x32_bf16 v[64:67], a[8:11], a[136:139], 0
ds_read_b64_tr_b16 a[54:55], v197 offset:33792
v_mfma_f32_16x16x32_bf16 v[72:75], a[8:11], a[140:143], 0
ds_read_b64_tr_b16 a[58:59], v198 offset:33792
buffer_load_dwordx4 v211, s[8:11], s31 offen offset:1024  lds
v_mfma_f32_16x16x32_bf16 v[80:83], a[8:11], a[144:147], 0
ds_read_b64_tr_b16 a[62:63], v199 offset:33792
v_mfma_f32_16x16x32_bf16 v[88:91], a[8:11], a[148:151], 0
ds_read_b128 a[152:155], v209 offset:0
buffer_load_dwordx4 v212, s[8:11], s31 offen offset:2048  lds
v_mfma_f32_16x16x32_bf16 v[52:55], a[12:15], a[128:131], 0
ds_read_b128 a[156:159], v209 offset:2048
v_mfma_f32_16x16x32_bf16 v[60:63], a[12:15], a[132:135], 0
ds_read_b128 a[160:163], v209 offset:4096
buffer_load_dwordx4 v213, s[8:11], s31 offen offset:3072  lds
v_mfma_f32_16x16x32_bf16 v[68:71], a[12:15], a[136:139], 0
ds_read_b128 a[164:167], v209 offset:6144
s_add_u32 s30, s30, 262144
v_mfma_f32_16x16x32_bf16 v[76:79], a[12:15], a[140:143], 0
ds_read_b128 a[168:171], v209 offset:8192
s_add_u32 m0, s43, 98304
v_mfma_f32_16x16x32_bf16 v[84:87], a[12:15], a[144:147], 0
ds_read_b128 a[172:175], v209 offset:10240
s_add_u32 s31, s30, 131072
v_mfma_f32_16x16x32_bf16 v[92:95], a[12:15], a[148:151], 0
buffer_load_dwordx4 v210, s[8:11], s30 offen offset:0  lds
s_waitcnt lgkmcnt(15)
v_mfma_f32_16x16x32_bf16 v[96:99], a[16:19], a[128:131], 0
v_mfma_f32_16x16x32_bf16 v[104:107], a[16:19], a[132:135], 0
v_mfma_f32_16x16x32_bf16 v[112:115], a[16:19], a[136:139], 0
v_mfma_f32_16x16x32_bf16 v[120:123], a[16:19], a[140:143], 0
buffer_load_dwordx4 v211, s[8:11], s30 offen offset:1024  lds
v_mfma_f32_16x16x32_bf16 v[128:131], a[16:19], a[144:147], 0
v_mfma_f32_16x16x32_bf16 v[136:139], a[16:19], a[148:151], 0
v_mfma_f32_16x16x32_bf16 v[100:103], a[20:23], a[128:131], 0
v_mfma_f32_16x16x32_bf16 v[108:111], a[20:23], a[132:135], 0
buffer_load_dwordx4 v212, s[8:11], s30 offen offset:2048  lds
v_mfma_f32_16x16x32_bf16 v[116:119], a[20:23], a[136:139], 0
v_mfma_f32_16x16x32_bf16 v[124:127], a[20:23], a[140:143], 0
v_mfma_f32_16x16x32_bf16 v[132:135], a[20:23], a[144:147], 0
v_mfma_f32_16x16x32_bf16 v[140:143], a[20:23], a[148:151], 0
buffer_load_dwordx4 v213, s[8:11], s30 offen offset:3072  lds
s_add_u32 m0, s43, 102400
v_mfma_f32_16x16x32_bf16 v[144:147], a[24:27], a[128:131], 0
v_mfma_f32_16x16x32_bf16 v[152:155], a[24:27], a[132:135], 0
v_mfma_f32_16x16x32_bf16 v[160:163], a[24:27], a[136:139], 0
v_mfma_f32_16x16x32_bf16 v[168:171], a[24:27], a[140:143], 0
v_mfma_f32_16x16x32_bf16 v[176:179], a[24:27], a[144:147], 0
buffer_load_dwordx4 v210, s[8:11], s31 offen offset:0  lds
v_mfma_f32_16x16x32_bf16 v[184:187], a[24:27], a[148:151], 0
v_mfma_f32_16x16x32_bf16 v[148:151], a[28:31], a[128:131], 0
v_mfma_f32_16x16x32_bf16 v[156:159], a[28:31], a[132:135], 0
v_mfma_f32_16x16x32_bf16 v[164:167], a[28:31], a[136:139], 0
buffer_load_dwordx4 v211, s[8:11], s31 offen offset:1024  lds
v_mfma_f32_16x16x32_bf16 v[172:175], a[28:31], a[140:143], 0
v_mfma_f32_16x16x32_bf16 v[180:183], a[28:31], a[144:147], 0
v_mfma_f32_16x16x32_bf16 v[188:191], a[28:31], a[148:151], 0
s_waitcnt lgkmcnt(0)
v_mfma_f32_16x16x32_bf16 v[0:3], a[32:35], a[152:155], v[0:3]
s_waitcnt vmcnt(14)
s_barrier
s_waitcnt vmcnt(6)
buffer_load_dwordx4 v212, s[8:11], s31 offen offset:2048  lds
v_mfma_f32_16x16x32_bf16 v[8:11], a[32:35], a[156:159], v[8:11]
ds_read_b64_tr_b16 a[64:65], v200 offset:0
v_mfma_f32_16x16x32_bf16 v[16:19], a[32:35], a[160:163], v[16:19]
ds_read_b64_tr_b16 a[68:69], v201 offset:0
v_mfma_f32_16x16x32_bf16 v[24:27], a[32:35], a[164:167], v[24:27]
ds_read_b64_tr_b16 a[72:73], v202 offset:0
v_mfma_f32_16x16x32_bf16 v[32:35], a[32:35], a[168:171], v[32:35]
ds_read_b64_tr_b16 a[76:77], v203 offset:0
buffer_load_dwordx4 v213, s[8:11], s31 offen offset:3072  lds
v_mfma_f32_16x16x32_bf16 v[40:43], a[32:35], a[172:175], v[40:43]
ds_read_b64_tr_b16 a[80:81], v204 offset:0
s_add_u32 s30, s30, 262144
v_mfma_f32_16x16x32_bf16 v[4:7], a[36:39], a[152:155], v[4:7]
ds_read_b64_tr_b16 a[84:85], v205 offset:0
s_cmp_eq_u32 s30, s74
s_cselect_b32 s30, s75, s30
v_mfma_f32_16x16x32_bf16 v[12:15], a[36:39], a[156:159], v[12:15]
ds_read_b64_tr_b16 a[88:89], v206 offset:0
s_add_u32 m0, s44, 0
s_nop 0
v_mfma_f32_16x16x32_bf16 v[20:23], a[36:39], a[160:163], v[20:23]
ds_read_b64_tr_b16 a[92:93], v207 offset:0
buffer_load_dwordx4 v214, s[4:7], s29 offen offset:0  lds
v_mfma_f32_16x16x32_bf16 v[28:31], a[36:39], a[164:167], v[28:31]
ds_read_b64_tr_b16 a[66:67], v200 offset:1024
v_mfma_f32_16x16x32_bf16 v[36:39], a[36:39], a[168:171], v[36:39]
ds_read_b64_tr_b16 a[70:71], v201 offset:1024
v_mfma_f32_16x16x32_bf16 v[44:47], a[36:39], a[172:175], v[44:47]
ds_read_b64_tr_b16 a[74:75], v202 offset:1024
v_mfma_f32_16x16x32_bf16 v[48:51], a[40:43], a[152:155], v[48:51]
ds_read_b64_tr_b16 a[78:79], v203 offset:1024
v_mfma_f32_16x16x32_bf16 v[56:59], a[40:43], a[156:159], v[56:59]
ds_read_b64_tr_b16 a[82:83], v204 offset:1024
buffer_load_dwordx4 v215, s[4:7], s29 offen offset:1024  lds
v_mfma_f32_16x16x32_bf16 v[64:67], a[40:43], a[160:163], v[64:67]
ds_read_b64_tr_b16 a[86:87], v205 offset:1024
v_mfma_f32_16x16x32_bf16 v[72:75], a[40:43], a[164:167], v[72:75]
ds_read_b64_tr_b16 a[90:91], v206 offset:1024
v_mfma_f32_16x16x32_bf16 v[80:83], a[40:43], a[168:171], v[80:83]
ds_read_b64_tr_b16 a[94:95], v207 offset:1024
v_mfma_f32_16x16x32_bf16 v[88:91], a[40:43], a[172:175], v[88:91]
ds_read_b128 a[176:179], v208 offset:12288
buffer_load_dwordx4 v216, s[4:7], s29 offen offset:2048  lds
v_mfma_f32_16x16x32_bf16 v[52:55], a[44:47], a[152:155], v[52:55]
ds_read_b128 a[180:183], v208 offset:14336
s_add_u32 s29, s29, 128
v_mfma_f32_16x16x32_bf16 v[60:63], a[44:47], a[156:159], v[60:63]
ds_read_b128 a[184:187], v208 offset:16384
s_cmp_eq_u32 s29, s47
s_cselect_b32 s29, s73, s29
v_mfma_f32_16x16x32_bf16 v[68:71], a[44:47], a[160:163], v[68:71]
ds_read_b128 a[188:191], v208 offset:18432
s_add_u32 m0, s43, 0
s_add_u32 s31, s30, 131072
v_mfma_f32_16x16x32_bf16 v[76:79], a[44:47], a[164:167], v[76:79]
ds_read_b128 a[192:195], v208 offset:20480
buffer_load_dwordx4 v210, s[8:11], s30 offen offset:0  lds
v_mfma_f32_16x16x32_bf16 v[84:87], a[44:47], a[168:171], v[84:87]
ds_read_b128 a[196:199], v208 offset:22528
v_mfma_f32_16x16x32_bf16 v[92:95], a[44:47], a[172:175], v[92:95]
v_mfma_f32_16x16x32_bf16 v[96:99], a[48:51], a[152:155], v[96:99]
v_mfma_f32_16x16x32_bf16 v[104:107], a[48:51], a[156:159], v[104:107]
buffer_load_dwordx4 v211, s[8:11], s30 offen offset:1024  lds
v_mfma_f32_16x16x32_bf16 v[112:115], a[48:51], a[160:163], v[112:115]
v_mfma_f32_16x16x32_bf16 v[120:123], a[48:51], a[164:167], v[120:123]
v_mfma_f32_16x16x32_bf16 v[128:131], a[48:51], a[168:171], v[128:131]
v_mfma_f32_16x16x32_bf16 v[136:139], a[48:51], a[172:175], v[136:139]
buffer_load_dwordx4 v212, s[8:11], s30 offen offset:2048  lds
v_mfma_f32_16x16x32_bf16 v[100:103], a[52:55], a[152:155], v[100:103]
v_mfma_f32_16x16x32_bf16 v[108:111], a[52:55], a[156:159], v[108:111]
v_mfma_f32_16x16x32_bf16 v[116:119], a[52:55], a[160:163], v[116:119]
v_mfma_f32_16x16x32_bf16 v[124:127], a[52:55], a[164:167], v[124:127]
v_mfma_f32_16x16x32_bf16 v[132:135], a[52:55], a[168:171], v[132:135]
buffer_load_dwordx4 v213, s[8:11], s30 offen offset:3072  lds
s_add_u32 m0, s43, 4096
v_mfma_f32_16x16x32_bf16 v[140:143], a[52:55], a[172:175], v[140:143]
v_mfma_f32_16x16x32_bf16 v[144:147], a[56:59], a[152:155], v[144:147]
v_mfma_f32_16x16x32_bf16 v[152:155], a[56:59], a[156:159], v[152:155]
v_mfma_f32_16x16x32_bf16 v[160:163], a[56:59], a[160:163], v[160:163]
buffer_load_dwordx4 v210, s[8:11], s31 offen offset:0  lds
v_mfma_f32_16x16x32_bf16 v[168:171], a[56:59], a[164:167], v[168:171]
v_mfma_f32_16x16x32_bf16 v[176:179], a[56:59], a[168:171], v[176:179]
v_mfma_f32_16x16x32_bf16 v[184:187], a[56:59], a[172:175], v[184:187]
v_mfma_f32_16x16x32_bf16 v[148:151], a[60:63], a[152:155], v[148:151]
buffer_load_dwordx4 v211, s[8:11], s31 offen offset:1024  lds
v_mfma_f32_16x16x32_bf16 v[156:159], a[60:63], a[156:159], v[156:159]
v_mfma_f32_16x16x32_bf16 v[164:167], a[60:63], a[160:163], v[164:167]
v_mfma_f32_16x16x32_bf16 v[172:175], a[60:63], a[164:167], v[172:175]
v_mfma_f32_16x16x32_bf16 v[180:183], a[60:63], a[168:171], v[180:183]
buffer_load_dwordx4 v212, s[8:11], s31 offen offset:2048  lds
v_mfma_f32_16x16x32_bf16 v[188:191], a[60:63], a[172:175], v[188:191]
s_waitcnt lgkmcnt(0)
v_mfma_f32_16x16x32_bf16 v[0:3], a[64:67], a[176:179], v[0:3]
s_waitcnt vmcnt(10)
v_mfma_f32_16x16x32_bf16 v[8:11], a[64:67], a[180:183], v[8:11]
ds_read_b64_tr_b16 a[96:97], v200 offset:32768
v_mfma_f32_16x16x32_bf16 v[16:19], a[64:67], a[184:187], v[16:19]
ds_read_b64_tr_b16 a[100:101], v201 offset:32768
buffer_load_dwordx4 v213, s[8:11], s31 offen offset:3072  lds
v_mfma_f32_16x16x32_bf16 v[24:27], a[64:67], a[188:191], v[24:27]
ds_read_b64_tr_b16 a[104:105], v202 offset:32768
s_add_u32 s30, s30, 262144
v_mfma_f32_16x16x32_bf16 v[32:35], a[64:67], a[192:195], v[32:35]
ds_read_b64_tr_b16 a[108:109], v203 offset:32768
s_add_u32 m0, s43, 32768
v_mfma_f32_16x16x32_bf16 v[40:43], a[64:67], a[196:199], v[40:43]
ds_read_b64_tr_b16 a[112:113], v204 offset:32768
s_add_u32 s31, s30, 131072
v_mfma_f32_16x16x32_bf16 v[4:7], a[68:71], a[176:179], v[4:7]
ds_read_b64_tr_b16 a[116:117], v205 offset:32768
v_mfma_f32_16x16x32_bf16 v[12:15], a[68:71], a[180:183], v[12:15]
ds_read_b64_tr_b16 a[120:121], v206 offset:32768
buffer_load_dwordx4 v210, s[8:11], s30 offen offset:0  lds
v_mfma_f32_16x16x32_bf16 v[20:23], a[68:71], a[184:187], v[20:23]
ds_read_b64_tr_b16 a[124:125], v207 offset:32768
v_mfma_f32_16x16x32_bf16 v[28:31], a[68:71], a[188:191], v[28:31]
ds_read_b64_tr_b16 a[98:99], v200 offset:33792
v_mfma_f32_16x16x32_bf16 v[36:39], a[68:71], a[192:195], v[36:39]
ds_read_b64_tr_b16 a[102:103], v201 offset:33792
v_mfma_f32_16x16x32_bf16 v[44:47], a[68:71], a[196:199], v[44:47]
ds_read_b64_tr_b16 a[106:107], v202 offset:33792
buffer_load_dwordx4 v211, s[8:11], s30 offen offset:1024  lds
v_mfma_f32_16x16x32_bf16 v[48:51], a[72:75], a[176:179], v[48:51]
ds_read_b64_tr_b16 a[110:111], v203 offset:33792
v_mfma_f32_16x16x32_bf16 v[56:59], a[72:75], a[180:183], v[56:59]
ds_read_b64_tr_b16 a[114:115], v204 offset:33792
v_mfma_f32_16x16x32_bf16 v[64:67], a[72:75], a[184:187], v[64:67]
ds_read_b64_tr_b16 a[118:119], v205 offset:33792
v_mfma_f32_16x16x32_bf16 v[72:75], a[72:75], a[188:191], v[72:75]
ds_read_b64_tr_b16 a[122:123], v206 offset:33792
buffer_load_dwordx4 v212, s[8:11], s30 offen offset:2048  lds
v_mfma_f32_16x16x32_bf16 v[80:83], a[72:75], a[192:195], v[80:83]
ds_read_b64_tr_b16 a[126:127], v207 offset:33792
v_mfma_f32_16x16x32_bf16 v[88:91], a[72:75], a[196:199], v[88:91]
ds_read_b128 a[200:203], v209 offset:12288
v_mfma_f32_16x16x32_bf16 v[52:55], a[76:79], a[176:179], v[52:55]
ds_read_b128 a[204:207], v209 offset:14336
v_mfma_f32_16x16x32_bf16 v[60:63], a[76:79], a[180:183], v[60:63]
ds_read_b128 a[208:211], v209 offset:16384
buffer_load_dwordx4 v213, s[8:11], s30 offen offset:3072  lds
v_mfma_f32_16x16x32_bf16 v[68:71], a[76:79], a[184:187], v[68:71]
ds_read_b128 a[212:215], v209 offset:18432
s_add_u32 m0, s43, 36864
v_mfma_f32_16x16x32_bf16 v[76:79], a[76:79], a[188:191], v[76:79]
ds_read_b128 a[216:219], v209 offset:20480
v_mfma_f32_16x16x32_bf16 v[84:87], a[76:79], a[192:195], v[84:87]
ds_read_b128 a[220:223], v209 offset:22528
v_mfma_f32_16x16x32_bf16 v[92:95], a[76:79], a[196:199], v[92:95]
buffer_load_dwordx4 v210, s[8:11], s31 offen offset:0  lds
v_mov_b32 v223, 0x3f803f80
v_mfma_f32_16x16x32_bf16 v[96:99], a[80:83], a[176:179], v[96:99]
v_accvgpr_write_b32 a248, v223
v_accvgpr_write_b32 a249, v223
v_mfma_f32_16x16x32_bf16 v[104:107], a[80:83], a[180:183], v[104:107]
v_accvgpr_write_b32 a250, v223
v_accvgpr_write_b32 a251, v223
v_mfma_f32_16x16x32_bf16 v[112:115], a[80:83], a[184:187], v[112:115]
v_mfma_f32_16x16x32_bf16 v[120:123], a[80:83], a[188:191], v[120:123]
v_mfma_f32_16x16x32_bf16 v[128:131], a[80:83], a[192:195], v[128:131]
buffer_load_dwordx4 v211, s[8:11], s31 offen offset:1024  lds
v_mfma_f32_16x16x32_bf16 v[136:139], a[80:83], a[196:199], v[136:139]
v_mfma_f32_16x16x32_bf16 v[100:103], a[84:87], a[176:179], v[100:103]
v_mfma_f32_16x16x32_bf16 v[108:111], a[84:87], a[180:183], v[108:111]
v_mfma_f32_16x16x32_bf16 v[116:119], a[84:87], a[184:187], v[116:119]
buffer_load_dwordx4 v212, s[8:11], s31 offen offset:2048  lds
v_mfma_f32_16x16x32_bf16 v[124:127], a[84:87], a[188:191], v[124:127]
v_mfma_f32_16x16x32_bf16 v[132:135], a[84:87], a[192:195], v[132:135]
v_mfma_f32_16x16x32_bf16 v[140:143], a[84:87], a[196:199], v[140:143]
v_mfma_f32_16x16x32_bf16 v[144:147], a[88:91], a[176:179], v[144:147]
buffer_load_dwordx4 v213, s[8:11], s31 offen offset:3072  lds
s_add_u32 s30, s30, 262144
v_mfma_f32_16x16x32_bf16 v[152:155], a[88:91], a[180:183], v[152:155]
s_cmp_eq_u32 s30, s74
s_cselect_b32 s30, s75, s30
v_mfma_f32_16x16x32_bf16 v[160:163], a[88:91], a[184:187], v[160:163]
s_add_u32 m0, s43, 65536
s_add_u32 s31, s30, 131072
v_mfma_f32_16x16x32_bf16 v[168:171], a[88:91], a[188:191], v[168:171]
v_mfma_f32_16x16x32_bf16 v[176:179], a[88:91], a[192:195], v[176:179]
buffer_load_dwordx4 v210, s[8:11], s30 offen offset:0  lds
v_mfma_f32_16x16x32_bf16 v[184:187], a[88:91], a[196:199], v[184:187]
v_mfma_f32_16x16x32_bf16 v[148:151], a[92:95], a[176:179], v[148:151]
v_mfma_f32_16x16x32_bf16 v[156:159], a[92:95], a[180:183], v[156:159]
v_mfma_f32_16x16x32_bf16 v[164:167], a[92:95], a[184:187], v[164:167]
buffer_load_dwordx4 v211, s[8:11], s30 offen offset:1024  lds
v_mfma_f32_16x16x32_bf16 v[172:175], a[92:95], a[188:191], v[172:175]
v_mfma_f32_16x16x32_bf16 v[180:183], a[92:95], a[192:195], v[180:183]
v_mfma_f32_16x16x32_bf16 v[188:191], a[92:95], a[196:199], v[188:191]
s_waitcnt lgkmcnt(0)
v_mfma_f32_16x16x32_bf16 v[0:3], a[96:99], a[200:203], v[0:3]
s_waitcnt vmcnt(18)
s_barrier
s_waitcnt vmcnt(10)
v_mfma_f32_16x16x32_bf16 v[8:11], a[96:99], a[204:207], v[8:11]
ds_read_b64_tr_b16 a[0:1], v192 offset:0
buffer_load_dwordx4 v212, s[8:11], s30 offen offset:2048  lds
v_mfma_f32_16x16x32_bf16 v[16:19], a[96:99], a[208:211], v[16:19]
ds_read_b64_tr_b16 a[4:5], v193 offset:0
v_mfma_f32_16x16x32_bf16 v[24:27], a[96:99], a[212:215], v[24:27]
ds_read_b64_tr_b16 a[8:9], v194 offset:0
v_mfma_f32_16x16x32_bf16 v[32:35], a[96:99], a[216:219], v[32:35]
ds_read_b64_tr_b16 a[12:13], v195 offset:0
v_mfma_f32_16x16x32_bf16 v[40:43], a[96:99], a[220:223], v[40:43]
ds_read_b64_tr_b16 a[16:17], v196 offset:0
buffer_load_dwordx4 v213, s[8:11], s30 offen offset:3072  lds
v_mfma_f32_16x16x32_bf16 v[4:7], a[100:103], a[200:203], v[4:7]
ds_read_b64_tr_b16 a[20:21], v197 offset:0
s_add_u32 m0, s43, 69632
v_mfma_f32_16x16x32_bf16 v[12:15], a[100:103], a[204:207], v[12:15]
ds_read_b64_tr_b16 a[24:25], v198 offset:0
v_mfma_f32_16x16x32_bf16 v[20:23], a[100:103], a[208:211], v[20:23]
ds_read_b64_tr_b16 a[28:29], v199 offset:0
v_mfma_f32_16x16x32_bf16 v[28:31], a[100:103], a[212:215], v[28:31]
ds_read_b64_tr_b16 a[2:3], v192 offset:1024
buffer_load_dwordx4 v210, s[8:11], s31 offen offset:0  lds
v_mfma_f32_16x16x32_bf16 v[36:39], a[100:103], a[216:219], v[36:39]
ds_read_b64_tr_b16 a[6:7], v193 offset:1024
v_mfma_f32_16x16x32_bf16 v[44:47], a[100:103], a[220:223], v[44:47]
ds_read_b64_tr_b16 a[10:11], v194 offset:1024
v_mfma_f32_16x16x32_bf16 v[48:51], a[104:107], a[200:203], v[48:51]
ds_read_b64_tr_b16 a[14:15], v195 offset:1024
v_mfma_f32_16x16x32_bf16 v[56:59], a[104:107], a[204:207], v[56:59]
ds_read_b64_tr_b16 a[18:19], v196 offset:1024
buffer_load_dwordx4 v211, s[8:11], s31 offen offset:1024  lds
v_mfma_f32_16x16x32_bf16 v[64:67], a[104:107], a[208:211], v[64:67]
ds_read_b64_tr_b16 a[22:23], v197 offset:1024
v_mfma_f32_16x16x32_bf16 v[72:75], a[104:107], a[212:215], v[72:75]
ds_read_b64_tr_b16 a[26:27], v198 offset:1024
v_mfma_f32_16x16x32_bf16 v[80:83], a[104:107], a[216:219], v[80:83]
ds_read_b64_tr_b16 a[30:31], v199 offset:1024
v_mfma_f32_16x16x32_bf16 v[88:91], a[104:107], a[220:223], v[88:91]
ds_read_b128 a[128:131], v208 offset:0
buffer_load_dwordx4 v212, s[8:11], s31 offen offset:2048  lds
v_mfma_f32_16x16x32_bf16 v[52:55], a[108:111], a[200:203], v[52:55]
ds_read_b128 a[132:135], v208 offset:2048
v_mfma_f32_16x16x32_bf16 v[60:63], a[108:111], a[204:207], v[60:63]
ds_read_b128 a[136:139], v208 offset:4096
v_mfma_f32_16x16x32_bf16 v[68:71], a[108:111], a[208:211], v[68:71]
ds_read_b128 a[140:143], v208 offset:6144
v_mfma_f32_16x16x32_bf16 v[76:79], a[108:111], a[212:215], v[76:79]
ds_read_b128 a[144:147], v208 offset:8192
buffer_load_dwordx4 v213, s[8:11], s31 offen offset:3072  lds
v_mfma_f32_16x16x32_bf16 v[84:87], a[108:111], a[216:219], v[84:87]
ds_read_b128 a[148:151], v208 offset:10240
s_add_u32 s30, s30, 262144
v_mfma_f32_16x16x32_bf16 v[92:95], a[108:111], a[220:223], v[92:95]
s_add_u32 m0, s44, 12288
s_nop 0
v_mfma_f32_16x16x32_bf16 v[96:99], a[112:115], a[200:203], v[96:99]
v_mfma_f32_16x16x32_bf16 v[104:107], a[112:115], a[204:207], v[104:107]
v_mfma_f32_16x16x32_bf16 v[112:115], a[112:115], a[208:211], v[112:115]
buffer_load_dwordx4 v214, s[4:7], s29 offen offset:0  lds
v_mfma_f32_16x16x32_bf16 v[120:123], a[112:115], a[212:215], v[120:123]
v_mfma_f32_16x16x32_bf16 v[128:131], a[112:115], a[216:219], v[128:131]
v_mfma_f32_16x16x32_bf16 v[136:139], a[112:115], a[220:223], v[136:139]
v_mfma_f32_16x16x32_bf16 v[100:103], a[116:119], a[200:203], v[100:103]
buffer_load_dwordx4 v215, s[4:7], s29 offen offset:1024  lds
v_mfma_f32_16x16x32_bf16 v[108:111], a[116:119], a[204:207], v[108:111]
v_mfma_f32_16x16x32_bf16 v[116:119], a[116:119], a[208:211], v[116:119]
v_mfma_f32_16x16x32_bf16 v[124:127], a[116:119], a[212:215], v[124:127]
v_mfma_f32_16x16x32_bf16 v[132:135], a[116:119], a[216:219], v[132:135]
buffer_load_dwordx4 v216, s[4:7], s29 offen offset:2048  lds
s_add_u32 s29, s29, 128
v_mfma_f32_16x16x32_bf16 v[140:143], a[116:119], a[220:223], v[140:143]
s_cmp_eq_u32 s29, s47
s_cselect_b32 s29, s73, s29
v_mfma_f32_16x16x32_bf16 v[144:147], a[120:123], a[200:203], v[144:147]
s_add_u32 m0, s43, 98304
s_add_u32 s31, s30, 131072
v_mfma_f32_16x16x32_bf16 v[152:155], a[120:123], a[204:207], v[152:155]
v_mfma_f32_16x16x32_bf16 v[160:163], a[120:123], a[208:211], v[160:163]
buffer_load_dwordx4 v210, s[8:11], s30 offen offset:0  lds
v_mfma_f32_16x16x32_bf16 v[168:171], a[120:123], a[212:215], v[168:171]
v_mfma_f32_16x16x32_bf16 v[176:179], a[120:123], a[216:219], v[176:179]
v_mfma_f32_16x16x32_bf16 v[184:187], a[120:123], a[220:223], v[184:187]
v_mfma_f32_16x16x32_bf16 v[148:151], a[124:127], a[200:203], v[148:151]
buffer_load_dwordx4 v211, s[8:11], s30 offen offset:1024  lds
v_mfma_f32_16x16x32_bf16 v[156:159], a[124:127], a[204:207], v[156:159]
v_mfma_f32_16x16x32_bf16 v[164:167], a[124:127], a[208:211], v[164:167]
v_mfma_f32_16x16x32_bf16 v[172:175], a[124:127], a[212:215], v[172:175]
v_mfma_f32_16x16x32_bf16 v[180:183], a[124:127], a[216:219], v[180:183]
v_mfma_f32_16x16x32_bf16 v[188:191], a[124:127], a[220:223], v[188:191]
buffer_load_dwordx4 v212, s[8:11], s30 offen offset:2048  lds
s_waitcnt lgkmcnt(0)
v_mfma_f32_16x16x32_bf16 v[0:3], a[0:3], a[128:131], v[0:3]
s_waitcnt vmcnt(14)
v_mfma_f32_16x16x32_bf16 v[8:11], a[0:3], a[132:135], v[8:11]
ds_read_b64_tr_b16 a[32:33], v192 offset:32768
v_mfma_f32_16x16x32_bf16 v[16:19], a[0:3], a[136:139], v[16:19]
ds_read_b64_tr_b16 a[36:37], v193 offset:32768
v_mfma_f32_16x16x32_bf16 v[24:27], a[0:3], a[140:143], v[24:27]
ds_read_b64_tr_b16 a[40:41], v194 offset:32768
buffer_load_dwordx4 v213, s[8:11], s30 offen offset:3072  lds
v_mfma_f32_16x16x32_bf16 v[32:35], a[0:3], a[144:147], v[32:35]
ds_read_b64_tr_b16 a[44:45], v195 offset:32768
s_add_u32 m0, s43, 102400
v_mfma_f32_16x16x32_bf16 v[40:43], a[0:3], a[148:151], v[40:43]
ds_read_b64_tr_b16 a[48:49], v196 offset:32768
v_mfma_f32_16x16x32_bf16 v[4:7], a[4:7], a[128:131], v[4:7]
ds_read_b64_tr_b16 a[52:53], v197 offset:32768
v_mfma_f32_16x16x32_bf16 v[12:15], a[4:7], a[132:135], v[12:15]
ds_read_b64_tr_b16 a[56:57], v198 offset:32768
buffer_load_dwordx4 v210, s[8:11], s31 offen offset:0  lds
v_mfma_f32_16x16x32_bf16 v[20:23], a[4:7], a[136:139], v[20:23]
ds_read_b64_tr_b16 a[60:61], v199 offset:32768
v_mfma_f32_16x16x32_bf16 v[28:31], a[4:7], a[140:143], v[28:31]
ds_read_b64_tr_b16 a[34:35], v192 offset:33792
v_mfma_f32_16x16x32_bf16 v[36:39], a[4:7], a[144:147], v[36:39]
ds_read_b64_tr_b16 a[38:39], v193 offset:33792
v_mfma_f32_16x16x32_bf16 v[44:47], a[4:7], a[148:151], v[44:47]
ds_read_b64_tr_b16 a[42:43], v194 offset:33792
buffer_load_dwordx4 v211, s[8:11], s31 offen offset:1024  lds
v_mfma_f32_16x16x32_bf16 v[48:51], a[8:11], a[128:131], v[48:51]
ds_read_b64_tr_b16 a[46:47], v195 offset:33792
v_mfma_f32_16x16x32_bf16 v[56:59], a[8:11], a[132:135], v[56:59]
ds_read_b64_tr_b16 a[50:51], v196 offset:33792
v_mfma_f32_16x16x32_bf16 v[64:67], a[8:11], a[136:139], v[64:67]
ds_read_b64_tr_b16 a[54:55], v197 offset:33792
v_mfma_f32_16x16x32_bf16 v[72:75], a[8:11], a[140:143], v[72:75]
ds_read_b64_tr_b16 a[58:59], v198 offset:33792
buffer_load_dwordx4 v212, s[8:11], s31 offen offset:2048  lds
v_mfma_f32_16x16x32_bf16 v[80:83], a[8:11], a[144:147], v[80:83]
ds_read_b64_tr_b16 a[62:63], v199 offset:33792
v_mfma_f32_16x16x32_bf16 v[88:91], a[8:11], a[148:151], v[88:91]
ds_read_b128 a[152:155], v209 offset:0
v_mfma_f32_16x16x32_bf16 v[52:55], a[12:15], a[128:131], v[52:55]
ds_read_b128 a[156:159], v209 offset:2048
v_mfma_f32_16x16x32_bf16 v[60:63], a[12:15], a[132:135], v[60:63]
ds_read_b128 a[160:163], v209 offset:4096
v_mfma_f32_16x16x32_bf16 v[68:71], a[12:15], a[136:139], v[68:71]
ds_read_b128 a[164:167], v209 offset:6144
buffer_load_dwordx4 v213, s[8:11], s31 offen offset:3072  lds
v_mfma_f32_16x16x32_bf16 v[76:79], a[12:15], a[140:143], v[76:79]
ds_read_b128 a[168:171], v209 offset:8192
s_add_u32 s30, s30, 262144
v_mfma_f32_16x16x32_bf16 v[84:87], a[12:15], a[144:147], v[84:87]
ds_read_b128 a[172:175], v209 offset:10240
s_cmp_eq_u32 s30, s74
s_cselect_b32 s30, s75, s30
v_mfma_f32_16x16x32_bf16 v[92:95], a[12:15], a[148:151], v[92:95]
s_add_u32 m0, s43, 0
s_add_u32 s31, s30, 131072
v_mfma_f32_16x16x32_bf16 v[96:99], a[16:19], a[128:131], v[96:99]
buffer_load_dwordx4 v210, s[8:11], s30 offen offset:0  lds
v_mfma_f32_16x16x32_bf16 v[104:107], a[16:19], a[132:135], v[104:107]
v_mfma_f32_16x16x32_bf16 v[112:115], a[16:19], a[136:139], v[112:115]
v_mfma_f32_16x16x32_bf16 v[120:123], a[16:19], a[140:143], v[120:123]
v_mfma_f32_16x16x32_bf16 v[128:131], a[16:19], a[144:147], v[128:131]
buffer_load_dwordx4 v211, s[8:11], s30 offen offset:1024  lds
v_mfma_f32_16x16x32_bf16 v[136:139], a[16:19], a[148:151], v[136:139]
v_mfma_f32_16x16x32_bf16 v[100:103], a[20:23], a[128:131], v[100:103]
v_mfma_f32_16x16x32_bf16 v[108:111], a[20:23], a[132:135], v[108:111]
v_mfma_f32_16x16x32_bf16 v[116:119], a[20:23], a[136:139], v[116:119]
buffer_load_dwordx4 v212, s[8:11], s30 offen offset:2048  lds
v_mfma_f32_16x16x32_bf16 v[124:127], a[20:23], a[140:143], v[124:127]
v_mfma_f32_16x16x32_bf16 v[132:135], a[20:23], a[144:147], v[132:135]
v_mfma_f32_16x16x32_bf16 v[140:143], a[20:23], a[148:151], v[140:143]
v_mfma_f32_16x16x32_bf16 v[144:147], a[24:27], a[128:131], v[144:147]
buffer_load_dwordx4 v213, s[8:11], s30 offen offset:3072  lds
s_add_u32 m0, s43, 4096
v_mfma_f32_16x16x32_bf16 v[152:155], a[24:27], a[132:135], v[152:155]
v_mfma_f32_16x16x32_bf16 v[160:163], a[24:27], a[136:139], v[160:163]
v_mfma_f32_16x16x32_bf16 v[168:171], a[24:27], a[140:143], v[168:171]
v_mfma_f32_16x16x32_bf16 v[176:179], a[24:27], a[144:147], v[176:179]
v_mfma_f32_16x16x32_bf16 v[184:187], a[24:27], a[148:151], v[184:187]
buffer_load_dwordx4 v210, s[8:11], s31 offen offset:0  lds
v_mfma_f32_16x16x32_bf16 v[148:151], a[28:31], a[128:131], v[148:151]
v_mfma_f32_16x16x32_bf16 v[156:159], a[28:31], a[132:135], v[156:159]
v_mfma_f32_16x16x32_bf16 v[164:167], a[28:31], a[136:139], v[164:167]
v_mfma_f32_16x16x32_bf16 v[172:175], a[28:31], a[140:143], v[172:175]
buffer_load_dwordx4 v211, s[8:11], s31 offen offset:1024  lds
v_mfma_f32_16x16x32_bf16 v[180:183], a[28:31], a[144:147], v[180:183]
v_mfma_f32_16x16x32_bf16 v[188:191], a[28:31], a[148:151], v[188:191]
s_waitcnt lgkmcnt(0)
v_mfma_f32_16x16x32_bf16 v[0:3], a[32:35], a[152:155], v[0:3]
s_waitcnt vmcnt(14)
s_barrier
v_mfma_f32_16x16x32_bf16 v[8:11], a[32:35], a[156:159], v[8:11]
ds_read_b64_tr_b16 a[64:65], v200 offset:0
buffer_load_dwordx4 v212, s[8:11], s31 offen offset:2048  lds
v_mfma_f32_16x16x32_bf16 v[16:19], a[32:35], a[160:163], v[16:19]
ds_read_b64_tr_b16 a[68:69], v201 offset:0
v_mfma_f32_16x16x32_bf16 v[24:27], a[32:35], a[164:167], v[24:27]
ds_read_b64_tr_b16 a[72:73], v202 offset:0
v_mfma_f32_16x16x32_bf16 v[32:35], a[32:35], a[168:171], v[32:35]
ds_read_b64_tr_b16 a[76:77], v203 offset:0
v_mfma_f32_16x16x32_bf16 v[40:43], a[32:35], a[172:175], v[40:43]
ds_read_b64_tr_b16 a[80:81], v204 offset:0
buffer_load_dwordx4 v213, s[8:11], s31 offen offset:3072  lds
v_mfma_f32_16x16x32_bf16 v[4:7], a[36:39], a[152:155], v[4:7]
ds_read_b64_tr_b16 a[84:85], v205 offset:0
s_add_u32 s30, s30, 262144
v_mfma_f32_16x16x32_bf16 v[12:15], a[36:39], a[156:159], v[12:15]
ds_read_b64_tr_b16 a[88:89], v206 offset:0
s_add_u32 m0, s44, 0
v_mfma_f32_16x16x32_bf16 v[20:23], a[36:39], a[160:163], v[20:23]
ds_read_b64_tr_b16 a[92:93], v207 offset:0
s_nop 0
v_mfma_f32_16x16x32_bf16 v[28:31], a[36:39], a[164:167], v[28:31]
ds_read_b64_tr_b16 a[66:67], v200 offset:1024
buffer_load_dwordx4 v214, s[4:7], s29 offen offset:0  lds
v_mfma_f32_16x16x32_bf16 v[36:39], a[36:39], a[168:171], v[36:39]
ds_read_b64_tr_b16 a[70:71], v201 offset:1024
v_mfma_f32_16x16x32_bf16 v[44:47], a[36:39], a[172:175], v[44:47]
ds_read_b64_tr_b16 a[74:75], v202 offset:1024
v_mfma_f32_16x16x32_bf16 v[48:51], a[40:43], a[152:155], v[48:51]
ds_read_b64_tr_b16 a[78:79], v203 offset:1024
v_mfma_f32_16x16x32_bf16 v[56:59], a[40:43], a[156:159], v[56:59]
ds_read_b64_tr_b16 a[82:83], v204 offset:1024
v_mfma_f32_16x16x32_bf16 v[64:67], a[40:43], a[160:163], v[64:67]
ds_read_b64_tr_b16 a[86:87], v205 offset:1024
buffer_load_dwordx4 v215, s[4:7], s29 offen offset:1024  lds
v_mfma_f32_16x16x32_bf16 v[72:75], a[40:43], a[164:167], v[72:75]
ds_read_b64_tr_b16 a[90:91], v206 offset:1024
v_mfma_f32_16x16x32_bf16 v[80:83], a[40:43], a[168:171], v[80:83]
ds_read_b64_tr_b16 a[94:95], v207 offset:1024
v_mfma_f32_16x16x32_bf16 v[88:91], a[40:43], a[172:175], v[88:91]
ds_read_b128 a[176:179], v208 offset:12288
v_mfma_f32_16x16x32_bf16 v[52:55], a[44:47], a[152:155], v[52:55]
ds_read_b128 a[180:183], v208 offset:14336
buffer_load_dwordx4 v216, s[4:7], s29 offen offset:2048  lds
v_mfma_f32_16x16x32_bf16 v[60:63], a[44:47], a[156:159], v[60:63]
ds_read_b128 a[184:187], v208 offset:16384
s_add_u32 s29, s29, 128
v_mfma_f32_16x16x32_bf16 v[68:71], a[44:47], a[160:163], v[68:71]
ds_read_b128 a[188:191], v208 offset:18432
s_cmp_eq_u32 s29, s47
s_cselect_b32 s29, s73, s29
v_mfma_f32_16x16x32_bf16 v[76:79], a[44:47], a[164:167], v[76:79]
ds_read_b128 a[192:195], v208 offset:20480
s_add_u32 m0, s43, 32768
s_add_u32 s31, s30, 131072
v_mfma_f32_16x16x32_bf16 v[84:87], a[44:47], a[168:171], v[84:87]
ds_read_b128 a[196:199], v208 offset:22528
buffer_load_dwordx4 v210, s[8:11], s30 offen offset:0  lds
v_mfma_f32_16x16x32_bf16 v[92:95], a[44:47], a[172:175], v[92:95]
s_waitcnt vmcnt(12)
v_mfma_f32_16x16x32_bf16 v[96:99], a[48:51], a[152:155], v[96:99]
ds_read_b64_tr_b16 a[96:97], v200 offset:32768
v_mfma_f32_16x16x32_bf16 v[104:107], a[48:51], a[156:159], v[104:107]
ds_read_b64_tr_b16 a[100:101], v201 offset:32768
v_mfma_f32_16x16x32_bf16 v[112:115], a[48:51], a[160:163], v[112:115]
ds_read_b64_tr_b16 a[104:105], v202 offset:32768
buffer_load_dwordx4 v211, s[8:11], s30 offen offset:1024  lds
v_mfma_f32_16x16x32_bf16 v[120:123], a[48:51], a[164:167], v[120:123]
ds_read_b64_tr_b16 a[108:109], v203 offset:32768
v_mfma_f32_16x16x32_bf16 v[128:131], a[48:51], a[168:171], v[128:131]
ds_read_b64_tr_b16 a[112:113], v204 offset:32768
v_mfma_f32_16x16x32_bf16 v[136:139], a[48:51], a[172:175], v[136:139]
ds_read_b64_tr_b16 a[116:117], v205 offset:32768
v_mfma_f32_16x16x32_bf16 v[100:103], a[52:55], a[152:155], v[100:103]
ds_read_b64_tr_b16 a[120:121], v206 offset:32768
buffer_load_dwordx4 v212, s[8:11], s30 offen offset:2048  lds
v_mfma_f32_16x16x32_bf16 v[108:111], a[52:55], a[156:159], v[108:111]
ds_read_b64_tr_b16 a[124:125], v207 offset:32768
v_mfma_f32_16x16x32_bf16 v[116:119], a[52:55], a[160:163], v[116:119]
ds_read_b64_tr_b16 a[98:99], v200 offset:33792
v_mfma_f32_16x16x32_bf16 v[124:127], a[52:55], a[164:167], v[124:127]
ds_read_b64_tr_b16 a[102:103], v201 offset:33792
v_mfma_f32_16x16x32_bf16 v[132:135], a[52:55], a[168:171], v[132:135]
ds_read_b64_tr_b16 a[106:107], v202 offset:33792
v_mfma_f32_16x16x32_bf16 v[140:143], a[52:55], a[172:175], v[140:143]
ds_read_b64_tr_b16 a[110:111], v203 offset:33792
buffer_load_dwordx4 v213, s[8:11], s30 offen offset:3072  lds
v_mfma_f32_16x16x32_bf16 v[144:147], a[56:59], a[152:155], v[144:147]
ds_read_b64_tr_b16 a[114:115], v204 offset:33792
s_add_u32 m0, s43, 36864
v_mfma_f32_16x16x32_bf16 v[152:155], a[56:59], a[156:159], v[152:155]
ds_read_b64_tr_b16 a[118:119], v205 offset:33792
v_mfma_f32_16x16x32_bf16 v[160:163], a[56:59], a[160:163], v[160:163]
ds_read_b64_tr_b16 a[122:123], v206 offset:33792
v_mfma_f32_16x16x32_bf16 v[168:171], a[56:59], a[164:167], v[168:171]
ds_read_b64_tr_b16 a[126:127], v207 offset:33792
buffer_load_dwordx4 v210, s[8:11], s31 offen offset:0  lds
v_mfma_f32_16x16x32_bf16 v[176:179], a[56:59], a[168:171], v[176:179]
ds_read_b128 a[200:203], v209 offset:12288
v_mfma_f32_16x16x32_bf16 v[184:187], a[56:59], a[172:175], v[184:187]
ds_read_b128 a[204:207], v209 offset:14336
v_mfma_f32_16x16x32_bf16 v[148:151], a[60:63], a[152:155], v[148:151]
ds_read_b128 a[208:211], v209 offset:16384
v_mfma_f32_16x16x32_bf16 v[156:159], a[60:63], a[156:159], v[156:159]
ds_read_b128 a[212:215], v209 offset:18432
buffer_load_dwordx4 v211, s[8:11], s31 offen offset:1024  lds
v_mfma_f32_16x16x32_bf16 v[164:167], a[60:63], a[160:163], v[164:167]
ds_read_b128 a[216:219], v209 offset:20480
v_mfma_f32_16x16x32_bf16 v[172:175], a[60:63], a[164:167], v[172:175]
ds_read_b128 a[220:223], v209 offset:22528
v_mfma_f32_16x16x32_bf16 v[180:183], a[60:63], a[168:171], v[180:183]
v_mfma_f32_16x16x32_bf16 v[188:191], a[60:63], a[172:175], v[188:191]
buffer_load_dwordx4 v212, s[8:11], s31 offen offset:2048  lds
s_waitcnt lgkmcnt(0)
v_mfma_f32_16x16x32_bf16 v[0:3], a[64:67], a[176:179], v[0:3]
s_waitcnt vmcnt(7)
s_barrier
v_mfma_f32_16x16x32_bf16 v[0:3], a[96:99], a[200:203], v[0:3]
ds_read_b64_tr_b16 a[0:1], v192 offset:0
v_mfma_f32_16x16x32_bf16 v[8:11], a[64:67], a[180:183], v[8:11]
ds_read_b64_tr_b16 a[4:5], v193 offset:0
v_mfma_f32_16x16x32_bf16 v[8:11], a[96:99], a[204:207], v[8:11]
ds_read_b64_tr_b16 a[8:9], v194 offset:0
buffer_load_dwordx4 v213, s[8:11], s31 offen offset:3072  lds
v_mfma_f32_16x16x32_bf16 v[16:19], a[64:67], a[184:187], v[16:19]
ds_read_b64_tr_b16 a[12:13], v195 offset:0
s_add_u32 s30, s30, 262144
v_mfma_f32_16x16x32_bf16 v[16:19], a[96:99], a[208:211], v[16:19]
ds_read_b64_tr_b16 a[16:17], v196 offset:0
s_cmp_eq_u32 s30, s74
s_cselect_b32 s30, s75, s30
v_mfma_f32_16x16x32_bf16 v[24:27], a[64:67], a[188:191], v[24:27]
ds_read_b64_tr_b16 a[20:21], v197 offset:0
s_add_u32 m0, s44, 12288
v_mfma_f32_16x16x32_bf16 v[24:27], a[96:99], a[212:215], v[24:27]
ds_read_b64_tr_b16 a[24:25], v198 offset:0
s_nop 0
v_mfma_f32_16x16x32_bf16 v[32:35], a[64:67], a[192:195], v[32:35]
ds_read_b64_tr_b16 a[28:29], v199 offset:0
buffer_load_dwordx4 v214, s[4:7], s29 offen offset:0  lds
v_mfma_f32_16x16x32_bf16 v[32:35], a[96:99], a[216:219], v[32:35]
ds_read_b64_tr_b16 a[2:3], v192 offset:1024
v_mfma_f32_16x16x32_bf16 v[40:43], a[64:67], a[196:199], v[40:43]
ds_read_b64_tr_b16 a[6:7], v193 offset:1024
v_mfma_f32_16x16x32_bf16 v[40:43], a[96:99], a[220:223], v[40:43]
ds_read_b64_tr_b16 a[10:11], v194 offset:1024
v_mfma_f32_16x16x32_bf16 v[4:7], a[68:71], a[176:179], v[4:7]
ds_read_b64_tr_b16 a[14:15], v195 offset:1024
buffer_load_dwordx4 v215, s[4:7], s29 offen offset:1024  lds
v_mfma_f32_16x16x32_bf16 v[4:7], a[100:103], a[200:203], v[4:7]
ds_read_b64_tr_b16 a[18:19], v196 offset:1024
v_mfma_f32_16x16x32_bf16 v[12:15], a[68:71], a[180:183], v[12:15]
ds_read_b64_tr_b16 a[22:23], v197 offset:1024
v_mfma_f32_16x16x32_bf16 v[12:15], a[100:103], a[204:207], v[12:15]
ds_read_b64_tr_b16 a[26:27], v198 offset:1024
v_mfma_f32_16x16x32_bf16 v[20:23], a[68:71], a[184:187], v[20:23]
ds_read_b64_tr_b16 a[30:31], v199 offset:1024
buffer_load_dwordx4 v216, s[4:7], s29 offen offset:2048  lds
v_mfma_f32_16x16x32_bf16 v[20:23], a[100:103], a[208:211], v[20:23]
ds_read_b128 a[128:131], v208 offset:0
s_add_u32 s29, s29, 128
v_mfma_f32_16x16x32_bf16 v[28:31], a[68:71], a[188:191], v[28:31]
ds_read_b128 a[132:135], v208 offset:2048
s_cmp_eq_u32 s29, s47
s_cselect_b32 s29, s73, s29
v_mfma_f32_16x16x32_bf16 v[28:31], a[100:103], a[212:215], v[28:31]
ds_read_b128 a[136:139], v208 offset:4096
s_add_u32 m0, s43, 65536
s_add_u32 s31, s30, 131072
v_mfma_f32_16x16x32_bf16 v[36:39], a[68:71], a[192:195], v[36:39]
ds_read_b128 a[140:143], v208 offset:6144
buffer_load_dwordx4 v210, s[8:11], s30 offen offset:0  lds
v_mfma_f32_16x16x32_bf16 v[36:39], a[100:103], a[216:219], v[36:39]
ds_read_b128 a[144:147], v208 offset:8192
v_mfma_f32_16x16x32_bf16 v[44:47], a[68:71], a[196:199], v[44:47]
ds_read_b128 a[148:151], v208 offset:10240
v_mfma_f32_16x16x32_bf16 v[44:47], a[100:103], a[220:223], v[44:47]
v_mfma_f32_16x16x32_bf16 v[48:51], a[72:75], a[176:179], v[48:51]
buffer_load_dwordx4 v211, s[8:11], s30 offen offset:1024  lds
v_mfma_f32_16x16x32_bf16 v[48:51], a[104:107], a[200:203], v[48:51]
v_mfma_f32_16x16x32_bf16 v[56:59], a[72:75], a[180:183], v[56:59]
v_mfma_f32_16x16x32_bf16 v[56:59], a[104:107], a[204:207], v[56:59]
v_mfma_f32_16x16x32_bf16 v[64:67], a[72:75], a[184:187], v[64:67]
v_mfma_f32_16x16x32_bf16 v[64:67], a[104:107], a[208:211], v[64:67]
buffer_load_dwordx4 v212, s[8:11], s30 offen offset:2048  lds
v_mfma_f32_16x16x32_bf16 v[72:75], a[72:75], a[188:191], v[72:75]
v_mfma_f32_16x16x32_bf16 v[72:75], a[104:107], a[212:215], v[72:75]
v_mfma_f32_16x16x32_bf16 v[80:83], a[72:75], a[192:195], v[80:83]
v_mfma_f32_16x16x32_bf16 v[80:83], a[104:107], a[216:219], v[80:83]
buffer_load_dwordx4 v213, s[8:11], s30 offen offset:3072  lds
s_add_u32 m0, s43, 69632
v_mfma_f32_16x16x32_bf16 v[88:91], a[72:75], a[196:199], v[88:91]
v_mfma_f32_16x16x32_bf16 v[88:91], a[104:107], a[220:223], v[88:91]
v_mfma_f32_16x16x32_bf16 v[52:55], a[76:79], a[176:179], v[52:55]
v_mfma_f32_16x16x32_bf16 v[52:55], a[108:111], a[200:203], v[52:55]
buffer_load_dwordx4 v210, s[8:11], s31 offen offset:0  lds
v_mfma_f32_16x16x32_bf16 v[60:63], a[76:79], a[180:183], v[60:63]
v_mfma_f32_16x16x32_bf16 v[60:63], a[108:111], a[204:207], v[60:63]
v_mfma_f32_16x16x32_bf16 v[68:71], a[76:79], a[184:187], v[68:71]
v_mfma_f32_16x16x32_bf16 v[68:71], a[108:111], a[208:211], v[68:71]
buffer_load_dwordx4 v211, s[8:11], s31 offen offset:1024  lds
v_mfma_f32_16x16x32_bf16 v[76:79], a[76:79], a[188:191], v[76:79]
v_mfma_f32_16x16x32_bf16 v[76:79], a[108:111], a[212:215], v[76:79]
v_mfma_f32_16x16x32_bf16 v[84:87], a[76:79], a[192:195], v[84:87]
v_mfma_f32_16x16x32_bf16 v[84:87], a[108:111], a[216:219], v[84:87]
buffer_load_dwordx4 v212, s[8:11], s31 offen offset:2048  lds
v_mfma_f32_16x16x32_bf16 v[92:95], a[76:79], a[196:199], v[92:95]
v_mfma_f32_16x16x32_bf16 v[92:95], a[108:111], a[220:223], v[92:95]
v_mfma_f32_16x16x32_bf16 v[96:99], a[80:83], a[176:179], v[96:99]
s_waitcnt vmcnt(10)
v_mfma_f32_16x16x32_bf16 v[96:99], a[112:115], a[200:203], v[96:99]
ds_read_b64_tr_b16 a[32:33], v192 offset:32768
v_mfma_f32_16x16x32_bf16 v[104:107], a[80:83], a[180:183], v[104:107]
ds_read_b64_tr_b16 a[36:37], v193 offset:32768
buffer_load_dwordx4 v213, s[8:11], s31 offen offset:3072  lds
v_mfma_f32_16x16x32_bf16 v[104:107], a[112:115], a[204:207], v[104:107]
ds_read_b64_tr_b16 a[40:41], v194 offset:32768
s_add_u32 s30, s30, 262144
v_mfma_f32_16x16x32_bf16 v[112:115], a[80:83], a[184:187], v[112:115]
ds_read_b64_tr_b16 a[44:45], v195 offset:32768
s_add_u32 m0, s43, 98304
v_mfma_f32_16x16x32_bf16 v[112:115], a[112:115], a[208:211], v[112:115]
ds_read_b64_tr_b16 a[48:49], v196 offset:32768
s_add_u32 s31, s30, 131072
v_mfma_f32_16x16x32_bf16 v[120:123], a[80:83], a[188:191], v[120:123]
ds_read_b64_tr_b16 a[52:53], v197 offset:32768
buffer_load_dwordx4 v210, s[8:11], s30 offen offset:0  lds
v_mfma_f32_16x16x32_bf16 v[120:123], a[112:115], a[212:215], v[120:123]
ds_read_b64_tr_b16 a[56:57], v198 offset:32768
v_mfma_f32_16x16x32_bf16 v[128:131], a[80:83], a[192:195], v[128:131]
ds_read_b64_tr_b16 a[60:61], v199 offset:32768
v_mfma_f32_16x16x32_bf16 v[128:131], a[112:115], a[216:219], v[128:131]
ds_read_b64_tr_b16 a[34:35], v192 offset:33792
v_mfma_f32_16x16x32_bf16 v[136:139], a[80:83], a[196:199], v[136:139]
ds_read_b64_tr_b16 a[38:39], v193 offset:33792
buffer_load_dwordx4 v211, s[8:11], s30 offen offset:1024  lds
v_mfma_f32_16x16x32_bf16 v[136:139], a[112:115], a[220:223], v[136:139]
ds_read_b64_tr_b16 a[42:43], v194 offset:33792
v_mfma_f32_16x16x32_bf16 v[100:103], a[84:87], a[176:179], v[100:103]
ds_read_b64_tr_b16 a[46:47], v195 offset:33792
v_mfma_f32_16x16x32_bf16 v[100:103], a[116:119], a[200:203], v[100:103]
ds_read_b64_tr_b16 a[50:51], v196 offset:33792
v_mfma_f32_16x16x32_bf16 v[108:111], a[84:87], a[180:183], v[108:111]
ds_read_b64_tr_b16 a[54:55], v197 offset:33792
buffer_load_dwordx4 v212, s[8:11], s30 offen offset:2048  lds
v_mfma_f32_16x16x32_bf16 v[108:111], a[116:119], a[204:207], v[108:111]
ds_read_b64_tr_b16 a[58:59], v198 offset:33792
v_mfma_f32_16x16x32_bf16 v[116:119], a[84:87], a[184:187], v[116:119]
ds_read_b64_tr_b16 a[62:63], v199 offset:33792
v_mfma_f32_16x16x32_bf16 v[116:119], a[116:119], a[208:211], v[116:119]
ds_read_b128 a[152:155], v209 offset:0
v_mfma_f32_16x16x32_bf16 v[124:127], a[84:87], a[188:191], v[124:127]
ds_read_b128 a[156:159], v209 offset:2048
buffer_load_dwordx4 v213, s[8:11], s30 offen offset:3072  lds
v_mfma_f32_16x16x32_bf16 v[124:127], a[116:119], a[212:215], v[124:127]
ds_read_b128 a[160:163], v209 offset:4096
s_add_u32 m0, s43, 102400
v_mfma_f32_16x16x32_bf16 v[132:135], a[84:87], a[192:195], v[132:135]
ds_read_b128 a[164:167], v209 offset:6144
v_mfma_f32_16x16x32_bf16 v[132:135], a[116:119], a[216:219], v[132:135]
ds_read_b128 a[168:171], v209 offset:8192
v_mfma_f32_16x16x32_bf16 v[140:143], a[84:87], a[196:199], v[140:143]
ds_read_b128 a[172:175], v209 offset:10240
v_mfma_f32_16x16x32_bf16 v[140:143], a[116:119], a[220:223], v[140:143]
buffer_load_dwordx4 v210, s[8:11], s31 offen offset:0  lds
v_mfma_f32_16x16x32_bf16 v[144:147], a[88:91], a[176:179], v[144:147]
v_mfma_f32_16x16x32_bf16 v[144:147], a[120:123], a[200:203], v[144:147]
v_mfma_f32_16x16x32_bf16 v[152:155], a[88:91], a[180:183], v[152:155]
v_mfma_f32_16x16x32_bf16 v[152:155], a[120:123], a[204:207], v[152:155]
buffer_load_dwordx4 v211, s[8:11], s31 offen offset:1024  lds
v_mfma_f32_16x16x32_bf16 v[160:163], a[88:91], a[184:187], v[160:163]
v_mfma_f32_16x16x32_bf16 v[160:163], a[120:123], a[208:211], v[160:163]
v_mfma_f32_16x16x32_bf16 v[168:171], a[88:91], a[188:191], v[168:171]
v_mfma_f32_16x16x32_bf16 v[168:171], a[120:123], a[212:215], v[168:171]
buffer_load_dwordx4 v212, s[8:11], s31 offen offset:2048  lds
v_mfma_f32_16x16x32_bf16 v[176:179], a[88:91], a[192:195], v[176:179]
v_mfma_f32_16x16x32_bf16 v[176:179], a[120:123], a[216:219], v[176:179]
v_mfma_f32_16x16x32_bf16 v[184:187], a[88:91], a[196:199], v[184:187]
v_mfma_f32_16x16x32_bf16 v[184:187], a[120:123], a[220:223], v[184:187]
buffer_load_dwordx4 v213, s[8:11], s31 offen offset:3072  lds
s_add_u32 s30, s30, 262144
v_mfma_f32_16x16x32_bf16 v[148:151], a[92:95], a[176:179], v[148:151]
s_cmp_eq_u32 s30, s74
s_cselect_b32 s30, s75, s30
v_mfma_f32_16x16x32_bf16 v[148:151], a[124:127], a[200:203], v[148:151]
s_add_u32 m0, s43, 0
s_add_u32 s31, s30, 131072
v_mfma_f32_16x16x32_bf16 v[156:159], a[92:95], a[180:183], v[156:159]
v_mfma_f32_16x16x32_bf16 v[156:159], a[124:127], a[204:207], v[156:159]
s_waitcnt lgkmcnt(15)
buffer_load_dwordx4 v210, s[8:11], s30 offen offset:0  lds
v_mfma_f32_16x16x32_bf16 v[164:167], a[92:95], a[184:187], v[164:167]
v_mfma_f32_16x16x32_bf16 v[164:167], a[124:127], a[208:211], v[164:167]
v_mfma_f32_16x16x32_bf16 v[172:175], a[92:95], a[188:191], v[172:175]
v_mfma_f32_16x16x32_bf16 v[172:175], a[124:127], a[212:215], v[172:175]
v_mfma_f32_16x16x32_bf16 v[180:183], a[92:95], a[192:195], v[180:183]
buffer_load_dwordx4 v211, s[8:11], s30 offen offset:1024  lds
v_mfma_f32_16x16x32_bf16 v[180:183], a[124:127], a[216:219], v[180:183]
v_mfma_f32_16x16x32_bf16 v[188:191], a[92:95], a[196:199], v[188:191]
v_mfma_f32_16x16x32_bf16 v[188:191], a[124:127], a[220:223], v[188:191]
s_waitcnt lgkmcnt(0)
v_mfma_f32_16x16x32_bf16 v[0:3], a[0:3], a[128:131], v[0:3]
s_waitcnt vmcnt(18)
s_barrier
s_waitcnt vmcnt(10)
buffer_load_dwordx4 v212, s[8:11], s30 offen offset:2048  lds
v_mfma_f32_16x16x32_bf16 v[0:3], a[32:35], a[152:155], v[0:3]
ds_read_b64_tr_b16 a[64:65], v200 offset:0
v_mfma_f32_16x16x32_bf16 v[8:11], a[0:3], a[132:135], v[8:11]
ds_read_b64_tr_b16 a[68:69], v201 offset:0
v_mfma_f32_16x16x32_bf16 v[8:11], a[32:35], a[156:159], v[8:11]
ds_read_b64_tr_b16 a[72:73], v202 offset:0
v_mfma_f32_16x16x32_bf16 v[16:19], a[0:3], a[136:139], v[16:19]
ds_read_b64_tr_b16 a[76:77], v203 offset:0
buffer_load_dwordx4 v213, s[8:11], s30 offen offset:3072  lds
v_mfma_f32_16x16x32_bf16 v[16:19], a[32:35], a[160:163], v[16:19]
ds_read_b64_tr_b16 a[80:81], v204 offset:0
s_add_u32 m0, s43, 4096
v_mfma_f32_16x16x32_bf16 v[24:27], a[0:3], a[140:143], v[24:27]
ds_read_b64_tr_b16 a[84:85], v205 offset:0
v_mfma_f32_16x16x32_bf16 v[24:27], a[32:35], a[164:167], v[24:27]
ds_read_b64_tr_b16 a[88:89], v206 offset:0
v_mfma_f32_16x16x32_bf16 v[32:35], a[0:3], a[144:147], v[32:35]
ds_read_b64_tr_b16 a[92:93], v207 offset:0
buffer_load_dwordx4 v210, s[8:11], s31 offen offset:0  lds
v_mfma_f32_16x16x32_bf16 v[32:35], a[32:35], a[168:171], v[32:35]
ds_read_b64_tr_b16 a[66:67], v200 offset:1024
v_mfma_f32_16x16x32_bf16 v[40:43], a[0:3], a[148:151], v[40:43]
ds_read_b64_tr_b16 a[70:71], v201 offset:1024
v_mfma_f32_16x16x32_bf16 v[40:43], a[32:35], a[172:175], v[40:43]
ds_read_b64_tr_b16 a[74:75], v202 offset:1024
v_mfma_f32_16x16x32_bf16 v[4:7], a[4:7], a[128:131], v[4:7]
ds_read_b64_tr_b16 a[78:79], v203 offset:1024
buffer_load_dwordx4 v211, s[8:11], s31 offen offset:1024  lds
v_mfma_f32_16x16x32_bf16 v[4:7], a[36:39], a[152:155], v[4:7]
ds_read_b64_tr_b16 a[82:83], v204 offset:1024
v_mfma_f32_16x16x32_bf16 v[12:15], a[4:7], a[132:135], v[12:15]
ds_read_b64_tr_b16 a[86:87], v205 offset:1024
v_mfma_f32_16x16x32_bf16 v[12:15], a[36:39], a[156:159], v[12:15]
ds_read_b64_tr_b16 a[90:91], v206 offset:1024
v_mfma_f32_16x16x32_bf16 v[20:23], a[4:7], a[136:139], v[20:23]
ds_read_b64_tr_b16 a[94:95], v207 offset:1024
v_mfma_f32_16x16x32_bf16 v[20:23], a[36:39], a[160:163], v[20:23]
ds_read_b128 a[176:179], v208 offset:12288
buffer_load_dwordx4 v212, s[8:11], s31 offen offset:2048  lds
v_mfma_f32_16x16x32_bf16 v[28:31], a[4:7], a[140:143], v[28:31]
ds_read_b128 a[180:183], v208 offset:14336
v_mfma_f32_16x16x32_bf16 v[28:31], a[36:39], a[164:167], v[28:31]
ds_read_b128 a[184:187], v208 offset:16384
v_mfma_f32_16x16x32_bf16 v[36:39], a[4:7], a[144:147], v[36:39]
ds_read_b128 a[188:191], v208 offset:18432
v_mfma_f32_16x16x32_bf16 v[36:39], a[36:39], a[168:171], v[36:39]
ds_read_b128 a[192:195], v208 offset:20480
buffer_load_dwordx4 v213, s[8:11], s31 offen offset:3072  lds
v_mfma_f32_16x16x32_bf16 v[44:47], a[4:7], a[148:151], v[44:47]
ds_read_b128 a[196:199], v208 offset:22528
s_add_u32 s30, s30, 262144
v_mfma_f32_16x16x32_bf16 v[44:47], a[36:39], a[172:175], v[44:47]
s_add_u32 m0, s44, 0
s_nop 0
v_mfma_f32_16x16x32_bf16 v[48:51], a[8:11], a[128:131], v[48:51]
v_mfma_f32_16x16x32_bf16 v[48:51], a[40:43], a[152:155], v[48:51]
buffer_load_dwordx4 v214, s[4:7], s29 offen offset:0  lds
v_mfma_f32_16x16x32_bf16 v[56:59], a[8:11], a[132:135], v[56:59]
v_mfma_f32_16x16x32_bf16 v[56:59], a[40:43], a[156:159], v[56:59]
v_mfma_f32_16x16x32_bf16 v[64:67], a[8:11], a[136:139], v[64:67]
v_mfma_f32_16x16x32_bf16 v[64:67], a[40:43], a[160:163], v[64:67]
buffer_load_dwordx4 v215, s[4:7], s29 offen offset:1024  lds
v_mfma_f32_16x16x32_bf16 v[72:75], a[8:11], a[140:143], v[72:75]
v_mfma_f32_16x16x32_bf16 v[72:75], a[40:43], a[164:167], v[72:75]
v_mfma_f32_16x16x32_bf16 v[80:83], a[8:11], a[144:147], v[80:83]
v_mfma_f32_16x16x32_bf16 v[80:83], a[40:43], a[168:171], v[80:83]
buffer_load_dwordx4 v216, s[4:7], s29 offen offset:2048  lds
s_add_u32 s29, s29, 128
v_mfma_f32_16x16x32_bf16 v[88:91], a[8:11], a[148:151], v[88:91]
s_cmp_eq_u32 s29, s47
s_cselect_b32 s29, s73, s29
v_mfma_f32_16x16x32_bf16 v[88:91], a[40:43], a[172:175], v[88:91]
s_add_u32 m0, s43, 32768
s_add_u32 s31, s30, 131072
v_mfma_f32_16x16x32_bf16 v[52:55], a[12:15], a[128:131], v[52:55]
v_mfma_f32_16x16x32_bf16 v[52:55], a[44:47], a[152:155], v[52:55]
v_mfma_f32_16x16x32_bf16 v[60:63], a[12:15], a[132:135], v[60:63]
buffer_load_dwordx4 v210, s[8:11], s30 offen offset:0  lds
v_mfma_f32_16x16x32_bf16 v[60:63], a[44:47], a[156:159], v[60:63]
v_mfma_f32_16x16x32_bf16 v[68:71], a[12:15], a[136:139], v[68:71]
v_mfma_f32_16x16x32_bf16 v[68:71], a[44:47], a[160:163], v[68:71]
v_mfma_f32_16x16x32_bf16 v[76:79], a[12:15], a[140:143], v[76:79]
buffer_load_dwordx4 v211, s[8:11], s30 offen offset:1024  lds
v_mfma_f32_16x16x32_bf16 v[76:79], a[44:47], a[164:167], v[76:79]
v_mfma_f32_16x16x32_bf16 v[84:87], a[12:15], a[144:147], v[84:87]
v_mfma_f32_16x16x32_bf16 v[84:87], a[44:47], a[168:171], v[84:87]
v_mfma_f32_16x16x32_bf16 v[92:95], a[12:15], a[148:151], v[92:95]
buffer_load_dwordx4 v212, s[8:11], s30 offen offset:2048  lds
v_mfma_f32_16x16x32_bf16 v[92:95], a[44:47], a[172:175], v[92:95]
v_mfma_f32_16x16x32_bf16 v[96:99], a[16:19], a[128:131], v[96:99]
s_waitcnt vmcnt(14)
v_mfma_f32_16x16x32_bf16 v[96:99], a[48:51], a[152:155], v[96:99]
ds_read_b64_tr_b16 a[96:97], v200 offset:32768
v_mfma_f32_16x16x32_bf16 v[104:107], a[16:19], a[132:135], v[104:107]
ds_read_b64_tr_b16 a[100:101], v201 offset:32768
buffer_load_dwordx4 v213, s[8:11], s30 offen offset:3072  lds
v_mfma_f32_16x16x32_bf16 v[104:107], a[48:51], a[156:159], v[104:107]
ds_read_b64_tr_b16 a[104:105], v202 offset:32768
s_add_u32 m0, s43, 36864
v_mfma_f32_16x16x32_bf16 v[112:115], a[16:19], a[136:139], v[112:115]
ds_read_b64_tr_b16 a[108:109], v203 offset:32768
v_mfma_f32_16x16x32_bf16 v[112:115], a[48:51], a[160:163], v[112:115]
ds_read_b64_tr_b16 a[112:113], v204 offset:32768
v_mfma_f32_16x16x32_bf16 v[120:123], a[16:19], a[140:143], v[120:123]
ds_read_b64_tr_b16 a[116:117], v205 offset:32768
buffer_load_dwordx4 v210, s[8:11], s31 offen offset:0  lds
v_mfma_f32_16x16x32_bf16 v[120:123], a[48:51], a[164:167], v[120:123]
ds_read_b64_tr_b16 a[120:121], v206 offset:32768
v_mfma_f32_16x16x32_bf16 v[128:131], a[16:19], a[144:147], v[128:131]
ds_read_b64_tr_b16 a[124:125], v207 offset:32768
v_mfma_f32_16x16x32_bf16 v[128:131], a[48:51], a[168:171], v[128:131]
ds_read_b64_tr_b16 a[98:99], v200 offset:33792
v_mfma_f32_16x16x32_bf16 v[136:139], a[16:19], a[148:151], v[136:139]
ds_read_b64_tr_b16 a[102:103], v201 offset:33792
v_mfma_f32_16x16x32_bf16 v[136:139], a[48:51], a[172:175], v[136:139]
ds_read_b64_tr_b16 a[106:107], v202 offset:33792
buffer_load_dwordx4 v211, s[8:11], s31 offen offset:1024  lds
v_mfma_f32_16x16x32_bf16 v[100:103], a[20:23], a[128:131], v[100:103]
ds_read_b64_tr_b16 a[110:111], v203 offset:33792
v_mfma_f32_16x16x32_bf16 v[100:103], a[52:55], a[152:155], v[100:103]
ds_read_b64_tr_b16 a[114:115], v204 offset:33792
v_mfma_f32_16x16x32_bf16 v[108:111], a[20:23], a[132:135], v[108:111]
ds_read_b64_tr_b16 a[118:119], v205 offset:33792
v_mfma_f32_16x16x32_bf16 v[108:111], a[52:55], a[156:159], v[108:111]
ds_read_b64_tr_b16 a[122:123], v206 offset:33792
buffer_load_dwordx4 v212, s[8:11], s31 offen offset:2048  lds
v_mfma_f32_16x16x32_bf16 v[116:119], a[20:23], a[136:139], v[116:119]
ds_read_b64_tr_b16 a[126:127], v207 offset:33792
v_mfma_f32_16x16x32_bf16 v[116:119], a[52:55], a[160:163], v[116:119]
ds_read_b128 a[200:203], v209 offset:12288
v_mfma_f32_16x16x32_bf16 v[124:127], a[20:23], a[140:143], v[124:127]
ds_read_b128 a[204:207], v209 offset:14336
v_mfma_f32_16x16x32_bf16 v[124:127], a[52:55], a[164:167], v[124:127]
ds_read_b128 a[208:211], v209 offset:16384
buffer_load_dwordx4 v213, s[8:11], s31 offen offset:3072  lds
v_mfma_f32_16x16x32_bf16 v[132:135], a[20:23], a[144:147], v[132:135]
ds_read_b128 a[212:215], v209 offset:18432
s_add_u32 s30, s30, 262144
v_mfma_f32_16x16x32_bf16 v[132:135], a[52:55], a[168:171], v[132:135]
ds_read_b128 a[216:219], v209 offset:20480
s_cmp_eq_u32 s30, s74
s_cselect_b32 s30, s75, s30
v_mfma_f32_16x16x32_bf16 v[140:143], a[20:23], a[148:151], v[140:143]
ds_read_b128 a[220:223], v209 offset:22528
s_add_u32 m0, s43, 65536
s_add_u32 s31, s30, 131072
v_mfma_f32_16x16x32_bf16 v[140:143], a[52:55], a[172:175], v[140:143]
s_waitcnt lgkmcnt(15)
buffer_load_dwordx4 v210, s[8:11], s30 offen offset:0  lds
v_mfma_f32_16x16x32_bf16 v[144:147], a[24:27], a[128:131], v[144:147]
v_mfma_f32_16x16x32_bf16 v[144:147], a[56:59], a[152:155], v[144:147]
v_mfma_f32_16x16x32_bf16 v[152:155], a[24:27], a[132:135], v[152:155]
v_mfma_f32_16x16x32_bf16 v[152:155], a[56:59], a[156:159], v[152:155]
buffer_load_dwordx4 v211, s[8:11], s30 offen offset:1024  lds
v_mfma_f32_16x16x32_bf16 v[160:163], a[24:27], a[136:139], v[160:163]
v_mfma_f32_16x16x32_bf16 v[160:163], a[56:59], a[160:163], v[160:163]
v_mfma_f32_16x16x32_bf16 v[168:171], a[24:27], a[140:143], v[168:171]
v_mfma_f32_16x16x32_bf16 v[168:171], a[56:59], a[164:167], v[168:171]
v_mfma_f32_16x16x32_bf16 v[176:179], a[24:27], a[144:147], v[176:179]
buffer_load_dwordx4 v212, s[8:11], s30 offen offset:2048  lds
v_mfma_f32_16x16x32_bf16 v[176:179], a[56:59], a[168:171], v[176:179]
v_mfma_f32_16x16x32_bf16 v[184:187], a[24:27], a[148:151], v[184:187]
v_mfma_f32_16x16x32_bf16 v[184:187], a[56:59], a[172:175], v[184:187]
v_mfma_f32_16x16x32_bf16 v[148:151], a[28:31], a[128:131], v[148:151]
buffer_load_dwordx4 v213, s[8:11], s30 offen offset:3072  lds
s_add_u32 m0, s43, 69632
v_mfma_f32_16x16x32_bf16 v[148:151], a[60:63], a[152:155], v[148:151]
v_mfma_f32_16x16x32_bf16 v[156:159], a[28:31], a[132:135], v[156:159]
v_mfma_f32_16x16x32_bf16 v[156:159], a[60:63], a[156:159], v[156:159]
v_mfma_f32_16x16x32_bf16 v[164:167], a[28:31], a[136:139], v[164:167]
buffer_load_dwordx4 v210, s[8:11], s31 offen offset:0  lds
v_mfma_f32_16x16x32_bf16 v[164:167], a[60:63], a[160:163], v[164:167]
v_mfma_f32_16x16x32_bf16 v[172:175], a[28:31], a[140:143], v[172:175]
v_mfma_f32_16x16x32_bf16 v[172:175], a[60:63], a[164:167], v[172:175]
v_mfma_f32_16x16x32_bf16 v[180:183], a[28:31], a[144:147], v[180:183]
buffer_load_dwordx4 v211, s[8:11], s31 offen offset:1024  lds
v_mfma_f32_16x16x32_bf16 v[180:183], a[60:63], a[168:171], v[180:183]
v_mfma_f32_16x16x32_bf16 v[188:191], a[28:31], a[148:151], v[188:191]
v_mfma_f32_16x16x32_bf16 v[188:191], a[60:63], a[172:175], v[188:191]
s_waitcnt lgkmcnt(0)
v_mfma_f32_16x16x32_bf16 v[0:3], a[64:67], a[176:179], v[0:3]
s_waitcnt vmcnt(14)
s_barrier
buffer_load_dwordx4 v212, s[8:11], s31 offen offset:2048  lds
v_mfma_f32_16x16x32_bf16 v[0:3], a[96:99], a[200:203], v[0:3]
ds_read_b64_tr_b16 a[0:1], v192 offset:0
v_mfma_f32_16x16x32_bf16 v[8:11], a[64:67], a[180:183], v[8:11]
ds_read_b64_tr_b16 a[4:5], v193 offset:0
v_mfma_f32_16x16x32_bf16 v[8:11], a[96:99], a[204:207], v[8:11]
ds_read_b64_tr_b16 a[8:9], v194 offset:0
v_mfma_f32_16x16x32_bf16 v[16:19], a[64:67], a[184:187], v[16:19]
ds_read_b64_tr_b16 a[12:13], v195 offset:0
v_mfma_f32_16x16x32_bf16 v[16:19], a[96:99], a[208:211], v[16:19]
ds_read_b64_tr_b16 a[16:17], v196 offset:0
buffer_load_dwordx4 v213, s[8:11], s31 offen offset:3072  lds
v_mfma_f32_16x16x32_bf16 v[24:27], a[64:67], a[188:191], v[24:27]
ds_read_b64_tr_b16 a[20:21], v197 offset:0
s_add_u32 s30, s30, 262144
v_mfma_f32_16x16x32_bf16 v[24:27], a[96:99], a[212:215], v[24:27]
ds_read_b64_tr_b16 a[24:25], v198 offset:0
s_add_u32 m0, s44, 12288
v_mfma_f32_16x16x32_bf16 v[32:35], a[64:67], a[192:195], v[32:35]
ds_read_b64_tr_b16 a[28:29], v199 offset:0
s_nop 0
v_mfma_f32_16x16x32_bf16 v[32:35], a[96:99], a[216:219], v[32:35]
ds_read_b64_tr_b16 a[2:3], v192 offset:1024
buffer_load_dwordx4 v214, s[4:7], s29 offen offset:0  lds
v_mfma_f32_16x16x32_bf16 v[40:43], a[64:67], a[196:199], v[40:43]
ds_read_b64_tr_b16 a[6:7], v193 offset:1024
v_mfma_f32_16x16x32_bf16 v[40:43], a[96:99], a[220:223], v[40:43]
ds_read_b64_tr_b16 a[10:11], v194 offset:1024
v_mfma_f32_16x16x32_bf16 v[4:7], a[68:71], a[176:179], v[4:7]
ds_read_b64_tr_b16 a[14:15], v195 offset:1024
v_mfma_f32_16x16x32_bf16 v[4:7], a[100:103], a[200:203], v[4:7]
ds_read_b64_tr_b16 a[18:19], v196 offset:1024
buffer_load_dwordx4 v215, s[4:7], s29 offen offset:1024  lds
v_mfma_f32_16x16x32_bf16 v[12:15], a[68:71], a[180:183], v[12:15]
ds_read_b64_tr_b16 a[22:23], v197 offset:1024
v_mfma_f32_16x16x32_bf16 v[12:15], a[100:103], a[204:207], v[12:15]
ds_read_b64_tr_b16 a[26:27], v198 offset:1024
v_mfma_f32_16x16x32_bf16 v[20:23], a[68:71], a[184:187], v[20:23]
ds_read_b64_tr_b16 a[30:31], v199 offset:1024
v_mfma_f32_16x16x32_bf16 v[20:23], a[100:103], a[208:211], v[20:23]
ds_read_b128 a[128:131], v208 offset:0
buffer_load_dwordx4 v216, s[4:7], s29 offen offset:2048  lds
v_mfma_f32_16x16x32_bf16 v[28:31], a[68:71], a[188:191], v[28:31]
ds_read_b128 a[132:135], v208 offset:2048
s_add_u32 s29, s29, 128
v_mfma_f32_16x16x32_bf16 v[28:31], a[100:103], a[212:215], v[28:31]
ds_read_b128 a[136:139], v208 offset:4096
s_cmp_eq_u32 s29, s47
s_cselect_b32 s29, s73, s29
v_mfma_f32_16x16x32_bf16 v[36:39], a[68:71], a[192:195], v[36:39]
ds_read_b128 a[140:143], v208 offset:6144
s_add_u32 m0, s43, 98304
s_add_u32 s31, s30, 131072
v_mfma_f32_16x16x32_bf16 v[36:39], a[100:103], a[216:219], v[36:39]
ds_read_b128 a[144:147], v208 offset:8192
buffer_load_dwordx4 v210, s[8:11], s30 offen offset:0  lds
v_mfma_f32_16x16x32_bf16 v[44:47], a[68:71], a[196:199], v[44:47]
ds_read_b128 a[148:151], v208 offset:10240
v_mfma_f32_16x16x32_bf16 v[44:47], a[100:103], a[220:223], v[44:47]
v_mfma_f32_16x16x32_bf16 v[48:51], a[72:75], a[176:179], v[48:51]
v_mfma_f32_16x16x32_bf16 v[48:51], a[104:107], a[200:203], v[48:51]
v_mfma_f32_16x16x32_bf16 v[56:59], a[72:75], a[180:183], v[56:59]
buffer_load_dwordx4 v211, s[8:11], s30 offen offset:1024  lds
v_mfma_f32_16x16x32_bf16 v[56:59], a[104:107], a[204:207], v[56:59]
v_mfma_f32_16x16x32_bf16 v[64:67], a[72:75], a[184:187], v[64:67]
v_mfma_f32_16x16x32_bf16 v[64:67], a[104:107], a[208:211], v[64:67]
v_mfma_f32_16x16x32_bf16 v[72:75], a[72:75], a[188:191], v[72:75]
buffer_load_dwordx4 v212, s[8:11], s30 offen offset:2048  lds
v_mfma_f32_16x16x32_bf16 v[72:75], a[104:107], a[212:215], v[72:75]
v_mfma_f32_16x16x32_bf16 v[80:83], a[72:75], a[192:195], v[80:83]
v_mfma_f32_16x16x32_bf16 v[80:83], a[104:107], a[216:219], v[80:83]
v_mfma_f32_16x16x32_bf16 v[88:91], a[72:75], a[196:199], v[88:91]
buffer_load_dwordx4 v213, s[8:11], s30 offen offset:3072  lds
s_add_u32 m0, s43, 102400
v_mfma_f32_16x16x32_bf16 v[88:91], a[104:107], a[220:223], v[88:91]
v_mfma_f32_16x16x32_bf16 v[52:55], a[76:79], a[176:179], v[52:55]
v_mfma_f32_16x16x32_bf16 v[52:55], a[108:111], a[200:203], v[52:55]
v_mfma_f32_16x16x32_bf16 v[60:63], a[76:79], a[180:183], v[60:63]
buffer_load_dwordx4 v210, s[8:11], s31 offen offset:0  lds
v_mfma_f32_16x16x32_bf16 v[60:63], a[108:111], a[204:207], v[60:63]
v_mfma_f32_16x16x32_bf16 v[68:71], a[76:79], a[184:187], v[68:71]
v_mfma_f32_16x16x32_bf16 v[68:71], a[108:111], a[208:211], v[68:71]
v_mfma_f32_16x16x32_bf16 v[76:79], a[76:79], a[188:191], v[76:79]
buffer_load_dwordx4 v211, s[8:11], s31 offen offset:1024  lds
v_mfma_f32_16x16x32_bf16 v[76:79], a[108:111], a[212:215], v[76:79]
v_mfma_f32_16x16x32_bf16 v[84:87], a[76:79], a[192:195], v[84:87]
v_mfma_f32_16x16x32_bf16 v[84:87], a[108:111], a[216:219], v[84:87]
v_mfma_f32_16x16x32_bf16 v[92:95], a[76:79], a[196:199], v[92:95]
v_mfma_f32_16x16x32_bf16 v[92:95], a[108:111], a[220:223], v[92:95]
buffer_load_dwordx4 v212, s[8:11], s31 offen offset:2048  lds
v_mfma_f32_16x16x32_bf16 v[96:99], a[80:83], a[176:179], v[96:99]
s_waitcnt vmcnt(18)
v_mfma_f32_16x16x32_bf16 v[96:99], a[112:115], a[200:203], v[96:99]
ds_read_b64_tr_b16 a[32:33], v192 offset:32768
v_mfma_f32_16x16x32_bf16 v[104:107], a[80:83], a[180:183], v[104:107]
ds_read_b64_tr_b16 a[36:37], v193 offset:32768
v_mfma_f32_16x16x32_bf16 v[104:107], a[112:115], a[204:207], v[104:107]
ds_read_b64_tr_b16 a[40:41], v194 offset:32768
buffer_load_dwordx4 v213, s[8:11], s31 offen offset:3072  lds
v_mfma_f32_16x16x32_bf16 v[112:115], a[80:83], a[184:187], v[112:115]
ds_read_b64_tr_b16 a[44:45], v195 offset:32768
s_add_u32 s30, s30, 262144
v_mfma_f32_16x16x32_bf16 v[112:115], a[112:115], a[208:211], v[112:115]
ds_read_b64_tr_b16 a[48:49], v196 offset:32768
s_cmp_eq_u32 s30, s74
s_cselect_b32 s30, s75, s30
v_mfma_f32_16x16x32_bf16 v[120:123], a[80:83], a[188:191], v[120:123]
ds_read_b64_tr_b16 a[52:53], v197 offset:32768
s_add_u32 m0, s43, 0
s_add_u32 s31, s30, 131072
v_mfma_f32_16x16x32_bf16 v[120:123], a[112:115], a[212:215], v[120:123]
ds_read_b64_tr_b16 a[56:57], v198 offset:32768
s_waitcnt lgkmcnt(13)
buffer_load_dwordx4 v210, s[8:11], s30 offen offset:0  lds
v_mfma_f32_16x16x32_bf16 v[128:131], a[80:83], a[192:195], v[128:131]
ds_read_b64_tr_b16 a[60:61], v199 offset:32768
v_mfma_f32_16x16x32_bf16 v[128:131], a[112:115], a[216:219], v[128:131]
ds_read_b64_tr_b16 a[34:35], v192 offset:33792
v_mfma_f32_16x16x32_bf16 v[136:139], a[80:83], a[196:199], v[136:139]
ds_read_b64_tr_b16 a[38:39], v193 offset:33792
v_mfma_f32_16x16x32_bf16 v[136:139], a[112:115], a[220:223], v[136:139]
ds_read_b64_tr_b16 a[42:43], v194 offset:33792
buffer_load_dwordx4 v211, s[8:11], s30 offen offset:1024  lds
v_mfma_f32_16x16x32_bf16 v[100:103], a[84:87], a[176:179], v[100:103]
ds_read_b64_tr_b16 a[46:47], v195 offset:33792
v_mfma_f32_16x16x32_bf16 v[100:103], a[116:119], a[200:203], v[100:103]
ds_read_b64_tr_b16 a[50:51], v196 offset:33792
v_mfma_f32_16x16x32_bf16 v[108:111], a[84:87], a[180:183], v[108:111]
ds_read_b64_tr_b16 a[54:55], v197 offset:33792
v_mfma_f32_16x16x32_bf16 v[108:111], a[116:119], a[204:207], v[108:111]
ds_read_b64_tr_b16 a[58:59], v198 offset:33792
buffer_load_dwordx4 v212, s[8:11], s30 offen offset:2048  lds
v_mfma_f32_16x16x32_bf16 v[116:119], a[84:87], a[184:187], v[116:119]
ds_read_b64_tr_b16 a[62:63], v199 offset:33792
v_mfma_f32_16x16x32_bf16 v[116:119], a[116:119], a[208:211], v[116:119]
ds_read_b128 a[152:155], v209 offset:0
v_mfma_f32_16x16x32_bf16 v[124:127], a[84:87], a[188:191], v[124:127]
ds_read_b128 a[156:159], v209 offset:2048
v_mfma_f32_16x16x32_bf16 v[124:127], a[116:119], a[212:215], v[124:127]
ds_read_b128 a[160:163], v209 offset:4096
v_mfma_f32_16x16x32_bf16 v[132:135], a[84:87], a[192:195], v[132:135]
ds_read_b128 a[164:167], v209 offset:6144
buffer_load_dwordx4 v213, s[8:11], s30 offen offset:3072  lds
v_mfma_f32_16x16x32_bf16 v[132:135], a[116:119], a[216:219], v[132:135]
ds_read_b128 a[168:171], v209 offset:8192
s_add_u32 m0, s43, 4096
v_mfma_f32_16x16x32_bf16 v[140:143], a[84:87], a[196:199], v[140:143]
ds_read_b128 a[172:175], v209 offset:10240
v_mfma_f32_16x16x32_bf16 v[140:143], a[116:119], a[220:223], v[140:143]
v_mfma_f32_16x16x32_bf16 v[144:147], a[88:91], a[176:179], v[144:147]
buffer_load_dwordx4 v210, s[8:11], s31 offen offset:0  lds
v_mfma_f32_16x16x32_bf16 v[144:147], a[120:123], a[200:203], v[144:147]
v_mfma_f32_16x16x32_bf16 v[152:155], a[88:91], a[180:183], v[152:155]
v_mfma_f32_16x16x32_bf16 v[152:155], a[120:123], a[204:207], v[152:155]
v_mfma_f32_16x16x32_bf16 v[160:163], a[88:91], a[184:187], v[160:163]
buffer_load_dwordx4 v211, s[8:11], s31 offen offset:1024  lds
v_mfma_f32_16x16x32_bf16 v[160:163], a[120:123], a[208:211], v[160:163]
v_mfma_f32_16x16x32_bf16 v[168:171], a[88:91], a[188:191], v[168:171]
v_mfma_f32_16x16x32_bf16 v[168:171], a[120:123], a[212:215], v[168:171]
v_mfma_f32_16x16x32_bf16 v[176:179], a[88:91], a[192:195], v[176:179]
buffer_load_dwordx4 v212, s[8:11], s31 offen offset:2048  lds
v_mfma_f32_16x16x32_bf16 v[176:179], a[120:123], a[216:219], v[176:179]
v_mfma_f32_16x16x32_bf16 v[184:187], a[88:91], a[196:199], v[184:187]
v_mfma_f32_16x16x32_bf16 v[184:187], a[120:123], a[220:223], v[184:187]
v_mfma_f32_16x16x32_bf16 v[148:151], a[92:95], a[176:179], v[148:151]
buffer_load_dwordx4 v213, s[8:11], s31 offen offset:3072  lds
s_add_u32 s30, s30, 262144
v_mfma_f32_16x16x32_bf16 v[148:151], a[124:127], a[200:203], v[148:151]
s_add_u32 m0, s43, 32768
s_add_u32 s31, s30, 131072
v_mfma_f32_16x16x32_bf16 v[156:159], a[92:95], a[180:183], v[156:159]
v_mfma_f32_16x16x32_bf16 v[156:159], a[124:127], a[204:207], v[156:159]
v_mfma_f32_16x16x32_bf16 v[164:167], a[92:95], a[184:187], v[164:167]
v_mfma_f32_16x16x32_bf16 v[164:167], a[124:127], a[208:211], v[164:167]
s_waitcnt lgkmcnt(6)
buffer_load_dwordx4 v210, s[8:11], s30 offen offset:0  lds
v_mfma_f32_16x16x32_bf16 v[172:175], a[92:95], a[188:191], v[172:175]
v_mfma_f32_16x16x32_bf16 v[172:175], a[124:127], a[212:215], v[172:175]
v_mfma_f32_16x16x32_bf16 v[180:183], a[92:95], a[192:195], v[180:183]
v_mfma_f32_16x16x32_bf16 v[180:183], a[124:127], a[216:219], v[180:183]
buffer_load_dwordx4 v211, s[8:11], s30 offen offset:1024  lds
v_mfma_f32_16x16x32_bf16 v[188:191], a[92:95], a[196:199], v[188:191]
v_mfma_f32_16x16x32_bf16 v[188:191], a[124:127], a[220:223], v[188:191]
s_waitcnt lgkmcnt(0)
v_mfma_f32_16x16x32_bf16 v[0:3], a[0:3], a[128:131], v[0:3]
s_waitcnt vmcnt(18)
s_barrier
v_mfma_f32_16x16x32_bf16 v[0:3], a[32:35], a[152:155], v[0:3]
ds_read_b64_tr_b16 a[64:65], v200 offset:0
buffer_load_dwordx4 v212, s[8:11], s30 offen offset:2048  lds
v_mfma_f32_16x16x32_bf16 v[8:11], a[0:3], a[132:135], v[8:11]
ds_read_b64_tr_b16 a[68:69], v201 offset:0
v_mfma_f32_16x16x32_bf16 v[8:11], a[32:35], a[156:159], v[8:11]
ds_read_b64_tr_b16 a[72:73], v202 offset:0
v_mfma_f32_16x16x32_bf16 v[16:19], a[0:3], a[136:139], v[16:19]
ds_read_b64_tr_b16 a[76:77], v203 offset:0
v_mfma_f32_16x16x32_bf16 v[16:19], a[32:35], a[160:163], v[16:19]
ds_read_b64_tr_b16 a[80:81], v204 offset:0
buffer_load_dwordx4 v213, s[8:11], s30 offen offset:3072  lds
v_mfma_f32_16x16x32_bf16 v[24:27], a[0:3], a[140:143], v[24:27]
ds_read_b64_tr_b16 a[84:85], v205 offset:0
s_add_u32 m0, s43, 36864
v_mfma_f32_16x16x32_bf16 v[24:27], a[32:35], a[164:167], v[24:27]
ds_read_b64_tr_b16 a[88:89], v206 offset:0
v_mfma_f32_16x16x32_bf16 v[32:35], a[0:3], a[144:147], v[32:35]
ds_read_b64_tr_b16 a[92:93], v207 offset:0
v_mfma_f32_16x16x32_bf16 v[32:35], a[32:35], a[168:171], v[32:35]
ds_read_b64_tr_b16 a[66:67], v200 offset:1024
buffer_load_dwordx4 v210, s[8:11], s31 offen offset:0  lds
v_mfma_f32_16x16x32_bf16 v[40:43], a[0:3], a[148:151], v[40:43]
ds_read_b64_tr_b16 a[70:71], v201 offset:1024
v_mfma_f32_16x16x32_bf16 v[40:43], a[32:35], a[172:175], v[40:43]
ds_read_b64_tr_b16 a[74:75], v202 offset:1024
v_mfma_f32_16x16x32_bf16 v[4:7], a[4:7], a[128:131], v[4:7]
ds_read_b64_tr_b16 a[78:79], v203 offset:1024
v_mfma_f32_16x16x32_bf16 v[4:7], a[36:39], a[152:155], v[4:7]
ds_read_b64_tr_b16 a[82:83], v204 offset:1024
v_mfma_f32_16x16x32_bf16 v[12:15], a[4:7], a[132:135], v[12:15]
ds_read_b64_tr_b16 a[86:87], v205 offset:1024
buffer_load_dwordx4 v211, s[8:11], s31 offen offset:1024  lds
v_mfma_f32_16x16x32_bf16 v[12:15], a[36:39], a[156:159], v[12:15]
ds_read_b64_tr_b16 a[90:91], v206 offset:1024
v_mfma_f32_16x16x32_bf16 v[20:23], a[4:7], a[136:139], v[20:23]
ds_read_b64_tr_b16 a[94:95], v207 offset:1024
v_mfma_f32_16x16x32_bf16 v[20:23], a[36:39], a[160:163], v[20:23]
ds_read_b128 a[176:179], v208 offset:12288
v_mfma_f32_16x16x32_bf16 v[28:31], a[4:7], a[140:143], v[28:31]
ds_read_b128 a[180:183], v208 offset:14336
buffer_load_dwordx4 v212, s[8:11], s31 offen offset:2048  lds
v_mfma_f32_16x16x32_bf16 v[28:31], a[36:39], a[164:167], v[28:31]
ds_read_b128 a[184:187], v208 offset:16384
v_mfma_f32_16x16x32_bf16 v[36:39], a[4:7], a[144:147], v[36:39]
ds_read_b128 a[188:191], v208 offset:18432
v_mfma_f32_16x16x32_bf16 v[36:39], a[36:39], a[168:171], v[36:39]
ds_read_b128 a[192:195], v208 offset:20480
v_mfma_f32_16x16x32_bf16 v[44:47], a[4:7], a[148:151], v[44:47]
ds_read_b128 a[196:199], v208 offset:22528
buffer_load_dwordx4 v213, s[8:11], s31 offen offset:3072  lds
v_mfma_f32_16x16x32_bf16 v[44:47], a[36:39], a[172:175], v[44:47]
s_add_u32 s30, s30, 262144
v_mfma_f32_16x16x32_bf16 v[48:51], a[8:11], a[128:131], v[48:51]
s_cmp_eq_u32 s30, s74
s_cselect_b32 s30, s75, s30
v_mfma_f32_16x16x32_bf16 v[48:51], a[40:43], a[152:155], v[48:51]
s_add_u32 m0, s44, 0
s_nop 0
v_mfma_f32_16x16x32_bf16 v[56:59], a[8:11], a[132:135], v[56:59]
buffer_load_dwordx4 v214, s[4:7], s29 offen offset:0  lds
v_mfma_f32_16x16x32_bf16 v[56:59], a[40:43], a[156:159], v[56:59]
v_mfma_f32_16x16x32_bf16 v[64:67], a[8:11], a[136:139], v[64:67]
v_mfma_f32_16x16x32_bf16 v[64:67], a[40:43], a[160:163], v[64:67]
v_mfma_f32_16x16x32_bf16 v[72:75], a[8:11], a[140:143], v[72:75]
v_mfma_f32_16x16x32_bf16 v[72:75], a[40:43], a[164:167], v[72:75]
buffer_load_dwordx4 v215, s[4:7], s29 offen offset:1024  lds
v_mfma_f32_16x16x32_bf16 v[80:83], a[8:11], a[144:147], v[80:83]
v_mfma_f32_16x16x32_bf16 v[80:83], a[40:43], a[168:171], v[80:83]
v_mfma_f32_16x16x32_bf16 v[88:91], a[8:11], a[148:151], v[88:91]
v_mfma_f32_16x16x32_bf16 v[88:91], a[40:43], a[172:175], v[88:91]
buffer_load_dwordx4 v216, s[4:7], s29 offen offset:2048  lds
s_add_u32 s29, s29, 128
v_mfma_f32_16x16x32_bf16 v[52:55], a[12:15], a[128:131], v[52:55]
s_cmp_eq_u32 s29, s47
s_cselect_b32 s29, s73, s29
v_mfma_f32_16x16x32_bf16 v[52:55], a[44:47], a[152:155], v[52:55]
s_add_u32 m0, s43, 65536
s_mov_b32 s34, s45
v_mfma_f32_16x16x32_bf16 v[60:63], a[12:15], a[132:135], v[60:63]
v_mfma_f32_16x16x32_bf16 v[60:63], a[44:47], a[156:159], v[60:63]
v_mfma_f32_16x16x32_bf16 v[68:71], a[12:15], a[136:139], v[68:71]
v_mfma_f32_16x16x32_bf16 v[68:71], a[44:47], a[160:163], v[68:71]
s_waitcnt lgkmcnt(6)
buffer_load_dwordx4 v217, s[16:19], s34 offen offset:0 nt lds
v_mfma_f32_16x16x32_bf16 v[76:79], a[12:15], a[140:143], v[76:79]
v_mfma_f32_16x16x32_bf16 v[76:79], a[44:47], a[164:167], v[76:79]
v_mfma_f32_16x16x32_bf16 v[84:87], a[12:15], a[144:147], v[84:87]
v_mfma_f32_16x16x32_bf16 v[84:87], a[44:47], a[168:171], v[84:87]
v_mfma_f32_16x16x32_bf16 v[92:95], a[12:15], a[148:151], v[92:95]
v_mfma_f32_16x16x32_bf16 v[92:95], a[44:47], a[172:175], v[92:95]
buffer_load_dwordx4 v218, s[16:19], s34 offen offset:1024 nt lds
v_mfma_f32_16x16x32_bf16 v[96:99], a[16:19], a[128:131], v[96:99]
s_waitcnt vmcnt(21)
v_mfma_f32_16x16x32_bf16 v[96:99], a[48:51], a[152:155], v[96:99]
ds_read_b64_tr_b16 a[96:97], v200 offset:32768
v_mfma_f32_16x16x32_bf16 v[104:107], a[16:19], a[132:135], v[104:107]
ds_read_b64_tr_b16 a[100:101], v201 offset:32768
v_mfma_f32_16x16x32_bf16 v[104:107], a[48:51], a[156:159], v[104:107]
ds_read_b64_tr_b16 a[104:105], v202 offset:32768
v_mfma_f32_16x16x32_bf16 v[112:115], a[16:19], a[136:139], v[112:115]
ds_read_b64_tr_b16 a[108:109], v203 offset:32768
v_mfma_f32_16x16x32_bf16 v[112:115], a[48:51], a[160:163], v[112:115]
ds_read_b64_tr_b16 a[112:113], v204 offset:32768
buffer_load_dwordx4 v219, s[16:19], s34 offen offset:2048 nt lds
v_mfma_f32_16x16x32_bf16 v[120:123], a[16:19], a[140:143], v[120:123]
ds_read_b64_tr_b16 a[116:117], v205 offset:32768
v_mfma_f32_16x16x32_bf16 v[120:123], a[48:51], a[164:167], v[120:123]
ds_read_b64_tr_b16 a[120:121], v206 offset:32768
v_mfma_f32_16x16x32_bf16 v[128:131], a[16:19], a[144:147], v[128:131]
ds_read_b64_tr_b16 a[124:125], v207 offset:32768
v_mfma_f32_16x16x32_bf16 v[128:131], a[48:51], a[168:171], v[128:131]
ds_read_b64_tr_b16 a[98:99], v200 offset:33792
v_mfma_f32_16x16x32_bf16 v[136:139], a[16:19], a[148:151], v[136:139]
ds_read_b64_tr_b16 a[102:103], v201 offset:33792
v_mfma_f32_16x16x32_bf16 v[136:139], a[48:51], a[172:175], v[136:139]
ds_read_b64_tr_b16 a[106:107], v202 offset:33792
buffer_load_dwordx4 v220, s[16:19], s34 offen offset:3072 nt lds
v_mfma_f32_16x16x32_bf16 v[100:103], a[20:23], a[128:131], v[100:103]
ds_read_b64_tr_b16 a[110:111], v203 offset:33792
v_mfma_f32_16x16x32_bf16 v[100:103], a[52:55], a[152:155], v[100:103]
ds_read_b64_tr_b16 a[114:115], v204 offset:33792
v_mfma_f32_16x16x32_bf16 v[108:111], a[20:23], a[132:135], v[108:111]
ds_read_b64_tr_b16 a[118:119], v205 offset:33792
v_mfma_f32_16x16x32_bf16 v[108:111], a[52:55], a[156:159], v[108:111]
ds_read_b64_tr_b16 a[122:123], v206 offset:33792
v_mfma_f32_16x16x32_bf16 v[116:119], a[20:23], a[136:139], v[116:119]
ds_read_b64_tr_b16 a[126:127], v207 offset:33792
v_mfma_f32_16x16x32_bf16 v[116:119], a[52:55], a[160:163], v[116:119]
ds_read_b128 a[200:203], v209 offset:12288
v_mfma_f32_16x16x32_bf16 v[124:127], a[20:23], a[140:143], v[124:127]
ds_read_b128 a[204:207], v209 offset:14336
v_mfma_f32_16x16x32_bf16 v[124:127], a[52:55], a[164:167], v[124:127]
ds_read_b128 a[208:211], v209 offset:16384
s_add_u32 m0, s43, 98304
v_mfma_f32_16x16x32_bf16 v[132:135], a[20:23], a[144:147], v[132:135]
ds_read_b128 a[212:215], v209 offset:18432
s_add_u32 s35, s32, 4096
v_mfma_f32_16x16x32_bf16 v[132:135], a[52:55], a[168:171], v[132:135]
ds_read_b128 a[216:219], v209 offset:20480
s_waitcnt lgkmcnt(5)
buffer_load_dwordx4 v248, s[12:15], s32 offen offset:0 nt lds
v_mfma_f32_16x16x32_bf16 v[140:143], a[20:23], a[148:151], v[140:143]
ds_read_b128 a[220:223], v209 offset:22528
v_mfma_f32_16x16x32_bf16 v[140:143], a[52:55], a[172:175], v[140:143]
v_mfma_f32_16x16x32_bf16 v[144:147], a[24:27], a[128:131], v[144:147]
v_mfma_f32_16x16x32_bf16 v[144:147], a[56:59], a[152:155], v[144:147]
v_mfma_f32_16x16x32_bf16 v[152:155], a[24:27], a[132:135], v[152:155]
v_mfma_f32_16x16x32_bf16 v[152:155], a[56:59], a[156:159], v[152:155]
buffer_load_dwordx4 v249, s[12:15], s32 offen offset:1024 nt lds
v_mfma_f32_16x16x32_bf16 v[160:163], a[24:27], a[136:139], v[160:163]
v_mfma_f32_16x16x32_bf16 v[160:163], a[56:59], a[160:163], v[160:163]
v_mfma_f32_16x16x32_bf16 v[168:171], a[24:27], a[140:143], v[168:171]
v_mfma_f32_16x16x32_bf16 v[168:171], a[56:59], a[164:167], v[168:171]
v_mfma_f32_16x16x32_bf16 v[176:179], a[24:27], a[144:147], v[176:179]
v_mfma_f32_16x16x32_bf16 v[176:179], a[56:59], a[168:171], v[176:179]
buffer_load_dwordx4 v250, s[12:15], s32 offen offset:2048 nt lds
v_mfma_f32_16x16x32_bf16 v[184:187], a[24:27], a[148:151], v[184:187]
v_mfma_f32_16x16x32_bf16 v[184:187], a[56:59], a[172:175], v[184:187]
v_mfma_f32_16x16x32_bf16 v[148:151], a[28:31], a[128:131], v[148:151]
v_mfma_f32_16x16x32_bf16 v[148:151], a[60:63], a[152:155], v[148:151]
v_mfma_f32_16x16x32_bf16 v[156:159], a[28:31], a[132:135], v[156:159]
v_mfma_f32_16x16x32_bf16 v[156:159], a[60:63], a[156:159], v[156:159]
buffer_load_dwordx4 v251, s[12:15], s32 offen offset:3072 nt lds
s_add_u32 m0, s43, 102400
v_mfma_f32_16x16x32_bf16 v[164:167], a[28:31], a[136:139], v[164:167]
s_add_u32 s32, s32, 8192
v_mfma_f32_16x16x32_bf16 v[164:167], a[60:63], a[160:163], v[164:167]
v_mfma_f32_16x16x32_bf16 v[172:175], a[28:31], a[140:143], v[172:175]
v_mfma_f32_16x16x32_bf16 v[172:175], a[60:63], a[164:167], v[172:175]
v_mfma_f32_16x16x32_bf16 v[180:183], a[28:31], a[144:147], v[180:183]
v_mfma_f32_16x16x32_bf16 v[180:183], a[60:63], a[168:171], v[180:183]
buffer_load_dwordx4 v248, s[12:15], s35 offen offset:0 nt lds
v_mfma_f32_16x16x32_bf16 v[188:191], a[28:31], a[148:151], v[188:191]
v_mfma_f32_16x16x32_bf16 v[188:191], a[60:63], a[172:175], v[188:191]
s_waitcnt lgkmcnt(0)
v_mfma_f32_16x16x32_bf16 v[0:3], a[64:67], a[176:179], v[0:3]
s_waitcnt vmcnt(9)
s_barrier
v_mfma_f32_16x16x32_bf16 v[0:3], a[96:99], a[200:203], v[0:3]
ds_read_b64_tr_b16 a[0:1], v192 offset:0
v_mfma_f32_16x16x32_bf16 v[8:11], a[64:67], a[180:183], v[8:11]
ds_read_b64_tr_b16 a[4:5], v193 offset:0
v_mfma_f32_16x16x32_bf16 v[8:11], a[96:99], a[204:207], v[8:11]
ds_read_b64_tr_b16 a[8:9], v194 offset:0
buffer_load_dwordx4 v249, s[12:15], s35 offen offset:1024 nt lds
v_mfma_f32_16x16x32_bf16 v[16:19], a[64:67], a[184:187], v[16:19]
ds_read_b64_tr_b16 a[12:13], v195 offset:0
v_mfma_f32_16x16x32_bf16 v[16:19], a[96:99], a[208:211], v[16:19]
ds_read_b64_tr_b16 a[16:17], v196 offset:0
v_mfma_f32_16x16x32_bf16 v[24:27], a[64:67], a[188:191], v[24:27]
ds_read_b64_tr_b16 a[20:21], v197 offset:0
v_mfma_f32_16x16x32_bf16 v[24:27], a[96:99], a[212:215], v[24:27]
ds_read_b64_tr_b16 a[24:25], v198 offset:0
v_mfma_f32_16x16x32_bf16 v[32:35], a[64:67], a[192:195], v[32:35]
ds_read_b64_tr_b16 a[28:29], v199 offset:0
v_mfma_f32_16x16x32_bf16 v[32:35], a[96:99], a[216:219], v[32:35]
ds_read_b64_tr_b16 a[2:3], v192 offset:1024
buffer_load_dwordx4 v250, s[12:15], s35 offen offset:2048 nt lds
v_mfma_f32_16x16x32_bf16 v[40:43], a[64:67], a[196:199], v[40:43]
ds_read_b64_tr_b16 a[6:7], v193 offset:1024
v_mfma_f32_16x16x32_bf16 v[40:43], a[96:99], a[220:223], v[40:43]
ds_read_b64_tr_b16 a[10:11], v194 offset:1024
v_mfma_f32_16x16x32_bf16 v[4:7], a[68:71], a[176:179], v[4:7]
ds_read_b64_tr_b16 a[14:15], v195 offset:1024
v_mfma_f32_16x16x32_bf16 v[4:7], a[100:103], a[200:203], v[4:7]
ds_read_b64_tr_b16 a[18:19], v196 offset:1024
v_mfma_f32_16x16x32_bf16 v[12:15], a[68:71], a[180:183], v[12:15]
ds_read_b64_tr_b16 a[22:23], v197 offset:1024
v_mfma_f32_16x16x32_bf16 v[12:15], a[100:103], a[204:207], v[12:15]
ds_read_b64_tr_b16 a[26:27], v198 offset:1024
buffer_load_dwordx4 v251, s[12:15], s35 offen offset:3072 nt lds
v_mfma_f32_16x16x32_bf16 v[20:23], a[68:71], a[184:187], v[20:23]
ds_read_b64_tr_b16 a[30:31], v199 offset:1024
v_mfma_f32_16x16x32_bf16 v[20:23], a[100:103], a[208:211], v[20:23]
ds_read_b128 a[128:131], v208 offset:0
v_mfma_f32_16x16x32_bf16 v[28:31], a[68:71], a[188:191], v[28:31]
ds_read_b128 a[132:135], v208 offset:2048
v_mfma_f32_16x16x32_bf16 v[28:31], a[100:103], a[212:215], v[28:31]
ds_read_b128 a[136:139], v208 offset:4096
v_mfma_f32_16x16x32_bf16 v[36:39], a[68:71], a[192:195], v[36:39]
ds_read_b128 a[140:143], v208 offset:6144
v_mfma_f32_16x16x32_bf16 v[36:39], a[100:103], a[216:219], v[36:39]
ds_read_b128 a[144:147], v208 offset:8192
v_mfma_f32_16x16x32_bf16 v[44:47], a[68:71], a[196:199], v[44:47]
ds_read_b128 a[148:151], v208 offset:10240
v_mfma_f32_16x16x32_bf16 v[44:47], a[100:103], a[220:223], v[44:47]
v_mfma_f32_16x16x32_bf16 v[48:51], a[72:75], a[176:179], v[48:51]
v_mfma_f32_16x16x32_bf16 v[48:51], a[104:107], a[200:203], v[48:51]
v_mfma_f32_16x16x32_bf16 v[56:59], a[72:75], a[180:183], v[56:59]
v_mfma_f32_16x16x32_bf16 v[56:59], a[104:107], a[204:207], v[56:59]
v_mfma_f32_16x16x32_bf16 v[64:67], a[72:75], a[184:187], v[64:67]
v_mfma_f32_16x16x32_bf16 v[64:67], a[104:107], a[208:211], v[64:67]
v_mfma_f32_16x16x32_bf16 v[72:75], a[72:75], a[188:191], v[72:75]
v_mfma_f32_16x16x32_bf16 v[72:75], a[104:107], a[212:215], v[72:75]
v_mfma_f32_16x16x32_bf16 v[80:83], a[72:75], a[192:195], v[80:83]
v_mfma_f32_16x16x32_bf16 v[80:83], a[104:107], a[216:219], v[80:83]
v_mfma_f32_16x16x32_bf16 v[88:91], a[72:75], a[196:199], v[88:91]
v_mfma_f32_16x16x32_bf16 v[88:91], a[104:107], a[220:223], v[88:91]
v_mfma_f32_16x16x32_bf16 v[52:55], a[76:79], a[176:179], v[52:55]
v_mfma_f32_16x16x32_bf16 v[52:55], a[108:111], a[200:203], v[52:55]
v_mfma_f32_16x16x32_bf16 v[60:63], a[76:79], a[180:183], v[60:63]
v_mfma_f32_16x16x32_bf16 v[60:63], a[108:111], a[204:207], v[60:63]
v_mfma_f32_16x16x32_bf16 v[68:71], a[76:79], a[184:187], v[68:71]
v_mfma_f32_16x16x32_bf16 v[68:71], a[108:111], a[208:211], v[68:71]
v_mfma_f32_16x16x32_bf16 v[76:79], a[76:79], a[188:191], v[76:79]
v_mfma_f32_16x16x32_bf16 v[76:79], a[108:111], a[212:215], v[76:79]
v_mfma_f32_16x16x32_bf16 v[84:87], a[76:79], a[192:195], v[84:87]
v_mfma_f32_16x16x32_bf16 v[84:87], a[108:111], a[216:219], v[84:87]
v_mfma_f32_16x16x32_bf16 v[92:95], a[76:79], a[196:199], v[92:95]
v_mfma_f32_16x16x32_bf16 v[92:95], a[108:111], a[220:223], v[92:95]
v_mfma_f32_16x16x32_bf16 v[96:99], a[80:83], a[176:179], v[96:99]
v_mfma_f32_16x16x32_bf16 v[96:99], a[112:115], a[200:203], v[96:99]
ds_read_b64_tr_b16 a[32:33], v192 offset:32768
v_mfma_f32_16x16x32_bf16 v[104:107], a[80:83], a[180:183], v[104:107]
ds_read_b64_tr_b16 a[36:37], v193 offset:32768
v_mfma_f32_16x16x32_bf16 v[104:107], a[112:115], a[204:207], v[104:107]
ds_read_b64_tr_b16 a[40:41], v194 offset:32768
v_mfma_f32_16x16x32_bf16 v[112:115], a[80:83], a[184:187], v[112:115]
ds_read_b64_tr_b16 a[44:45], v195 offset:32768
v_mfma_f32_16x16x32_bf16 v[112:115], a[112:115], a[208:211], v[112:115]
ds_read_b64_tr_b16 a[48:49], v196 offset:32768
v_mfma_f32_16x16x32_bf16 v[120:123], a[80:83], a[188:191], v[120:123]
ds_read_b64_tr_b16 a[52:53], v197 offset:32768
v_mfma_f32_16x16x32_bf16 v[120:123], a[112:115], a[212:215], v[120:123]
ds_read_b64_tr_b16 a[56:57], v198 offset:32768
v_mfma_f32_16x16x32_bf16 v[128:131], a[80:83], a[192:195], v[128:131]
ds_read_b64_tr_b16 a[60:61], v199 offset:32768
v_mfma_f32_16x16x32_bf16 v[128:131], a[112:115], a[216:219], v[128:131]
ds_read_b64_tr_b16 a[34:35], v192 offset:33792
v_mfma_f32_16x16x32_bf16 v[136:139], a[80:83], a[196:199], v[136:139]
ds_read_b64_tr_b16 a[38:39], v193 offset:33792
v_mfma_f32_16x16x32_bf16 v[136:139], a[112:115], a[220:223], v[136:139]
ds_read_b64_tr_b16 a[42:43], v194 offset:33792
v_mfma_f32_16x16x32_bf16 v[100:103], a[84:87], a[176:179], v[100:103]
ds_read_b64_tr_b16 a[46:47], v195 offset:33792
v_mfma_f32_16x16x32_bf16 v[100:103], a[116:119], a[200:203], v[100:103]
ds_read_b64_tr_b16 a[50:51], v196 offset:33792
v_mfma_f32_16x16x32_bf16 v[108:111], a[84:87], a[180:183], v[108:111]
ds_read_b64_tr_b16 a[54:55], v197 offset:33792
v_mfma_f32_16x16x32_bf16 v[108:111], a[116:119], a[204:207], v[108:111]
ds_read_b64_tr_b16 a[58:59], v198 offset:33792
v_mfma_f32_16x16x32_bf16 v[116:119], a[84:87], a[184:187], v[116:119]
ds_read_b64_tr_b16 a[62:63], v199 offset:33792
v_mfma_f32_16x16x32_bf16 v[116:119], a[116:119], a[208:211], v[116:119]
ds_read_b128 a[152:155], v209 offset:0
v_mfma_f32_16x16x32_bf16 v[124:127], a[84:87], a[188:191], v[124:127]
ds_read_b128 a[156:159], v209 offset:2048
v_mfma_f32_16x16x32_bf16 v[124:127], a[116:119], a[212:215], v[124:127]
ds_read_b128 a[160:163], v209 offset:4096
s_add_u32 m0, s43, 0
v_mfma_f32_16x16x32_bf16 v[132:135], a[84:87], a[192:195], v[132:135]
ds_read_b128 a[164:167], v209 offset:6144
s_add_u32 s35, s32, 4096
v_mfma_f32_16x16x32_bf16 v[132:135], a[116:119], a[216:219], v[132:135]
ds_read_b128 a[168:171], v209 offset:8192
s_waitcnt lgkmcnt(15)
buffer_load_dwordx4 v248, s[12:15], s32 offen offset:0 nt lds
v_mfma_f32_16x16x32_bf16 v[140:143], a[84:87], a[196:199], v[140:143]
ds_read_b128 a[172:175], v209 offset:10240
v_mfma_f32_16x16x32_bf16 v[140:143], a[116:119], a[220:223], v[140:143]
v_mfma_f32_16x16x32_bf16 v[144:147], a[88:91], a[176:179], v[144:147]
v_mfma_f32_16x16x32_bf16 v[144:147], a[120:123], a[200:203], v[144:147]
v_mfma_f32_16x16x32_bf16 v[152:155], a[88:91], a[180:183], v[152:155]
v_mfma_f32_16x16x32_bf16 v[152:155], a[120:123], a[204:207], v[152:155]
v_mfma_f32_16x16x32_bf16 v[160:163], a[88:91], a[184:187], v[160:163]
v_mfma_f32_16x16x32_bf16 v[160:163], a[120:123], a[208:211], v[160:163]
v_mfma_f32_16x16x32_bf16 v[168:171], a[88:91], a[188:191], v[168:171]
v_mfma_f32_16x16x32_bf16 v[168:171], a[120:123], a[212:215], v[168:171]
v_mfma_f32_16x16x32_bf16 v[176:179], a[88:91], a[192:195], v[176:179]
v_mfma_f32_16x16x32_bf16 v[176:179], a[120:123], a[216:219], v[176:179]
buffer_load_dwordx4 v249, s[12:15], s32 offen offset:1024 nt lds
v_mfma_f32_16x16x32_bf16 v[184:187], a[88:91], a[196:199], v[184:187]
v_mfma_f32_16x16x32_bf16 v[184:187], a[120:123], a[220:223], v[184:187]
v_mfma_f32_16x16x32_bf16 v[148:151], a[92:95], a[176:179], v[148:151]
v_mfma_f32_16x16x32_bf16 v[148:151], a[124:127], a[200:203], v[148:151]
v_mfma_f32_16x16x32_bf16 v[156:159], a[92:95], a[180:183], v[156:159]
v_mfma_f32_16x16x32_bf16 v[156:159], a[124:127], a[204:207], v[156:159]
v_mfma_f32_16x16x32_bf16 v[164:167], a[92:95], a[184:187], v[164:167]
v_mfma_f32_16x16x32_bf16 v[164:167], a[124:127], a[208:211], v[164:167]
v_mfma_f32_16x16x32_bf16 v[172:175], a[92:95], a[188:191], v[172:175]
v_mfma_f32_16x16x32_bf16 v[172:175], a[124:127], a[212:215], v[172:175]
v_mfma_f32_16x16x32_bf16 v[180:183], a[92:95], a[192:195], v[180:183]
v_mfma_f32_16x16x32_bf16 v[180:183], a[124:127], a[216:219], v[180:183]
buffer_load_dwordx4 v250, s[12:15], s32 offen offset:2048 nt lds
v_mfma_f32_16x16x32_bf16 v[188:191], a[92:95], a[196:199], v[188:191]
v_mfma_f32_16x16x32_bf16 v[188:191], a[124:127], a[220:223], v[188:191]
s_waitcnt lgkmcnt(0)
v_mfma_f32_16x16x32_bf16 v[0:3], a[0:3], a[128:131], v[0:3]
v_mfma_f32_16x16x32_bf16 v[0:3], a[32:35], a[152:155], v[0:3]
v_mfma_f32_16x16x32_bf16 v[8:11], a[0:3], a[132:135], v[8:11]
v_mfma_f32_16x16x32_bf16 v[8:11], a[32:35], a[156:159], v[8:11]
v_mfma_f32_16x16x32_bf16 v[16:19], a[0:3], a[136:139], v[16:19]
v_mfma_f32_16x16x32_bf16 v[16:19], a[32:35], a[160:163], v[16:19]
v_mfma_f32_16x16x32_bf16 v[24:27], a[0:3], a[140:143], v[24:27]
v_mfma_f32_16x16x32_bf16 v[24:27], a[32:35], a[164:167], v[24:27]
v_mfma_f32_16x16x32_bf16 v[32:35], a[0:3], a[144:147], v[32:35]
v_mfma_f32_16x16x32_bf16 v[32:35], a[32:35], a[168:171], v[32:35]
buffer_load_dwordx4 v251, s[12:15], s32 offen offset:3072 nt lds
s_add_u32 m0, s43, 4096
v_mfma_f32_16x16x32_bf16 v[40:43], a[0:3], a[148:151], v[40:43]
s_add_u32 s32, s32, 8192
v_mfma_f32_16x16x32_bf16 v[40:43], a[32:35], a[172:175], v[40:43]
v_mfma_f32_16x16x32_bf16 v[4:7], a[4:7], a[128:131], v[4:7]
v_mfma_f32_16x16x32_bf16 v[4:7], a[36:39], a[152:155], v[4:7]
v_mfma_f32_16x16x32_bf16 v[12:15], a[4:7], a[132:135], v[12:15]
v_mfma_f32_16x16x32_bf16 v[12:15], a[36:39], a[156:159], v[12:15]
v_mfma_f32_16x16x32_bf16 v[20:23], a[4:7], a[136:139], v[20:23]
v_mfma_f32_16x16x32_bf16 v[20:23], a[36:39], a[160:163], v[20:23]
v_mfma_f32_16x16x32_bf16 v[28:31], a[4:7], a[140:143], v[28:31]
v_mfma_f32_16x16x32_bf16 v[28:31], a[36:39], a[164:167], v[28:31]
v_mfma_f32_16x16x32_bf16 v[36:39], a[4:7], a[144:147], v[36:39]
v_mfma_f32_16x16x32_bf16 v[36:39], a[36:39], a[168:171], v[36:39]
buffer_load_dwordx4 v248, s[12:15], s35 offen offset:0 nt lds
v_mfma_f32_16x16x32_bf16 v[44:47], a[4:7], a[148:151], v[44:47]
v_mfma_f32_16x16x32_bf16 v[44:47], a[36:39], a[172:175], v[44:47]
v_mfma_f32_16x16x32_bf16 v[48:51], a[8:11], a[128:131], v[48:51]
v_mfma_f32_16x16x32_bf16 v[48:51], a[40:43], a[152:155], v[48:51]
v_mfma_f32_16x16x32_bf16 v[56:59], a[8:11], a[132:135], v[56:59]
v_mfma_f32_16x16x32_bf16 v[56:59], a[40:43], a[156:159], v[56:59]
v_mfma_f32_16x16x32_bf16 v[64:67], a[8:11], a[136:139], v[64:67]
v_mfma_f32_16x16x32_bf16 v[64:67], a[40:43], a[160:163], v[64:67]
v_mul_f32 v0, s36, v0
v_mul_f32 v1, s36, v1
v_mfma_f32_16x16x32_bf16 v[72:75], a[8:11], a[140:143], v[72:75]
v_mul_f32 v2, s36, v2
v_mul_f32 v3, s36, v3
v_mfma_f32_16x16x32_bf16 v[72:75], a[40:43], a[164:167], v[72:75]
v_mul_f32 v4, s36, v4
v_mul_f32 v5, s36, v5
v_mfma_f32_16x16x32_bf16 v[80:83], a[8:11], a[144:147], v[80:83]
v_mul_f32 v6, s36, v6
v_mul_f32 v7, s36, v7
v_mfma_f32_16x16x32_bf16 v[80:83], a[40:43], a[168:171], v[80:83]
buffer_load_dwordx4 v249, s[12:15], s35 offen offset:1024 nt lds
v_cvt_pk_bf16_f32 v0, v0, v1
v_mfma_f32_16x16x32_bf16 v[88:91], a[8:11], a[148:151], v[88:91]
v_cvt_pk_bf16_f32 v1, v2, v3
v_cvt_pk_bf16_f32 v2, v4, v5
v_mfma_f32_16x16x32_bf16 v[88:91], a[40:43], a[172:175], v[88:91]
v_cvt_pk_bf16_f32 v3, v6, v7
v_mul_f32 v8, s36, v8
v_mfma_f32_16x16x32_bf16 v[52:55], a[12:15], a[128:131], v[52:55]
v_mul_f32 v9, s36, v9
v_mul_f32 v10, s36, v10
v_mfma_f32_16x16x32_bf16 v[52:55], a[44:47], a[152:155], v[52:55]
v_mul_f32 v11, s36, v11
v_mul_f32 v12, s36, v12
v_mfma_f32_16x16x32_bf16 v[60:63], a[12:15], a[132:135], v[60:63]
v_mul_f32 v13, s36, v13
v_mul_f32 v14, s36, v14
v_mfma_f32_16x16x32_bf16 v[60:63], a[44:47], a[156:159], v[60:63]
v_mul_f32 v15, s36, v15
v_cvt_pk_bf16_f32 v4, v8, v9
v_mfma_f32_16x16x32_bf16 v[68:71], a[12:15], a[136:139], v[68:71]
v_cvt_pk_bf16_f32 v5, v10, v11
v_cvt_pk_bf16_f32 v6, v12, v13
v_mfma_f32_16x16x32_bf16 v[68:71], a[44:47], a[160:163], v[68:71]
v_cvt_pk_bf16_f32 v7, v14, v15
v_permlane16_swap_b32 v0, v2
v_mfma_f32_16x16x32_bf16 v[76:79], a[12:15], a[140:143], v[76:79]
v_permlane16_swap_b32 v1, v3
v_mul_f32 v16, s36, v16
v_mfma_f32_16x16x32_bf16 v[76:79], a[44:47], a[164:167], v[76:79]
v_mul_f32 v17, s36, v17
v_mul_f32 v18, s36, v18
v_mfma_f32_16x16x32_bf16 v[84:87], a[12:15], a[144:147], v[84:87]
v_mul_f32 v19, s36, v19
v_mul_f32 v20, s36, v20
v_mfma_f32_16x16x32_bf16 v[84:87], a[44:47], a[168:171], v[84:87]
buffer_load_dwordx4 v250, s[12:15], s35 offen offset:2048 nt lds
v_mul_f32 v21, s36, v21
v_mfma_f32_16x16x32_bf16 v[92:95], a[12:15], a[148:151], v[92:95]
v_mul_f32 v22, s36, v22
v_mul_f32 v23, s36, v23
v_mfma_f32_16x16x32_bf16 v[92:95], a[44:47], a[172:175], v[92:95]
v_cvt_pk_bf16_f32 v8, v16, v17
v_mfma_f32_16x16x32_bf16 v[96:99], a[16:19], a[128:131], v[96:99]
s_waitcnt vmcnt(15)
s_barrier
v_mfma_f32_16x16x32_bf16 v[96:99], a[48:51], a[152:155], v[96:99]
ds_read_b128 v[192:195], v224 offset:57344
v_cvt_pk_bf16_f32 v9, v18, v19
v_mfma_f32_16x16x32_bf16 v[104:107], a[16:19], a[132:135], v[104:107]
ds_read_b128 v[196:199], v228 offset:0
v_cvt_pk_bf16_f32 v10, v20, v21
v_mfma_f32_16x16x32_bf16 v[104:107], a[48:51], a[156:159], v[104:107]
ds_read_b128 v[200:203], v225 offset:57344
v_cvt_pk_bf16_f32 v11, v22, v23
v_mfma_f32_16x16x32_bf16 v[112:115], a[16:19], a[136:139], v[112:115]
ds_read_b128 v[204:207], v229 offset:0
v_permlane16_swap_b32 v4, v6
v_mfma_f32_16x16x32_bf16 v[112:115], a[48:51], a[160:163], v[112:115]
ds_read_b128 v[208:211], v226 offset:57344
v_permlane16_swap_b32 v5, v7
v_mfma_f32_16x16x32_bf16 v[120:123], a[16:19], a[140:143], v[120:123]
ds_read_b128 v[212:215], v230 offset:0
v_mul_f32 v24, s36, v24
v_mfma_f32_16x16x32_bf16 v[120:123], a[48:51], a[164:167], v[120:123]
ds_read_b128 v[216:219], v227 offset:57344
v_mul_f32 v25, s36, v25
v_mfma_f32_16x16x32_bf16 v[128:131], a[16:19], a[144:147], v[128:131]
ds_read_b128 v[220:223], v231 offset:0
v_mul_f32 v26, s36, v26
v_mfma_f32_16x16x32_bf16 v[128:131], a[48:51], a[168:171], v[128:131]
buffer_load_dwordx4 v251, s[12:15], s35 offen offset:3072 nt lds
v_mul_f32 v27, s36, v27
v_mfma_f32_16x16x32_bf16 v[136:139], a[16:19], a[148:151], v[136:139]
v_mul_f32 v28, s36, v28
v_mul_f32 v29, s36, v29
v_mfma_f32_16x16x32_bf16 v[136:139], a[48:51], a[172:175], v[136:139]
v_mul_f32 v30, s36, v30
v_mul_f32 v31, s36, v31
v_mfma_f32_16x16x32_bf16 v[100:103], a[20:23], a[128:131], v[100:103]
v_cvt_pk_bf16_f32 v12, v24, v25
v_cvt_pk_bf16_f32 v13, v26, v27
v_mfma_f32_16x16x32_bf16 v[100:103], a[52:55], a[152:155], v[100:103]
v_cvt_pk_bf16_f32 v14, v28, v29
v_cvt_pk_bf16_f32 v15, v30, v31
v_mfma_f32_16x16x32_bf16 v[108:111], a[20:23], a[132:135], v[108:111]
v_permlane16_swap_b32 v8, v10
v_permlane16_swap_b32 v9, v11
v_mfma_f32_16x16x32_bf16 v[108:111], a[52:55], a[156:159], v[108:111]
v_mul_f32 v32, s36, v32
v_mul_f32 v33, s36, v33
v_mfma_f32_16x16x32_bf16 v[116:119], a[20:23], a[136:139], v[116:119]
v_mul_f32 v34, s36, v34
v_mul_f32 v35, s36, v35
v_mfma_f32_16x16x32_bf16 v[116:119], a[52:55], a[160:163], v[116:119]
v_mul_f32 v36, s36, v36
v_mul_f32 v37, s36, v37
v_mfma_f32_16x16x32_bf16 v[124:127], a[20:23], a[140:143], v[124:127]
v_mul_f32 v38, s36, v38
v_mul_f32 v39, s36, v39
v_mfma_f32_16x16x32_bf16 v[124:127], a[52:55], a[164:167], v[124:127]
v_cvt_pk_bf16_f32 v16, v32, v33
v_cvt_pk_bf16_f32 v17, v34, v35
v_mfma_f32_16x16x32_bf16 v[132:135], a[20:23], a[144:147], v[132:135]
v_cvt_pk_bf16_f32 v18, v36, v37
v_cvt_pk_bf16_f32 v19, v38, v39
v_mfma_f32_16x16x32_bf16 v[132:135], a[52:55], a[168:171], v[132:135]
v_permlane16_swap_b32 v12, v14
v_permlane16_swap_b32 v13, v15
v_mfma_f32_16x16x32_bf16 v[140:143], a[20:23], a[148:151], v[140:143]
v_mul_f32 v40, s36, v40
v_mul_f32 v41, s36, v41
v_mfma_f32_16x16x32_bf16 v[140:143], a[52:55], a[172:175], v[140:143]
v_mul_f32 v42, s36, v42
v_mul_f32 v43, s36, v43
v_mfma_f32_16x16x32_bf16 v[144:147], a[24:27], a[128:131], v[144:147]
v_mul_f32 v44, s36, v44
v_mul_f32 v45, s36, v45
v_mfma_f32_16x16x32_bf16 v[144:147], a[56:59], a[152:155], v[144:147]
v_mul_f32 v46, s36, v46
v_mul_f32 v47, s36, v47
v_mfma_f32_16x16x32_bf16 v[152:155], a[24:27], a[132:135], v[152:155]
v_cvt_pk_bf16_f32 v20, v40, v41
v_cvt_pk_bf16_f32 v21, v42, v43
v_mfma_f32_16x16x32_bf16 v[152:155], a[56:59], a[156:159], v[152:155]
v_cvt_pk_bf16_f32 v22, v44, v45
v_cvt_pk_bf16_f32 v23, v46, v47
v_mfma_f32_16x16x32_bf16 v[160:163], a[24:27], a[136:139], v[160:163]
v_permlane16_swap_b32 v16, v18
v_permlane16_swap_b32 v17, v19
v_mfma_f32_16x16x32_bf16 v[160:163], a[56:59], a[160:163], v[160:163]
s_nop 0
v_permlane16_swap_b32 v20, v22
v_mfma_f32_16x16x32_bf16 v[168:171], a[24:27], a[140:143], v[168:171]
v_permlane16_swap_b32 v21, v23
v_mul_f32 v48, s36, v48
v_mfma_f32_16x16x32_bf16 v[168:171], a[56:59], a[164:167], v[168:171]
v_mul_f32 v49, s36, v49
v_mul_f32 v50, s36, v50
v_mfma_f32_16x16x32_bf16 v[176:179], a[24:27], a[144:147], v[176:179]
v_mul_f32 v51, s36, v51
v_mul_f32 v52, s36, v52
v_mfma_f32_16x16x32_bf16 v[176:179], a[56:59], a[168:171], v[176:179]
v_mul_f32 v53, s36, v53
v_mul_f32 v54, s36, v54
v_mfma_f32_16x16x32_bf16 v[184:187], a[24:27], a[148:151], v[184:187]
v_mul_f32 v55, s36, v55
v_cvt_pk_bf16_f32 v24, v48, v49
v_mfma_f32_16x16x32_bf16 v[184:187], a[56:59], a[172:175], v[184:187]
v_cvt_pk_bf16_f32 v25, v50, v51
v_cvt_pk_bf16_f32 v26, v52, v53
v_mfma_f32_16x16x32_bf16 v[148:151], a[28:31], a[128:131], v[148:151]
v_cvt_pk_bf16_f32 v27, v54, v55
v_mul_f32 v56, s36, v56
v_mfma_f32_16x16x32_bf16 v[148:151], a[60:63], a[152:155], v[148:151]
v_mul_f32 v57, s36, v57
v_mul_f32 v58, s36, v58
v_mfma_f32_16x16x32_bf16 v[156:159], a[28:31], a[132:135], v[156:159]
v_mul_f32 v59, s36, v59
v_mul_f32 v60, s36, v60
v_mfma_f32_16x16x32_bf16 v[156:159], a[60:63], a[156:159], v[156:159]
v_mul_f32 v61, s36, v61
v_mul_f32 v62, s36, v62
v_mfma_f32_16x16x32_bf16 v[164:167], a[28:31], a[136:139], v[164:167]
v_mul_f32 v63, s36, v63
v_cvt_pk_bf16_f32 v28, v56, v57
v_mfma_f32_16x16x32_bf16 v[164:167], a[60:63], a[160:163], v[164:167]
v_cvt_pk_bf16_f32 v29, v58, v59
v_cvt_pk_bf16_f32 v30, v60, v61
v_mfma_f32_16x16x32_bf16 v[172:175], a[28:31], a[140:143], v[172:175]
v_cvt_pk_bf16_f32 v31, v62, v63
v_permlane16_swap_b32 v24, v26
v_mfma_f32_16x16x32_bf16 v[172:175], a[60:63], a[164:167], v[172:175]
v_permlane16_swap_b32 v25, v27
v_mul_f32 v64, s36, v64
v_mfma_f32_16x16x32_bf16 v[180:183], a[28:31], a[144:147], v[180:183]
v_mul_f32 v65, s36, v65
v_mul_f32 v66, s36, v66
v_mfma_f32_16x16x32_bf16 v[180:183], a[60:63], a[168:171], v[180:183]
v_mul_f32 v67, s36, v67
v_mul_f32 v68, s36, v68
v_mfma_f32_16x16x32_bf16 v[188:191], a[28:31], a[148:151], v[188:191]
v_mul_f32 v69, s36, v69
v_mul_f32 v70, s36, v70
v_mfma_f32_16x16x32_bf16 v[188:191], a[60:63], a[172:175], v[188:191]
v_mul_f32 v71, s36, v71
v_cvt_pk_bf16_f32 v32, v64, v65
v_cvt_pk_bf16_f32 v33, v66, v67
v_cvt_pk_bf16_f32 v34, v68, v69
v_cvt_pk_bf16_f32 v35, v70, v71
v_permlane16_swap_b32 v28, v30
v_permlane16_swap_b32 v29, v31
v_pk_mul_f32 v[72:73], v[72:73], s[38:39]
v_pk_mul_f32 v[74:75], v[74:75], s[38:39]
v_pk_mul_f32 v[76:77], v[76:77], s[38:39]
s_add_u32 m0, s43, 32768
s_add_u32 s35, s32, 4096
buffer_load_dwordx4 v248, s[12:15], s32 offen offset:0 nt lds
v_pk_mul_f32 v[78:79], v[78:79], s[38:39]
v_cvt_pk_bf16_f32 v36, v72, v73
v_cvt_pk_bf16_f32 v37, v74, v75
v_cvt_pk_bf16_f32 v38, v76, v77
v_cvt_pk_bf16_f32 v39, v78, v79
v_permlane16_swap_b32 v32, v34
v_permlane16_swap_b32 v33, v35
v_pk_mul_f32 v[80:81], v[80:81], s[38:39]
v_pk_mul_f32 v[82:83], v[82:83], s[38:39]
v_pk_mul_f32 v[84:85], v[84:85], s[38:39]
v_pk_mul_f32 v[86:87], v[86:87], s[38:39]
v_cvt_pk_bf16_f32 v40, v80, v81
v_cvt_pk_bf16_f32 v41, v82, v83
v_cvt_pk_bf16_f32 v42, v84, v85
v_cvt_pk_bf16_f32 v43, v86, v87
v_permlane16_swap_b32 v36, v38
v_permlane16_swap_b32 v37, v39
v_pk_mul_f32 v[88:89], v[88:89], s[38:39]
v_pk_mul_f32 v[90:91], v[90:91], s[38:39]
buffer_load_dwordx4 v249, s[12:15], s32 offen offset:1024 nt lds
v_pk_mul_f32 v[92:93], v[92:93], s[38:39]
v_pk_mul_f32 v[94:95], v[94:95], s[38:39]
v_cvt_pk_bf16_f32 v44, v88, v89
v_cvt_pk_bf16_f32 v45, v90, v91
v_cvt_pk_bf16_f32 v46, v92, v93
v_cvt_pk_bf16_f32 v47, v94, v95
v_permlane16_swap_b32 v40, v42
v_permlane16_swap_b32 v41, v43
s_nop 0
v_permlane16_swap_b32 v44, v46
v_permlane16_swap_b32 v45, v47
v_pk_mul_f32 v[96:97], v[96:97], s[38:39]
v_pk_mul_f32 v[98:99], v[98:99], s[38:39]
v_pk_mul_f32 v[100:101], v[100:101], s[38:39]
v_pk_mul_f32 v[102:103], v[102:103], s[38:39]
v_cvt_pk_bf16_f32 v48, v96, v97
v_cvt_pk_bf16_f32 v49, v98, v99
v_cvt_pk_bf16_f32 v50, v100, v101
v_cvt_pk_bf16_f32 v51, v102, v103
buffer_load_dwordx4 v250, s[12:15], s32 offen offset:2048 nt lds
v_pk_mul_f32 v[104:105], v[104:105], s[38:39]
v_pk_mul_f32 v[106:107], v[106:107], s[38:39]
v_pk_mul_f32 v[108:109], v[108:109], s[38:39]
v_pk_mul_f32 v[110:111], v[110:111], s[38:39]
v_cvt_pk_bf16_f32 v52, v104, v105
v_cvt_pk_bf16_f32 v53, v106, v107
v_cvt_pk_bf16_f32 v54, v108, v109
v_cvt_pk_bf16_f32 v55, v110, v111
v_permlane16_swap_b32 v48, v50
v_permlane16_swap_b32 v49, v51
v_pk_mul_f32 v[112:113], v[112:113], s[38:39]
v_pk_mul_f32 v[114:115], v[114:115], s[38:39]
v_pk_mul_f32 v[116:117], v[116:117], s[38:39]
v_pk_mul_f32 v[118:119], v[118:119], s[38:39]
v_cvt_pk_bf16_f32 v56, v112, v113
v_cvt_pk_bf16_f32 v57, v114, v115
v_cvt_pk_bf16_f32 v58, v116, v117
v_cvt_pk_bf16_f32 v59, v118, v119
v_permlane16_swap_b32 v52, v54
buffer_load_dwordx4 v251, s[12:15], s32 offen offset:3072 nt lds
v_permlane16_swap_b32 v53, v55
v_pk_mul_f32 v[120:121], v[120:121], s[38:39]
v_pk_mul_f32 v[122:123], v[122:123], s[38:39]
v_pk_mul_f32 v[124:125], v[124:125], s[38:39]
v_pk_mul_f32 v[126:127], v[126:127], s[38:39]
v_cvt_pk_bf16_f32 v60, v120, v121
v_cvt_pk_bf16_f32 v61, v122, v123
v_cvt_pk_bf16_f32 v62, v124, v125
v_cvt_pk_bf16_f32 v63, v126, v127
v_permlane16_swap_b32 v56, v58
v_permlane16_swap_b32 v57, v59
v_pk_mul_f32 v[128:129], v[128:129], s[38:39]
v_pk_mul_f32 v[130:131], v[130:131], s[38:39]
v_pk_mul_f32 v[132:133], v[132:133], s[38:39]
v_pk_mul_f32 v[134:135], v[134:135], s[38:39]
v_cvt_pk_bf16_f32 v64, v128, v129
v_cvt_pk_bf16_f32 v65, v130, v131
v_cvt_pk_bf16_f32 v66, v132, v133
v_cvt_pk_bf16_f32 v67, v134, v135
s_add_u32 m0, s43, 36864
s_add_u32 s32, s32, 8192
buffer_load_dwordx4 v248, s[12:15], s35 offen offset:0 nt lds
v_permlane16_swap_b32 v60, v62
v_permlane16_swap_b32 v61, v63
v_pk_mul_f32 v[136:137], v[136:137], s[38:39]
v_pk_mul_f32 v[138:139], v[138:139], s[38:39]
v_pk_mul_f32 v[140:141], v[140:141], s[38:39]
v_pk_mul_f32 v[142:143], v[142:143], s[38:39]
v_cvt_pk_bf16_f32 v68, v136, v137
v_cvt_pk_bf16_f32 v69, v138, v139
v_cvt_pk_bf16_f32 v70, v140, v141
v_cvt_pk_bf16_f32 v71, v142, v143
v_permlane16_swap_b32 v64, v66
v_permlane16_swap_b32 v65, v67
s_nop 0
v_permlane16_swap_b32 v68, v70
v_permlane16_swap_b32 v69, v71
v_pk_mul_f32 v[144:145], v[144:145], s[38:39]
v_pk_mul_f32 v[146:147], v[146:147], s[38:39]
v_pk_mul_f32 v[148:149], v[148:149], s[38:39]
v_pk_mul_f32 v[150:151], v[150:151], s[38:39]
buffer_load_dwordx4 v249, s[12:15], s35 offen offset:1024 nt lds
v_cvt_pk_bf16_f32 v72, v144, v145
v_cvt_pk_bf16_f32 v73, v146, v147
v_cvt_pk_bf16_f32 v74, v148, v149
v_cvt_pk_bf16_f32 v75, v150, v151
v_pk_mul_f32 v[152:153], v[152:153], s[38:39]
v_pk_mul_f32 v[154:155], v[154:155], s[38:39]
v_pk_mul_f32 v[156:157], v[156:157], s[38:39]
v_pk_mul_f32 v[158:159], v[158:159], s[38:39]
v_cvt_pk_bf16_f32 v76, v152, v153
v_cvt_pk_bf16_f32 v77, v154, v155
v_cvt_pk_bf16_f32 v78, v156, v157
v_cvt_pk_bf16_f32 v79, v158, v159
v_permlane16_swap_b32 v72, v74
v_permlane16_swap_b32 v73, v75
v_pk_mul_f32 v[160:161], v[160:161], s[38:39]
v_pk_mul_f32 v[162:163], v[162:163], s[38:39]
v_pk_mul_f32 v[164:165], v[164:165], s[38:39]
v_pk_mul_f32 v[166:167], v[166:167], s[38:39]
v_cvt_pk_bf16_f32 v80, v160, v161
buffer_load_dwordx4 v250, s[12:15], s35 offen offset:2048 nt lds
v_cvt_pk_bf16_f32 v81, v162, v163
v_cvt_pk_bf16_f32 v82, v164, v165
v_cvt_pk_bf16_f32 v83, v166, v167
v_permlane16_swap_b32 v76, v78
v_permlane16_swap_b32 v77, v79
v_pk_mul_f32 v[168:169], v[168:169], s[38:39]
v_pk_mul_f32 v[170:171], v[170:171], s[38:39]
v_pk_mul_f32 v[172:173], v[172:173], s[38:39]
v_pk_mul_f32 v[174:175], v[174:175], s[38:39]
v_cvt_pk_bf16_f32 v84, v168, v169
v_cvt_pk_bf16_f32 v85, v170, v171
v_cvt_pk_bf16_f32 v86, v172, v173
v_cvt_pk_bf16_f32 v87, v174, v175
v_permlane16_swap_b32 v80, v82
v_permlane16_swap_b32 v81, v83
v_pk_mul_f32 v[176:177], v[176:177], s[38:39]
v_pk_mul_f32 v[178:179], v[178:179], s[38:39]
v_pk_mul_f32 v[180:181], v[180:181], s[38:39]
v_pk_mul_f32 v[182:183], v[182:183], s[38:39]
buffer_load_dwordx4 v251, s[12:15], s35 offen offset:3072 nt lds
v_cvt_pk_bf16_f32 v88, v176, v177
v_cvt_pk_bf16_f32 v89, v178, v179
v_cvt_pk_bf16_f32 v90, v180, v181
v_cvt_pk_bf16_f32 v91, v182, v183
v_permlane16_swap_b32 v84, v86
v_permlane16_swap_b32 v85, v87
v_pk_mul_f32 v[184:185], v[184:185], s[38:39]
v_pk_mul_f32 v[186:187], v[186:187], s[38:39]
v_pk_mul_f32 v[188:189], v[188:189], s[38:39]
v_pk_mul_f32 v[190:191], v[190:191], s[38:39]
v_cvt_pk_bf16_f32 v92, v184, v185
v_cvt_pk_bf16_f32 v93, v186, v187
v_cvt_pk_bf16_f32 v94, v188, v189
v_cvt_pk_bf16_f32 v95, v190, v191
v_permlane16_swap_b32 v88, v90
v_permlane16_swap_b32 v89, v91
s_nop 0
v_permlane16_swap_b32 v92, v94
v_permlane16_swap_b32 v93, v95
s_bitcmp1_b32 s77, 0
s_cbranch_scc1 L_maxpass
L_maxdone:
s_lshl_b32 s44, s72, 4
s_add_u32 s44, s44, s70
s_lshl_b32 s47, s44, 7
s_add_u32 s47, s47, s71
s_lshl_b32 s47, s47, 2
s_add_u32 s47, s47, 32506112
s_lshl_b32 s44, s44, 2
s_waitcnt lgkmcnt(0)
s_load_dwordx2 s[30:31], s[0:1], 80
s_lshr_b32 s29, s2, 3
s_mul_i32 s34, s29, 52
s_lshr_b32 s34, s34, 8
s_mul_i32 s34, s34, 5
s_sub_u32 s29, s29, s34
s_add_u32 s29, s29, 3
s_lshr_b32 s34, s77, 1
s_or_b32 s34, s34, s28
s_cmp_eq_u32 s34, 0
s_cselect_b32 s29, s29, 99
v_mfma_f32_16x16x32_bf16 v[96:99], v[192:195], v[0:3], 0
v_mfma_f32_16x16x32_bf16 v[96:99], v[200:203], v[24:27], v[96:99]
v_mfma_f32_16x16x32_bf16 v[96:99], v[208:211], v[48:51], v[96:99]
v_mfma_f32_16x16x32_bf16 v[96:99], v[216:219], v[72:75], v[96:99]
v_mfma_f32_16x16x32_bf16 v[104:107], v[192:195], v[4:7], 0
v_mfma_f32_16x16x32_bf16 v[104:107], v[200:203], v[28:31], v[104:107]
v_mfma_f32_16x16x32_bf16 v[104:107], v[208:211], v[52:55], v[104:107]
v_mfma_f32_16x16x32_bf16 v[104:107], v[216:219], v[76:79], v[104:107]
v_mfma_f32_16x16x32_bf16 v[100:103], v[196:199], v[0:3], 0
v_mfma_f32_16x16x32_bf16 v[100:103], v[204:207], v[24:27], v[100:103]
v_mfma_f32_16x16x32_bf16 v[100:103], v[212:215], v[48:51], v[100:103]
v_mfma_f32_16x16x32_bf16 v[100:103], v[220:223], v[72:75], v[100:103]
v_mfma_f32_16x16x32_bf16 v[108:111], v[196:199], v[4:7], 0
v_mfma_f32_16x16x32_bf16 v[108:111], v[204:207], v[28:31], v[108:111]
v_mfma_f32_16x16x32_bf16 v[108:111], v[212:215], v[52:55], v[108:111]
v_mfma_f32_16x16x32_bf16 v[108:111], v[220:223], v[76:79], v[108:111]
s_waitcnt lgkmcnt(0)
s_nop 7
s_bitcmp1_b32 s77, 0
s_cbranch_scc1 L_mx_0
v_max3_f32 v168, v96, v97, v98
v_max3_f32 v168, v168, v99, v100
v_max3_f32 v168, v168, v101, v102
v_max_f32 v168, v168, v103
v_mov_b32 v169, v168
s_nop 1
v_permlane16_swap_b32 v168, v169
v_max_f32 v168, v168, v169
v_mov_b32 v169, v168
s_nop 1
v_permlane32_swap_b32 v168, v169
v_max_f32 v168, v168, v169
v_sub_f32 v144, 0, v168
v_sub_f32 v145, 0, v168
v_sub_f32 v146, 0, v168
v_sub_f32 v147, 0, v168
v_max3_f32 v168, v104, v105, v106
v_max3_f32 v168, v168, v107, v108
v_max3_f32 v168, v168, v109, v110
v_max_f32 v168, v168, v111
v_mov_b32 v169, v168
s_nop 1
v_permlane16_swap_b32 v168, v169
v_max_f32 v168, v168, v169
v_mov_b32 v169, v168
s_nop 1
v_permlane32_swap_b32 v168, v169
v_max_f32 v168, v168, v169
v_sub_f32 v148, 0, v168
v_sub_f32 v149, 0, v168
v_sub_f32 v150, 0, v168
v_sub_f32 v151, 0, v168
L_mx_0:
v_add_f32 v96, v96, v144
v_mfma_f32_16x16x32_bf16 v[112:115], v[192:195], v[8:11], 0
v_add_f32 v97, v97, v144
v_add_f32 v98, v98, v144
v_mfma_f32_16x16x32_bf16 v[112:115], v[200:203], v[32:35], v[112:115]
v_add_f32 v99, v99, v144
v_add_f32 v100, v100, v144
v_mfma_f32_16x16x32_bf16 v[112:115], v[208:211], v[56:59], v[112:115]
v_add_f32 v101, v101, v144
v_add_f32 v102, v102, v144
v_mfma_f32_16x16x32_bf16 v[112:115], v[216:219], v[80:83], v[112:115]
v_add_f32 v103, v103, v144
v_add_f32 v104, v104, v148
v_mfma_f32_16x16x32_bf16 v[120:123], v[192:195], v[12:15], 0
v_add_f32 v105, v105, v148
v_add_f32 v106, v106, v148
v_mfma_f32_16x16x32_bf16 v[120:123], v[200:203], v[36:39], v[120:123]
v_add_f32 v107, v107, v148
v_add_f32 v108, v108, v148
v_mfma_f32_16x16x32_bf16 v[120:123], v[208:211], v[60:63], v[120:123]
v_add_f32 v109, v109, v148
v_add_f32 v110, v110, v148
v_mfma_f32_16x16x32_bf16 v[120:123], v[216:219], v[84:87], v[120:123]
v_add_f32 v111, v111, v148
v_mfma_f32_16x16x32_bf16 v[116:119], v[196:199], v[8:11], 0
v_exp_f32 v96, v96
v_mfma_f32_16x16x32_bf16 v[116:119], v[204:207], v[32:35], v[116:119]
v_exp_f32 v97, v97
v_mfma_f32_16x16x32_bf16 v[116:119], v[212:215], v[56:59], v[116:119]
v_exp_f32 v98, v98
v_mfma_f32_16x16x32_bf16 v[116:119], v[220:223], v[80:83], v[116:119]
v_cvt_pk_bf16_f32 v128, v96, v97
v_mfma_f32_16x16x32_bf16 v[124:127], v[196:199], v[12:15], 0
v_exp_f32 v99, v99
v_mfma_f32_16x16x32_bf16 v[124:127], v[204:207], v[36:39], v[124:127]
v_exp_f32 v100, v100
v_mfma_f32_16x16x32_bf16 v[124:127], v[212:215], v[60:63], v[124:127]
v_cvt_pk_bf16_f32 v129, v98, v99
v_mfma_f32_16x16x32_bf16 v[124:127], v[220:223], v[84:87], v[124:127]
s_waitcnt vmcnt(16)
s_barrier
ds_read_b64_tr_b16 a[192:193], v240 offset:32768
ds_read_b64_tr_b16 a[194:195], v240 offset:36864
ds_read_b64_tr_b16 a[196:197], v241 offset:32768
ds_read_b64_tr_b16 a[198:199], v241 offset:36864
ds_read_b64_tr_b16 a[200:201], v242 offset:32768
ds_read_b64_tr_b16 a[202:203], v242 offset:36864
ds_read_b64_tr_b16 a[204:205], v243 offset:32768
ds_read_b64_tr_b16 a[206:207], v243 offset:36864
ds_read_b64_tr_b16 a[208:209], v244 offset:32768
ds_read_b64_tr_b16 a[210:211], v244 offset:36864
ds_read_b64_tr_b16 a[212:213], v245 offset:32768
ds_read_b64_tr_b16 a[214:215], v245 offset:36864
ds_read_b64_tr_b16 a[216:217], v246 offset:32768
ds_read_b64_tr_b16 a[218:219], v246 offset:36864
ds_read_b64_tr_b16 a[220:221], v247 offset:32768
ds_read_b64_tr_b16 a[222:223], v247 offset:36864
v_exp_f32 v101, v101
v_exp_f32 v102, v102
v_cvt_pk_bf16_f32 v130, v100, v101
v_exp_f32 v103, v103
v_exp_f32 v104, v104
v_cvt_pk_bf16_f32 v131, v102, v103
v_exp_f32 v105, v105
v_exp_f32 v106, v106
v_cvt_pk_bf16_f32 v132, v104, v105
v_exp_f32 v107, v107
v_exp_f32 v108, v108
v_cvt_pk_bf16_f32 v133, v106, v107
v_exp_f32 v109, v109
v_exp_f32 v110, v110
v_cvt_pk_bf16_f32 v134, v108, v109
v_exp_f32 v111, v111
s_nop 0
v_cvt_pk_bf16_f32 v135, v110, v111
s_bitcmp1_b32 s77, 0
s_cbranch_scc1 L_mx_1
v_max3_f32 v168, v112, v113, v114
v_max3_f32 v168, v168, v115, v116
v_max3_f32 v168, v168, v117, v118
v_max_f32 v168, v168, v119
v_mov_b32 v169, v168
s_nop 1
v_permlane16_swap_b32 v168, v169
v_max_f32 v168, v168, v169
v_mov_b32 v169, v168
s_nop 1
v_permlane32_swap_b32 v168, v169
v_max_f32 v168, v168, v169
v_sub_f32 v152, 0, v168
v_sub_f32 v153, 0, v168
v_sub_f32 v154, 0, v168
v_sub_f32 v155, 0, v168
v_max3_f32 v168, v120, v121, v122
v_max3_f32 v168, v168, v123, v124
v_max3_f32 v168, v168, v125, v126
v_max_f32 v168, v168, v127
v_mov_b32 v169, v168
s_nop 1
v_permlane16_swap_b32 v168, v169
v_max_f32 v168, v168, v169
v_mov_b32 v169, v168
s_nop 1
v_permlane32_swap_b32 v168, v169
v_max_f32 v168, v168, v169
v_sub_f32 v156, 0, v168
v_sub_f32 v157, 0, v168
v_sub_f32 v158, 0, v168
v_sub_f32 v159, 0, v168
L_mx_1:
v_add_f32 v112, v112, v152
v_mfma_f32_16x16x32_bf16 v[96:99], v[192:195], v[16:19], 0
v_add_f32 v113, v113, v152
v_add_f32 v114, v114, v152
v_mfma_f32_16x16x32_bf16 v[96:99], v[200:203], v[40:43], v[96:99]
v_add_f32 v115, v115, v152
v_add_f32 v116, v116, v152
v_mfma_f32_16x16x32_bf16 v[96:99], v[208:211], v[64:67], v[96:99]
v_add_f32 v117, v117, v152
v_add_f32 v118, v118, v152
v_mfma_f32_16x16x32_bf16 v[96:99], v[216:219], v[88:91], v[96:99]
v_add_f32 v119, v119, v152
v_add_f32 v120, v120, v156
v_mfma_f32_16x16x32_bf16 v[104:107], v[192:195], v[20:23], 0
v_add_f32 v121, v121, v156
v_add_f32 v122, v122, v156
v_mfma_f32_16x16x32_bf16 v[104:107], v[200:203], v[44:47], v[104:107]
ds_read_b128 v[192:195], v228 offset:32768
v_add_f32 v123, v123, v156
v_mfma_f32_16x16x32_bf16 v[104:107], v[208:211], v[68:71], v[104:107]
v_add_f32 v124, v124, v156
v_add_f32 v125, v125, v156
v_mfma_f32_16x16x32_bf16 v[104:107], v[216:219], v[92:95], v[104:107]
ds_read_b128 v[200:203], v229 offset:32768
v_add_f32 v126, v126, v156
v_mfma_f32_16x16x32_bf16 v[100:103], v[196:199], v[16:19], 0
v_add_f32 v127, v127, v156
s_mov_b32 s48, s70
v_mfma_f32_16x16x32_bf16 v[100:103], v[204:207], v[40:43], v[100:103]
ds_read_b128 v[208:211], v230 offset:32768
s_sub_u32 s67, s48, 9
v_mfma_f32_16x16x32_bf16 v[100:103], v[212:215], v[64:67], v[100:103]
v_exp_f32 v112, v112
v_mfma_f32_16x16x32_bf16 v[100:103], v[220:223], v[88:91], v[100:103]
ds_read_b128 v[216:219], v231 offset:32768
s_min_u32 s48, s48, s67
v_mfma_f32_16x16x32_bf16 v[108:111], v[196:199], v[20:23], 0
v_exp_f32 v113, v113
v_mfma_f32_16x16x32_bf16 v[108:111], v[204:207], v[44:47], v[108:111]
ds_read_b128 v[196:199], v228 offset:36864
v_accvgpr_write_b32 a128, 0
v_mfma_f32_16x16x32_bf16 v[108:111], v[212:215], v[68:71], v[108:111]
s_sub_u32 s67, s48, 9
v_accvgpr_write_b32 a129, 0
v_mfma_f32_16x16x32_bf16 v[108:111], v[220:223], v[92:95], v[108:111]
ds_read_b128 v[204:207], v229 offset:36864
s_waitcnt lgkmcnt(6)
v_mfma_f32_16x16x32_bf16 a[0:3], a[192:195], v[128:131], 0
s_min_u32 s48, s48, s67
v_accvgpr_write_b32 a130, 0
v_mfma_f32_16x16x32_bf16 a[32:35], a[192:195], v[132:135], 0
ds_read_b128 v[212:215], v230 offset:36864
s_lshl_b32 s48, s48, 7
v_mfma_f32_16x16x32_bf16 a[4:7], a[196:199], v[128:131], 0
v_exp_f32 v114, v114
v_mfma_f32_16x16x32_bf16 a[36:39], a[196:199], v[132:135], 0
ds_read_b128 v[220:223], v231 offset:36864
v_cvt_pk_bf16_f32 v136, v112, v113
v_mfma_f32_16x16x32_bf16 a[8:11], a[200:203], v[128:131], 0
v_accvgpr_write_b32 a131, 0
s_add_u32 s49, s71, 1
v_mfma_f32_16x16x32_bf16 a[40:43], a[200:203], v[132:135], 0
v_accvgpr_write_b32 a132, 0
s_and_b32 s49, s49, 7
v_mfma_f32_16x16x32_bf16 a[12:15], a[204:207], v[128:131], 0
v_exp_f32 v115, v115
v_mfma_f32_16x16x32_bf16 a[44:47], a[204:207], v[132:135], 0
v_accvgpr_write_b32 a133, 0
s_add_u32 s49, s49, s70
v_mfma_f32_16x16x32_bf16 a[16:19], a[208:211], v[128:131], 0
v_accvgpr_write_b32 a134, 0
s_add_u32 s49, s49, 1
v_mfma_f32_16x16x32_bf16 a[48:51], a[208:211], v[132:135], 0
v_exp_f32 v116, v116
v_mfma_f32_16x16x32_bf16 a[20:23], a[212:215], v[128:131], 0
v_accvgpr_write_b32 a135, 0
s_sub_u32 s67, s49, 9
v_mfma_f32_16x16x32_bf16 a[52:55], a[212:215], v[132:135], 0
v_cvt_pk_bf16_f32 v137, v114, v115
v_accvgpr_write_b32 a136, 0
v_mfma_f32_16x16x32_bf16 a[24:27], a[216:219], v[128:131], 0
s_min_u32 s49, s49, s67
v_accvgpr_write_b32 a137, 0
v_mfma_f32_16x16x32_bf16 a[56:59], a[216:219], v[132:135], 0
s_sub_u32 s67, s49, 9
v_accvgpr_write_b32 a138, 0
v_mfma_f32_16x16x32_bf16 a[28:31], a[220:223], v[128:131], 0
v_exp_f32 v117, v117
v_mfma_f32_16x16x32_bf16 a[60:63], a[220:223], v[132:135], 0
s_min_u32 s49, s49, s67
v_accvgpr_write_b32 a139, 0
v_mfma_f32_16x16x32_bf16 a[224:227], a[248:251], v[128:131], 0
s_lshl_b32 s49, s49, 7
v_accvgpr_write_b32 a140, 0
v_mfma_f32_16x16x32_bf16 a[228:231], a[248:251], v[132:135], 0
v_exp_f32 v118, v118
s_add_u32 s50, s71, 2
v_cvt_pk_bf16_f32 v138, v116, v117
v_accvgpr_write_b32 a141, 0
s_and_b32 s50, s50, 7
v_accvgpr_write_b32 a142, 0
s_add_u32 s50, s50, s70
v_exp_f32 v119, v119
v_accvgpr_write_b32 a143, 0
s_add_u32 s50, s50, 1
v_accvgpr_write_b32 a144, 0
s_sub_u32 s67, s50, 9
v_exp_f32 v120, v120
v_accvgpr_write_b32 a145, 0
s_min_u32 s50, s50, s67
v_cvt_pk_bf16_f32 v139, v118, v119
v_accvgpr_write_b32 a146, 0
s_sub_u32 s67, s50, 9
v_accvgpr_write_b32 a147, 0
s_min_u32 s50, s50, s67
v_exp_f32 v121, v121
v_accvgpr_write_b32 a148, 0
s_lshl_b32 s50, s50, 7
v_accvgpr_write_b32 a149, 0
s_add_u32 s51, s71, 3
v_exp_f32 v122, v122
v_accvgpr_write_b32 a150, 0
s_and_b32 s51, s51, 7
v_cvt_pk_bf16_f32 v140, v120, v121
v_accvgpr_write_b32 a151, 0
s_add_u32 s51, s51, s70
v_accvgpr_write_b32 a152, 0
s_add_u32 s51, s51, 1
v_exp_f32 v123, v123
v_accvgpr_write_b32 a153, 0
s_sub_u32 s67, s51, 9
v_accvgpr_write_b32 a154, 0
s_min_u32 s51, s51, s67
v_exp_f32 v124, v124
v_accvgpr_write_b32 a155, 0
s_sub_u32 s67, s51, 9
v_cvt_pk_bf16_f32 v141, v122, v123
v_accvgpr_write_b32 a156, 0
s_min_u32 s51, s51, s67
v_accvgpr_write_b32 a157, 0
s_lshl_b32 s51, s51, 7
v_exp_f32 v125, v125
v_accvgpr_write_b32 a158, 0
s_add_u32 s52, s71, 4
v_accvgpr_write_b32 a159, 0
s_and_b32 s52, s52, 7
v_exp_f32 v126, v126
v_accvgpr_write_b32 a160, 0
s_add_u32 s52, s52, s70
v_cvt_pk_bf16_f32 v142, v124, v125
v_accvgpr_write_b32 a161, 0
s_add_u32 s52, s52, 1
v_accvgpr_write_b32 a162, 0
s_sub_u32 s67, s52, 9
v_exp_f32 v127, v127
v_accvgpr_write_b32 a163, 0
s_min_u32 s52, s52, s67
v_cvt_pk_bf16_f32 v143, v126, v127
s_bitcmp1_b32 s77, 0
s_cbranch_scc1 L_mx_2
v_max3_f32 v168, v96, v97, v98
v_max3_f32 v168, v168, v99, v100
v_max3_f32 v168, v168, v101, v102
v_max_f32 v168, v168, v103
v_mov_b32 v169, v168
s_nop 1
v_permlane16_swap_b32 v168, v169
v_max_f32 v168, v168, v169
v_mov_b32 v169, v168
s_nop 1
v_permlane32_swap_b32 v168, v169
v_max_f32 v168, v168, v169
v_sub_f32 v160, 0, v168
v_sub_f32 v161, 0, v168
v_sub_f32 v162, 0, v168
v_sub_f32 v163, 0, v168
v_max3_f32 v168, v104, v105, v106
v_max3_f32 v168, v168, v107, v108
v_max3_f32 v168, v168, v109, v110
v_max_f32 v168, v168, v111
v_mov_b32 v169, v168
s_nop 1
v_permlane16_swap_b32 v168, v169
v_max_f32 v168, v168, v169
v_mov_b32 v169, v168
s_nop 1
v_permlane32_swap_b32 v168, v169
v_max_f32 v168, v168, v169
v_sub_f32 v164, 0, v168
v_sub_f32 v165, 0, v168
v_sub_f32 v166, 0, v168
v_sub_f32 v167, 0, v168
L_mx_2:
s_waitcnt lgkmcnt(0)
v_mfma_f32_16x16x32_bf16 v[112:115], v[192:195], v[0:3], v[144:147]
v_add_f32 v96, v96, v160
v_add_f32 v97, v97, v160
v_mfma_f32_16x16x32_bf16 v[112:115], v[200:203], v[24:27], v[112:115]
v_add_f32 v98, v98, v160
v_add_f32 v99, v99, v160
v_mfma_f32_16x16x32_bf16 v[112:115], v[208:211], v[48:51], v[112:115]
v_add_f32 v100, v100, v160
v_add_f32 v101, v101, v160
v_mfma_f32_16x16x32_bf16 v[112:115], v[216:219], v[72:75], v[112:115]
v_add_f32 v102, v102, v160
v_add_f32 v103, v103, v160
v_mfma_f32_16x16x32_bf16 v[120:123], v[192:195], v[4:7], v[148:151]
v_add_f32 v104, v104, v164
v_add_f32 v105, v105, v164
v_mfma_f32_16x16x32_bf16 v[120:123], v[200:203], v[28:31], v[120:123]
v_add_f32 v106, v106, v164
v_add_f32 v107, v107, v164
v_mfma_f32_16x16x32_bf16 v[120:123], v[208:211], v[52:55], v[120:123]
v_add_f32 v108, v108, v164
v_add_f32 v109, v109, v164
v_mfma_f32_16x16x32_bf16 v[120:123], v[216:219], v[76:79], v[120:123]
v_add_f32 v110, v110, v164
v_add_f32 v111, v111, v164
v_mfma_f32_16x16x32_bf16 v[116:119], v[196:199], v[0:3], v[144:147]
s_sub_u32 s67, s52, 9
s_min_u32 s52, s52, s67
v_mfma_f32_16x16x32_bf16 v[116:119], v[204:207], v[24:27], v[116:119]
v_exp_f32 v96, v96
v_mfma_f32_16x16x32_bf16 v[116:119], v[212:215], v[48:51], v[116:119]
s_lshl_b32 s52, s52, 7
v_accvgpr_write_b32 a164, 0
v_mfma_f32_16x16x32_bf16 v[116:119], v[220:223], v[72:75], v[116:119]
v_exp_f32 v97, v97
v_mfma_f32_16x16x32_bf16 v[124:127], v[196:199], v[4:7], v[148:151]
s_add_u32 s53, s71, 5
v_accvgpr_write_b32 a165, 0
v_mfma_f32_16x16x32_bf16 v[124:127], v[204:207], v[28:31], v[124:127]
s_and_b32 s53, s53, 7
v_accvgpr_write_b32 a166, 0
v_mfma_f32_16x16x32_bf16 v[124:127], v[212:215], v[52:55], v[124:127]
v_exp_f32 v98, v98
v_mfma_f32_16x16x32_bf16 v[124:127], v[220:223], v[76:79], v[124:127]
s_add_u32 s53, s53, s70
v_cvt_pk_bf16_f32 v128, v96, v97
v_mfma_f32_16x16x32_bf16 a[64:67], a[192:195], v[136:139], 0
v_accvgpr_write_b32 a167, 0
s_add_u32 s53, s53, 1
v_mfma_f32_16x16x32_bf16 a[96:99], a[192:195], v[140:143], 0
v_accvgpr_write_b32 a168, 0
s_sub_u32 s67, s53, 9
v_mfma_f32_16x16x32_bf16 a[68:71], a[196:199], v[136:139], 0
v_exp_f32 v99, v99
v_mfma_f32_16x16x32_bf16 a[100:103], a[196:199], v[140:143], 0
v_accvgpr_write_b32 a169, 0
s_min_u32 s53, s53, s67
v_mfma_f32_16x16x32_bf16 a[72:75], a[200:203], v[136:139], 0
v_accvgpr_write_b32 a170, 0
s_sub_u32 s67, s53, 9
v_mfma_f32_16x16x32_bf16 a[104:107], a[200:203], v[140:143], 0
v_exp_f32 v100, v100
v_mfma_f32_16x16x32_bf16 a[76:79], a[204:207], v[136:139], 0
v_accvgpr_write_b32 a171, 0
s_min_u32 s53, s53, s67
v_mfma_f32_16x16x32_bf16 a[108:111], a[204:207], v[140:143], 0
v_cvt_pk_bf16_f32 v129, v98, v99
v_accvgpr_write_b32 a172, 0
v_mfma_f32_16x16x32_bf16 a[80:83], a[208:211], v[136:139], 0
s_lshl_b32 s53, s53, 7
v_accvgpr_write_b32 a173, 0
v_mfma_f32_16x16x32_bf16 a[112:115], a[208:211], v[140:143], 0
s_add_u32 s54, s71, 6
v_lshrrev_b32 v170, 3, v252
v_mfma_f32_16x16x32_bf16 a[84:87], a[212:215], v[136:139], 0
v_exp_f32 v101, v101
v_mfma_f32_16x16x32_bf16 a[116:119], a[212:215], v[140:143], 0
v_accvgpr_write_b32 a174, 0
s_and_b32 s54, s54, 7
v_mfma_f32_16x16x32_bf16 a[88:91], a[216:219], v[136:139], 0
v_mul_u32_u24 v170, 1152, v170
v_accvgpr_write_b32 a175, 0
v_mfma_f32_16x16x32_bf16 a[120:123], a[216:219], v[140:143], 0
s_add_u32 s54, s54, s70
v_and_b32 v171, 7, v252
v_mfma_f32_16x16x32_bf16 a[92:95], a[220:223], v[136:139], 0
v_exp_f32 v102, v102
v_mfma_f32_16x16x32_bf16 a[124:127], a[220:223], v[140:143], 0
v_accvgpr_write_b32 a176, 0
s_add_u32 s54, s54, 1
v_mfma_f32_16x16x32_bf16 a[232:235], a[248:251], v[136:139], 0
v_cvt_pk_bf16_f32 v130, v100, v101
v_lshlrev_b32 v172, 1, v253
v_mfma_f32_16x16x32_bf16 a[236:239], a[248:251], v[140:143], 0
v_accvgpr_write_b32 a177, 0
s_sub_u32 s67, s54, 9
v_xor_b32 v171, v171, v172
v_accvgpr_write_b32 a178, 0
s_min_u32 s54, s54, s67
v_exp_f32 v103, v103
v_lshl_add_u32 v170, v171, 4, v170
v_accvgpr_write_b32 a179, 0
s_sub_u32 s67, s54, 9
v_add_u32 v176, 0, v170
v_accvgpr_write_b32 a180, 0
s_min_u32 s54, s54, s67
v_exp_f32 v104, v104
v_add_u32 v177, 8192, v170
v_accvgpr_write_b32 a181, 0
s_lshl_b32 s54, s54, 7
v_cvt_pk_bf16_f32 v131, v102, v103
v_add_u32 v178, 16384, v170
v_accvgpr_write_b32 a182, 0
s_add_u32 s55, s71, 7
v_add_u32 v179, 24576, v170
v_accvgpr_write_b32 a183, 0
s_and_b32 s55, s55, 7
v_exp_f32 v105, v105
v_lshrrev_b32 v170, 2, v254
v_accvgpr_write_b32 a184, 0
s_add_u32 s55, s55, s70
v_lshl_add_u32 v170, v253, 2, v170
v_accvgpr_write_b32 a185, 0
s_add_u32 s55, s55, 1
v_exp_f32 v106, v106
v_bfe_u32 v171, v170, 1, 2
v_accvgpr_write_b32 a186, 0
s_sub_u32 s67, s55, 9
v_cvt_pk_bf16_f32 v132, v104, v105
v_xor_b32 v171, s28, v171
v_accvgpr_write_b32 a187, 0
s_min_u32 s55, s55, s67
v_lshlrev_b32 v170, 7, v170
v_accvgpr_write_b32 a188, 0
s_sub_u32 s67, s55, 9
v_exp_f32 v107, v107
v_lshl_add_u32 v170, v171, 5, v170
v_accvgpr_write_b32 a189, 0
s_min_u32 s55, s55, s67
v_exp_f32 v112, v112
v_and_b32 v171, 3, v252
v_accvgpr_write_b32 a190, 0
s_lshl_b32 s55, s55, 7
v_exp_f32 v108, v108
v_lshl_add_u32 v180, v171, 3, v170
v_accvgpr_write_b32 a191, 0
s_add_u32 s56, s71, 8
v_cvt_pk_bf16_f32 v133, v106, v107
v_exp_f32 v113, v113
v_add_u32 v185, 65536, v180
v_accvgpr_write_b32 a240, 0
s_and_b32 s56, s56, 7
v_add_u32 v186, 131072, v180
v_accvgpr_write_b32 a241, 0
s_add_u32 s56, s56, s70
v_exp_f32 v109, v109
v_exp_f32 v114, v114
v_lshlrev_b32 v184, 4, v252
v_accvgpr_write_b32 a242, 0
s_add_u32 s56, s56, 1
s_mul_i32 s94, s28, 24576
v_accvgpr_write_b32 a243, 0
s_sub_u32 s67, s56, 9
v_exp_f32 v110, v110
v_exp_f32 v115, v115
s_add_u32 s94, s94, 65536
v_accvgpr_write_b32 a244, 0
s_min_u32 s56, s56, s67
v_cvt_pk_bf16_f32 v134, v108, v109
v_add_u32 v181, s94, v184
v_accvgpr_write_b32 a245, 0
s_sub_u32 s67, s56, 9
v_exp_f32 v116, v116
v_add_u32 v182, 65536, v184
v_accvgpr_write_b32 a246, 0
s_min_u32 s56, s56, s67
v_exp_f32 v111, v111
v_add_u32 v183, 114688, v184
v_accvgpr_write_b32 a247, 0
s_lshl_b32 s56, s56, 7
v_cvt_pk_bf16_f32 v135, v110, v111
v_exp_f32 v117, v117
s_mov_b32 s94, 7
L_loop:
v_cvt_pk_bf16_f32 v136, v112, v113
v_cvt_pk_bf16_f32 v137, v114, v115
v_mfma_f32_16x16x32_bf16 v[96:99], v[192:195], v[8:11], v[152:155]
v_exp_f32 v118, v118
v_mfma_f32_16x16x32_bf16 v[96:99], v[200:203], v[32:35], v[96:99]
v_cvt_pk_bf16_f32 v138, v116, v117
v_mfma_f32_16x16x32_bf16 v[96:99], v[208:211], v[56:59], v[96:99]
v_exp_f32 v119, v119
v_mfma_f32_16x16x32_bf16 v[96:99], v[216:219], v[80:83], v[96:99]
v_exp_f32 v120, v120
v_mfma_f32_16x16x32_bf16 v[104:107], v[192:195], v[12:15], v[156:159]
v_cvt_pk_bf16_f32 v139, v118, v119
v_mfma_f32_16x16x32_bf16 v[104:107], v[200:203], v[36:39], v[104:107]
v_exp_f32 v121, v121
v_mfma_f32_16x16x32_bf16 v[104:107], v[208:211], v[60:63], v[104:107]
v_exp_f32 v122, v122
v_mfma_f32_16x16x32_bf16 v[104:107], v[216:219], v[84:87], v[104:107]
v_cvt_pk_bf16_f32 v140, v120, v121
v_mfma_f32_16x16x32_bf16 v[100:103], v[196:199], v[8:11], v[152:155]
v_exp_f32 v123, v123
v_mfma_f32_16x16x32_bf16 v[100:103], v[204:207], v[32:35], v[100:103]
v_exp_f32 v124, v124
v_mfma_f32_16x16x32_bf16 v[100:103], v[212:215], v[56:59], v[100:103]
v_cvt_pk_bf16_f32 v141, v122, v123
v_mfma_f32_16x16x32_bf16 v[100:103], v[220:223], v[80:83], v[100:103]
v_exp_f32 v125, v125
v_mfma_f32_16x16x32_bf16 v[108:111], v[196:199], v[12:15], v[156:159]
v_exp_f32 v126, v126
v_mfma_f32_16x16x32_bf16 v[108:111], v[204:207], v[36:39], v[108:111]
v_cvt_pk_bf16_f32 v142, v124, v125
v_mfma_f32_16x16x32_bf16 v[108:111], v[212:215], v[60:63], v[108:111]
v_exp_f32 v127, v127
v_mfma_f32_16x16x32_bf16 v[108:111], v[220:223], v[84:87], v[108:111]
s_waitcnt vmcnt(8)
s_barrier
v_mfma_f32_16x16x32_bf16 a[128:131], a[192:195], v[128:131], a[128:131]
v_cvt_pk_bf16_f32 v143, v126, v127
v_mfma_f32_16x16x32_bf16 a[160:163], a[192:195], v[132:135], a[160:163]
ds_read_b64_tr_b16 a[192:193], v232 offset:0
ds_read_b64_tr_b16 a[194:195], v232 offset:4096
v_mfma_f32_16x16x32_bf16 a[132:135], a[196:199], v[128:131], a[132:135]
v_mfma_f32_16x16x32_bf16 a[164:167], a[196:199], v[132:135], a[164:167]
ds_read_b64_tr_b16 a[196:197], v233 offset:0
ds_read_b64_tr_b16 a[198:199], v233 offset:4096
v_mfma_f32_16x16x32_bf16 a[136:139], a[200:203], v[128:131], a[136:139]
v_mfma_f32_16x16x32_bf16 a[168:171], a[200:203], v[132:135], a[168:171]
ds_read_b64_tr_b16 a[200:201], v234 offset:0
ds_read_b64_tr_b16 a[202:203], v234 offset:4096
v_mfma_f32_16x16x32_bf16 a[140:143], a[204:207], v[128:131], a[140:143]
v_mfma_f32_16x16x32_bf16 a[172:175], a[204:207], v[132:135], a[172:175]
ds_read_b64_tr_b16 a[204:205], v235 offset:0
ds_read_b64_tr_b16 a[206:207], v235 offset:4096
v_mfma_f32_16x16x32_bf16 a[144:147], a[208:211], v[128:131], a[144:147]
v_exp_f32 v96, v96
v_mfma_f32_16x16x32_bf16 a[176:179], a[208:211], v[132:135], a[176:179]
ds_read_b64_tr_b16 a[208:209], v236 offset:0
ds_read_b64_tr_b16 a[210:211], v236 offset:4096
v_mfma_f32_16x16x32_bf16 a[148:151], a[212:215], v[128:131], a[148:151]
v_exp_f32 v97, v97
v_mfma_f32_16x16x32_bf16 a[180:183], a[212:215], v[132:135], a[180:183]
ds_read_b64_tr_b16 a[212:213], v237 offset:0
ds_read_b64_tr_b16 a[214:215], v237 offset:4096
v_mfma_f32_16x16x32_bf16 a[152:155], a[216:219], v[128:131], a[152:155]
v_mfma_f32_16x16x32_bf16 a[184:187], a[216:219], v[132:135], a[184:187]
ds_read_b64_tr_b16 a[216:217], v238 offset:0
ds_read_b64_tr_b16 a[218:219], v238 offset:4096
v_mfma_f32_16x16x32_bf16 a[156:159], a[220:223], v[128:131], a[156:159]
v_mfma_f32_16x16x32_bf16 a[188:191], a[220:223], v[132:135], a[188:191]
ds_read_b64_tr_b16 a[220:221], v239 offset:0
ds_read_b64_tr_b16 a[222:223], v239 offset:4096
v_mfma_f32_16x16x32_bf16 a[240:243], a[248:251], v[128:131], a[240:243]
v_mfma_f32_16x16x32_bf16 a[244:247], a[248:251], v[132:135], a[244:247]
s_add_u32 m0, s43, 65536
s_add_u32 s35, s32, 4096
v_mfma_f32_16x16x32_bf16 v[112:115], v[192:195], v[16:19], v[160:163]
v_exp_f32 v98, v98
v_mfma_f32_16x16x32_bf16 v[112:115], v[200:203], v[40:43], v[112:115]
v_cvt_pk_bf16_f32 v128, v96, v97
v_mfma_f32_16x16x32_bf16 v[112:115], v[208:211], v[64:67], v[112:115]
buffer_load_dwordx4 v248, s[12:15], s32 offen offset:0 nt lds
v_mfma_f32_16x16x32_bf16 v[112:115], v[216:219], v[88:91], v[112:115]
v_exp_f32 v99, v99
v_mfma_f32_16x16x32_bf16 v[120:123], v[192:195], v[20:23], v[164:167]
v_exp_f32 v100, v100
v_mfma_f32_16x16x32_bf16 v[120:123], v[200:203], v[44:47], v[120:123]
ds_read_b128 v[192:195], v224 offset:0
v_cvt_pk_bf16_f32 v129, v98, v99
v_mfma_f32_16x16x32_bf16 v[120:123], v[208:211], v[68:71], v[120:123]
v_exp_f32 v101, v101
v_mfma_f32_16x16x32_bf16 v[120:123], v[216:219], v[92:95], v[120:123]
ds_read_b128 v[200:203], v225 offset:0
v_mfma_f32_16x16x32_bf16 v[116:119], v[196:199], v[16:19], v[160:163]
buffer_load_dwordx4 v249, s[12:15], s32 offen offset:1024 nt lds
v_mfma_f32_16x16x32_bf16 v[116:119], v[204:207], v[40:43], v[116:119]
ds_read_b128 v[208:211], v226 offset:0
v_mfma_f32_16x16x32_bf16 v[116:119], v[212:215], v[64:67], v[116:119]
v_exp_f32 v102, v102
v_mfma_f32_16x16x32_bf16 v[116:119], v[220:223], v[88:91], v[116:119]
ds_read_b128 v[216:219], v227 offset:0
v_cvt_pk_bf16_f32 v130, v100, v101
v_mfma_f32_16x16x32_bf16 v[124:127], v[196:199], v[20:23], v[164:167]
v_exp_f32 v103, v103
v_mfma_f32_16x16x32_bf16 v[124:127], v[204:207], v[44:47], v[124:127]
ds_read_b128 v[196:199], v224 offset:4096
v_mfma_f32_16x16x32_bf16 v[124:127], v[212:215], v[68:71], v[124:127]
buffer_load_dwordx4 v250, s[12:15], s32 offen offset:2048 nt lds
v_mfma_f32_16x16x32_bf16 v[124:127], v[220:223], v[92:95], v[124:127]
ds_read_b128 v[204:207], v225 offset:4096
s_waitcnt lgkmcnt(6)
v_mfma_f32_16x16x32_bf16 a[0:3], a[192:195], v[136:139], a[0:3]
v_exp_f32 v104, v104
v_mfma_f32_16x16x32_bf16 a[32:35], a[192:195], v[140:143], a[32:35]
ds_read_b128 v[212:215], v226 offset:4096
v_cvt_pk_bf16_f32 v131, v102, v103
v_mfma_f32_16x16x32_bf16 a[4:7], a[196:199], v[136:139], a[4:7]
v_exp_f32 v105, v105
v_mfma_f32_16x16x32_bf16 a[36:39], a[196:199], v[140:143], a[36:39]
ds_read_b128 v[220:223], v227 offset:4096
v_mfma_f32_16x16x32_bf16 a[8:11], a[200:203], v[136:139], a[8:11]
buffer_load_dwordx4 v251, s[12:15], s32 offen offset:3072 nt lds
v_mfma_f32_16x16x32_bf16 a[40:43], a[200:203], v[140:143], a[40:43]
v_exp_f32 v106, v106
v_mfma_f32_16x16x32_bf16 a[12:15], a[204:207], v[136:139], a[12:15]
v_cvt_pk_bf16_f32 v132, v104, v105
v_mfma_f32_16x16x32_bf16 a[44:47], a[204:207], v[140:143], a[44:47]
v_exp_f32 v107, v107
v_mfma_f32_16x16x32_bf16 a[16:19], a[208:211], v[136:139], a[16:19]
v_exp_f32 v108, v108
v_mfma_f32_16x16x32_bf16 a[48:51], a[208:211], v[140:143], a[48:51]
v_cvt_pk_bf16_f32 v133, v106, v107
v_mfma_f32_16x16x32_bf16 a[20:23], a[212:215], v[136:139], a[20:23]
v_exp_f32 v109, v109
v_mfma_f32_16x16x32_bf16 a[52:55], a[212:215], v[140:143], a[52:55]
v_exp_f32 v110, v110
v_mfma_f32_16x16x32_bf16 a[24:27], a[216:219], v[136:139], a[24:27]
v_cvt_pk_bf16_f32 v134, v108, v109
v_mfma_f32_16x16x32_bf16 a[56:59], a[216:219], v[140:143], a[56:59]
v_exp_f32 v112, v112
v_mfma_f32_16x16x32_bf16 a[28:31], a[220:223], v[136:139], a[28:31]
v_exp_f32 v111, v111
v_mfma_f32_16x16x32_bf16 a[60:63], a[220:223], v[140:143], a[60:63]
v_cvt_pk_bf16_f32 v135, v110, v111
v_mfma_f32_16x16x32_bf16 a[224:227], a[248:251], v[136:139], a[224:227]
v_exp_f32 v113, v113
v_mfma_f32_16x16x32_bf16 a[228:231], a[248:251], v[140:143], a[228:231]
s_add_u32 m0, s43, 69632
s_waitcnt lgkmcnt(0)
v_mfma_f32_16x16x32_bf16 v[96:99], v[192:195], v[0:3], v[144:147]
s_add_u32 s32, s32, 8192
v_mfma_f32_16x16x32_bf16 v[96:99], v[200:203], v[24:27], v[96:99]
v_exp_f32 v114, v114
v_mfma_f32_16x16x32_bf16 v[96:99], v[208:211], v[48:51], v[96:99]
v_cvt_pk_bf16_f32 v136, v112, v113
v_mfma_f32_16x16x32_bf16 v[96:99], v[216:219], v[72:75], v[96:99]
v_exp_f32 v115, v115
v_mfma_f32_16x16x32_bf16 v[104:107], v[192:195], v[4:7], v[148:151]
v_exp_f32 v116, v116
v_mfma_f32_16x16x32_bf16 v[104:107], v[200:203], v[28:31], v[104:107]
v_cvt_pk_bf16_f32 v137, v114, v115
v_mfma_f32_16x16x32_bf16 v[104:107], v[208:211], v[52:55], v[104:107]
v_exp_f32 v117, v117
v_mfma_f32_16x16x32_bf16 v[104:107], v[216:219], v[76:79], v[104:107]
v_exp_f32 v118, v118
v_mfma_f32_16x16x32_bf16 v[100:103], v[196:199], v[0:3], v[144:147]
v_cvt_pk_bf16_f32 v138, v116, v117
v_mfma_f32_16x16x32_bf16 v[100:103], v[204:207], v[24:27], v[100:103]
v_exp_f32 v119, v119
v_mfma_f32_16x16x32_bf16 v[100:103], v[212:215], v[48:51], v[100:103]
v_exp_f32 v120, v120
v_mfma_f32_16x16x32_bf16 v[100:103], v[220:223], v[72:75], v[100:103]
v_cvt_pk_bf16_f32 v139, v118, v119
v_mfma_f32_16x16x32_bf16 v[108:111], v[196:199], v[4:7], v[148:151]
s_waitcnt vmcnt(3)
v_mfma_f32_16x16x32_bf16 v[108:111], v[204:207], v[28:31], v[108:111]
v_exp_f32 v121, v121
v_mfma_f32_16x16x32_bf16 v[108:111], v[212:215], v[52:55], v[108:111]
buffer_load_dwordx4 v248, s[12:15], s35 offen offset:0 nt lds
v_mfma_f32_16x16x32_bf16 v[108:111], v[220:223], v[76:79], v[108:111]
v_exp_f32 v122, v122
v_mfma_f32_16x16x32_bf16 a[64:67], a[192:195], v[128:131], a[64:67]
v_cvt_pk_bf16_f32 v140, v120, v121
v_mfma_f32_16x16x32_bf16 a[96:99], a[192:195], v[132:135], a[96:99]
v_exp_f32 v123, v123
v_mfma_f32_16x16x32_bf16 a[68:71], a[196:199], v[128:131], a[68:71]
v_exp_f32 v124, v124
v_mfma_f32_16x16x32_bf16 a[100:103], a[196:199], v[132:135], a[100:103]
v_cvt_pk_bf16_f32 v141, v122, v123
v_mfma_f32_16x16x32_bf16 a[72:75], a[200:203], v[128:131], a[72:75]
buffer_load_dwordx4 v249, s[12:15], s35 offen offset:1024 nt lds
v_mfma_f32_16x16x32_bf16 a[104:107], a[200:203], v[132:135], a[104:107]
v_exp_f32 v125, v125
v_mfma_f32_16x16x32_bf16 a[76:79], a[204:207], v[128:131], a[76:79]
v_exp_f32 v126, v126
v_mfma_f32_16x16x32_bf16 a[108:111], a[204:207], v[132:135], a[108:111]
v_exp_f32 v96, v96
v_mfma_f32_16x16x32_bf16 a[80:83], a[208:211], v[128:131], a[80:83]
v_exp_f32 v97, v97
v_mfma_f32_16x16x32_bf16 a[112:115], a[208:211], v[132:135], a[112:115]
v_exp_f32 v98, v98
v_mfma_f32_16x16x32_bf16 a[84:87], a[212:215], v[128:131], a[84:87]
buffer_load_dwordx4 v250, s[12:15], s35 offen offset:2048 nt lds
v_cvt_pk_bf16_f32 v142, v124, v125
v_mfma_f32_16x16x32_bf16 a[116:119], a[212:215], v[132:135], a[116:119]
v_exp_f32 v99, v99
v_mfma_f32_16x16x32_bf16 a[88:91], a[216:219], v[128:131], a[88:91]
v_exp_f32 v100, v100
v_mfma_f32_16x16x32_bf16 a[120:123], a[216:219], v[132:135], a[120:123]
v_exp_f32 v127, v127
v_mfma_f32_16x16x32_bf16 a[92:95], a[220:223], v[128:131], a[92:95]
v_cvt_pk_bf16_f32 v143, v126, v127
v_mfma_f32_16x16x32_bf16 a[124:127], a[220:223], v[132:135], a[124:127]
buffer_load_dwordx4 v251, s[12:15], s35 offen offset:3072 nt lds
v_mfma_f32_16x16x32_bf16 a[232:235], a[248:251], v[128:131], a[232:235]
v_exp_f32 v101, v101
v_mfma_f32_16x16x32_bf16 a[236:239], a[248:251], v[132:135], a[236:239]
v_cvt_pk_bf16_f32 v128, v96, v97
v_cvt_pk_bf16_f32 v129, v98, v99
v_mfma_f32_16x16x32_bf16 v[112:115], v[192:195], v[8:11], v[152:155]
v_exp_f32 v102, v102
v_mfma_f32_16x16x32_bf16 v[112:115], v[200:203], v[32:35], v[112:115]
v_cvt_pk_bf16_f32 v130, v100, v101
v_mfma_f32_16x16x32_bf16 v[112:115], v[208:211], v[56:59], v[112:115]
v_exp_f32 v103, v103
v_mfma_f32_16x16x32_bf16 v[112:115], v[216:219], v[80:83], v[112:115]
v_exp_f32 v104, v104
v_mfma_f32_16x16x32_bf16 v[120:123], v[192:195], v[12:15], v[156:159]
v_cvt_pk_bf16_f32 v131, v102, v103
v_mfma_f32_16x16x32_bf16 v[120:123], v[200:203], v[36:39], v[120:123]
v_exp_f32 v105, v105
v_mfma_f32_16x16x32_bf16 v[120:123], v[208:211], v[60:63], v[120:123]
v_exp_f32 v106, v106
v_mfma_f32_16x16x32_bf16 v[120:123], v[216:219], v[84:87], v[120:123]
v_cvt_pk_bf16_f32 v132, v104, v105
v_mfma_f32_16x16x32_bf16 v[116:119], v[196:199], v[8:11], v[152:155]
v_exp_f32 v107, v107
v_mfma_f32_16x16x32_bf16 v[116:119], v[204:207], v[32:35], v[116:119]
v_exp_f32 v108, v108
v_mfma_f32_16x16x32_bf16 v[116:119], v[212:215], v[56:59], v[116:119]
v_cvt_pk_bf16_f32 v133, v106, v107
v_mfma_f32_16x16x32_bf16 v[116:119], v[220:223], v[80:83], v[116:119]
v_exp_f32 v109, v109
v_mfma_f32_16x16x32_bf16 v[124:127], v[196:199], v[12:15], v[156:159]
v_exp_f32 v110, v110
v_mfma_f32_16x16x32_bf16 v[124:127], v[204:207], v[36:39], v[124:127]
v_cvt_pk_bf16_f32 v134, v108, v109
v_mfma_f32_16x16x32_bf16 v[124:127], v[212:215], v[60:63], v[124:127]
v_exp_f32 v111, v111
v_mfma_f32_16x16x32_bf16 v[124:127], v[220:223], v[84:87], v[124:127]
s_waitcnt vmcnt(8)
s_barrier
v_mfma_f32_16x16x32_bf16 a[128:131], a[192:195], v[136:139], a[128:131]
v_cvt_pk_bf16_f32 v135, v110, v111
v_mfma_f32_16x16x32_bf16 a[160:163], a[192:195], v[140:143], a[160:163]
ds_read_b64_tr_b16 a[192:193], v232 offset:32768
ds_read_b64_tr_b16 a[194:195], v232 offset:36864
v_mfma_f32_16x16x32_bf16 a[132:135], a[196:199], v[136:139], a[132:135]
v_mfma_f32_16x16x32_bf16 a[164:167], a[196:199], v[140:143], a[164:167]
ds_read_b64_tr_b16 a[196:197], v233 offset:32768
ds_read_b64_tr_b16 a[198:199], v233 offset:36864
v_mfma_f32_16x16x32_bf16 a[136:139], a[200:203], v[136:139], a[136:139]
v_mfma_f32_16x16x32_bf16 a[168:171], a[200:203], v[140:143], a[168:171]
ds_read_b64_tr_b16 a[200:201], v234 offset:32768
ds_read_b64_tr_b16 a[202:203], v234 offset:36864
v_mfma_f32_16x16x32_bf16 a[140:143], a[204:207], v[136:139], a[140:143]
v_mfma_f32_16x16x32_bf16 a[172:175], a[204:207], v[140:143], a[172:175]
ds_read_b64_tr_b16 a[204:205], v235 offset:32768
ds_read_b64_tr_b16 a[206:207], v235 offset:36864
v_mfma_f32_16x16x32_bf16 a[144:147], a[208:211], v[136:139], a[144:147]
v_exp_f32 v112, v112
v_mfma_f32_16x16x32_bf16 a[176:179], a[208:211], v[140:143], a[176:179]
ds_read_b64_tr_b16 a[208:209], v236 offset:32768
ds_read_b64_tr_b16 a[210:211], v236 offset:36864
v_mfma_f32_16x16x32_bf16 a[148:151], a[212:215], v[136:139], a[148:151]
v_exp_f32 v113, v113
v_mfma_f32_16x16x32_bf16 a[180:183], a[212:215], v[140:143], a[180:183]
ds_read_b64_tr_b16 a[212:213], v237 offset:32768
ds_read_b64_tr_b16 a[214:215], v237 offset:36864
v_mfma_f32_16x16x32_bf16 a[152:155], a[216:219], v[136:139], a[152:155]
v_mfma_f32_16x16x32_bf16 a[184:187], a[216:219], v[140:143], a[184:187]
ds_read_b64_tr_b16 a[216:217], v238 offset:32768
ds_read_b64_tr_b16 a[218:219], v238 offset:36864
v_mfma_f32_16x16x32_bf16 a[156:159], a[220:223], v[136:139], a[156:159]
v_mfma_f32_16x16x32_bf16 a[188:191], a[220:223], v[140:143], a[188:191]
ds_read_b64_tr_b16 a[220:221], v239 offset:32768
ds_read_b64_tr_b16 a[222:223], v239 offset:36864
v_mfma_f32_16x16x32_bf16 a[240:243], a[248:251], v[136:139], a[240:243]
v_mfma_f32_16x16x32_bf16 a[244:247], a[248:251], v[140:143], a[244:247]
s_add_u32 m0, s43, 98304
s_add_u32 s35, s32, 4096
v_mfma_f32_16x16x32_bf16 v[96:99], v[192:195], v[16:19], v[160:163]
v_exp_f32 v114, v114
v_mfma_f32_16x16x32_bf16 v[96:99], v[200:203], v[40:43], v[96:99]
v_cvt_pk_bf16_f32 v136, v112, v113
v_mfma_f32_16x16x32_bf16 v[96:99], v[208:211], v[64:67], v[96:99]
buffer_load_dwordx4 v248, s[12:15], s32 offen offset:0 nt lds
v_mfma_f32_16x16x32_bf16 v[96:99], v[216:219], v[88:91], v[96:99]
v_exp_f32 v115, v115
v_mfma_f32_16x16x32_bf16 v[104:107], v[192:195], v[20:23], v[164:167]
v_exp_f32 v116, v116
v_mfma_f32_16x16x32_bf16 v[104:107], v[200:203], v[44:47], v[104:107]
ds_read_b128 v[192:195], v224 offset:32768
v_cvt_pk_bf16_f32 v137, v114, v115
v_mfma_f32_16x16x32_bf16 v[104:107], v[208:211], v[68:71], v[104:107]
v_exp_f32 v117, v117
v_mfma_f32_16x16x32_bf16 v[104:107], v[216:219], v[92:95], v[104:107]
ds_read_b128 v[200:203], v225 offset:32768
v_mfma_f32_16x16x32_bf16 v[100:103], v[196:199], v[16:19], v[160:163]
buffer_load_dwordx4 v249, s[12:15], s32 offen offset:1024 nt lds
v_mfma_f32_16x16x32_bf16 v[100:103], v[204:207], v[40:43], v[100:103]
ds_read_b128 v[208:211], v226 offset:32768
v_mfma_f32_16x16x32_bf16 v[100:103], v[212:215], v[64:67], v[100:103]
v_exp_f32 v118, v118
v_mfma_f32_16x16x32_bf16 v[100:103], v[220:223], v[88:91], v[100:103]
ds_read_b128 v[216:219], v227 offset:32768
v_cvt_pk_bf16_f32 v138, v116, v117
v_mfma_f32_16x16x32_bf16 v[108:111], v[196:199], v[20:23], v[164:167]
v_exp_f32 v119, v119
v_mfma_f32_16x16x32_bf16 v[108:111], v[204:207], v[44:47], v[108:111]
ds_read_b128 v[196:199], v224 offset:36864
v_mfma_f32_16x16x32_bf16 v[108:111], v[212:215], v[68:71], v[108:111]
buffer_load_dwordx4 v250, s[12:15], s32 offen offset:2048 nt lds
v_mfma_f32_16x16x32_bf16 v[108:111], v[220:223], v[92:95], v[108:111]
ds_read_b128 v[204:207], v225 offset:36864
s_waitcnt lgkmcnt(6)
v_mfma_f32_16x16x32_bf16 a[0:3], a[192:195], v[128:131], a[0:3]
v_exp_f32 v120, v120
v_mfma_f32_16x16x32_bf16 a[32:35], a[192:195], v[132:135], a[32:35]
ds_read_b128 v[212:215], v226 offset:36864
v_cvt_pk_bf16_f32 v139, v118, v119
v_mfma_f32_16x16x32_bf16 a[4:7], a[196:199], v[128:131], a[4:7]
v_exp_f32 v121, v121
v_mfma_f32_16x16x32_bf16 a[36:39], a[196:199], v[132:135], a[36:39]
ds_read_b128 v[220:223], v227 offset:36864
v_mfma_f32_16x16x32_bf16 a[8:11], a[200:203], v[128:131], a[8:11]
buffer_load_dwordx4 v251, s[12:15], s32 offen offset:3072 nt lds
v_mfma_f32_16x16x32_bf16 a[40:43], a[200:203], v[132:135], a[40:43]
v_exp_f32 v122, v122
v_mfma_f32_16x16x32_bf16 a[12:15], a[204:207], v[128:131], a[12:15]
v_cvt_pk_bf16_f32 v140, v120, v121
v_mfma_f32_16x16x32_bf16 a[44:47], a[204:207], v[132:135], a[44:47]
v_exp_f32 v123, v123
v_mfma_f32_16x16x32_bf16 a[16:19], a[208:211], v[128:131], a[16:19]
v_exp_f32 v124, v124
v_mfma_f32_16x16x32_bf16 a[48:51], a[208:211], v[132:135], a[48:51]
v_cvt_pk_bf16_f32 v141, v122, v123
v_mfma_f32_16x16x32_bf16 a[20:23], a[212:215], v[128:131], a[20:23]
v_exp_f32 v125, v125
v_mfma_f32_16x16x32_bf16 a[52:55], a[212:215], v[132:135], a[52:55]
v_exp_f32 v126, v126
v_mfma_f32_16x16x32_bf16 a[24:27], a[216:219], v[128:131], a[24:27]
v_cvt_pk_bf16_f32 v142, v124, v125
v_mfma_f32_16x16x32_bf16 a[56:59], a[216:219], v[132:135], a[56:59]
v_exp_f32 v96, v96
v_mfma_f32_16x16x32_bf16 a[28:31], a[220:223], v[128:131], a[28:31]
v_exp_f32 v127, v127
v_mfma_f32_16x16x32_bf16 a[60:63], a[220:223], v[132:135], a[60:63]
v_cvt_pk_bf16_f32 v143, v126, v127
v_mfma_f32_16x16x32_bf16 a[224:227], a[248:251], v[128:131], a[224:227]
v_exp_f32 v97, v97
v_mfma_f32_16x16x32_bf16 a[228:231], a[248:251], v[132:135], a[228:231]
s_add_u32 m0, s43, 102400
s_waitcnt lgkmcnt(0)
v_mfma_f32_16x16x32_bf16 v[112:115], v[192:195], v[0:3], v[144:147]
s_add_u32 s32, s32, 8192
v_mfma_f32_16x16x32_bf16 v[112:115], v[200:203], v[24:27], v[112:115]
v_exp_f32 v98, v98
v_mfma_f32_16x16x32_bf16 v[112:115], v[208:211], v[48:51], v[112:115]
v_cvt_pk_bf16_f32 v128, v96, v97
v_mfma_f32_16x16x32_bf16 v[112:115], v[216:219], v[72:75], v[112:115]
v_exp_f32 v99, v99
v_mfma_f32_16x16x32_bf16 v[120:123], v[192:195], v[4:7], v[148:151]
v_exp_f32 v100, v100
v_mfma_f32_16x16x32_bf16 v[120:123], v[200:203], v[28:31], v[120:123]
v_cvt_pk_bf16_f32 v129, v98, v99
v_mfma_f32_16x16x32_bf16 v[120:123], v[208:211], v[52:55], v[120:123]
v_exp_f32 v101, v101
v_mfma_f32_16x16x32_bf16 v[120:123], v[216:219], v[76:79], v[120:123]
v_exp_f32 v102, v102
v_mfma_f32_16x16x32_bf16 v[116:119], v[196:199], v[0:3], v[144:147]
v_cvt_pk_bf16_f32 v130, v100, v101
v_mfma_f32_16x16x32_bf16 v[116:119], v[204:207], v[24:27], v[116:119]
v_exp_f32 v103, v103
v_mfma_f32_16x16x32_bf16 v[116:119], v[212:215], v[48:51], v[116:119]
v_exp_f32 v104, v104
v_mfma_f32_16x16x32_bf16 v[116:119], v[220:223], v[72:75], v[116:119]
v_cvt_pk_bf16_f32 v131, v102, v103
v_mfma_f32_16x16x32_bf16 v[124:127], v[196:199], v[4:7], v[148:151]
s_waitcnt vmcnt(3)
v_mfma_f32_16x16x32_bf16 v[124:127], v[204:207], v[28:31], v[124:127]
v_exp_f32 v105, v105
v_mfma_f32_16x16x32_bf16 v[124:127], v[212:215], v[52:55], v[124:127]
buffer_load_dwordx4 v248, s[12:15], s35 offen offset:0 nt lds
v_mfma_f32_16x16x32_bf16 v[124:127], v[220:223], v[76:79], v[124:127]
v_exp_f32 v106, v106
v_mfma_f32_16x16x32_bf16 a[64:67], a[192:195], v[136:139], a[64:67]
v_cvt_pk_bf16_f32 v132, v104, v105
v_mfma_f32_16x16x32_bf16 a[96:99], a[192:195], v[140:143], a[96:99]
v_exp_f32 v107, v107
v_mfma_f32_16x16x32_bf16 a[68:71], a[196:199], v[136:139], a[68:71]
v_exp_f32 v108, v108
v_mfma_f32_16x16x32_bf16 a[100:103], a[196:199], v[140:143], a[100:103]
v_cvt_pk_bf16_f32 v133, v106, v107
v_mfma_f32_16x16x32_bf16 a[72:75], a[200:203], v[136:139], a[72:75]
buffer_load_dwordx4 v249, s[12:15], s35 offen offset:1024 nt lds
v_mfma_f32_16x16x32_bf16 a[104:107], a[200:203], v[140:143], a[104:107]
v_exp_f32 v109, v109
v_mfma_f32_16x16x32_bf16 a[76:79], a[204:207], v[136:139], a[76:79]
v_exp_f32 v110, v110
v_mfma_f32_16x16x32_bf16 a[108:111], a[204:207], v[140:143], a[108:111]
v_exp_f32 v112, v112
v_mfma_f32_16x16x32_bf16 a[80:83], a[208:211], v[136:139], a[80:83]
v_exp_f32 v113, v113
v_mfma_f32_16x16x32_bf16 a[112:115], a[208:211], v[140:143], a[112:115]
v_exp_f32 v114, v114
v_mfma_f32_16x16x32_bf16 a[84:87], a[212:215], v[136:139], a[84:87]
buffer_load_dwordx4 v250, s[12:15], s35 offen offset:2048 nt lds
v_cvt_pk_bf16_f32 v134, v108, v109
v_mfma_f32_16x16x32_bf16 a[116:119], a[212:215], v[140:143], a[116:119]
v_exp_f32 v115, v115
v_mfma_f32_16x16x32_bf16 a[88:91], a[216:219], v[136:139], a[88:91]
v_exp_f32 v116, v116
v_mfma_f32_16x16x32_bf16 a[120:123], a[216:219], v[140:143], a[120:123]
v_exp_f32 v111, v111
v_mfma_f32_16x16x32_bf16 a[92:95], a[220:223], v[136:139], a[92:95]
v_cvt_pk_bf16_f32 v135, v110, v111
v_mfma_f32_16x16x32_bf16 a[124:127], a[220:223], v[140:143], a[124:127]
buffer_load_dwordx4 v251, s[12:15], s35 offen offset:3072 nt lds
v_mfma_f32_16x16x32_bf16 a[232:235], a[248:251], v[136:139], a[232:235]
v_exp_f32 v117, v117
v_mfma_f32_16x16x32_bf16 a[236:239], a[248:251], v[140:143], a[236:239]
v_cvt_pk_bf16_f32 v136, v112, v113
v_cvt_pk_bf16_f32 v137, v114, v115
v_mfma_f32_16x16x32_bf16 v[96:99], v[192:195], v[8:11], v[152:155]
v_exp_f32 v118, v118
v_mfma_f32_16x16x32_bf16 v[96:99], v[200:203], v[32:35], v[96:99]
v_cvt_pk_bf16_f32 v138, v116, v117
v_mfma_f32_16x16x32_bf16 v[96:99], v[208:211], v[56:59], v[96:99]
v_exp_f32 v119, v119
v_mfma_f32_16x16x32_bf16 v[96:99], v[216:219], v[80:83], v[96:99]
v_exp_f32 v120, v120
v_mfma_f32_16x16x32_bf16 v[104:107], v[192:195], v[12:15], v[156:159]
v_cvt_pk_bf16_f32 v139, v118, v119
v_mfma_f32_16x16x32_bf16 v[104:107], v[200:203], v[36:39], v[104:107]
v_exp_f32 v121, v121
v_mfma_f32_16x16x32_bf16 v[104:107], v[208:211], v[60:63], v[104:107]
v_exp_f32 v122, v122
v_mfma_f32_16x16x32_bf16 v[104:107], v[216:219], v[84:87], v[104:107]
v_cvt_pk_bf16_f32 v140, v120, v121
v_mfma_f32_16x16x32_bf16 v[100:103], v[196:199], v[8:11], v[152:155]
v_exp_f32 v123, v123
v_mfma_f32_16x16x32_bf16 v[100:103], v[204:207], v[32:35], v[100:103]
v_exp_f32 v124, v124
v_mfma_f32_16x16x32_bf16 v[100:103], v[212:215], v[56:59], v[100:103]
v_cvt_pk_bf16_f32 v141, v122, v123
v_mfma_f32_16x16x32_bf16 v[100:103], v[220:223], v[80:83], v[100:103]
v_exp_f32 v125, v125
v_mfma_f32_16x16x32_bf16 v[108:111], v[196:199], v[12:15], v[156:159]
v_exp_f32 v126, v126
v_mfma_f32_16x16x32_bf16 v[108:111], v[204:207], v[36:39], v[108:111]
v_cvt_pk_bf16_f32 v142, v124, v125
v_mfma_f32_16x16x32_bf16 v[108:111], v[212:215], v[60:63], v[108:111]
v_exp_f32 v127, v127
v_mfma_f32_16x16x32_bf16 v[108:111], v[220:223], v[84:87], v[108:111]
s_waitcnt vmcnt(8)
s_barrier
v_mfma_f32_16x16x32_bf16 a[128:131], a[192:195], v[128:131], a[128:131]
v_cvt_pk_bf16_f32 v143, v126, v127
v_mfma_f32_16x16x32_bf16 a[160:163], a[192:195], v[132:135], a[160:163]
ds_read_b64_tr_b16 a[192:193], v240 offset:0
ds_read_b64_tr_b16 a[194:195], v240 offset:4096
v_mfma_f32_16x16x32_bf16 a[132:135], a[196:199], v[128:131], a[132:135]
v_mfma_f32_16x16x32_bf16 a[164:167], a[196:199], v[132:135], a[164:167]
ds_read_b64_tr_b16 a[196:197], v241 offset:0
ds_read_b64_tr_b16 a[198:199], v241 offset:4096
v_mfma_f32_16x16x32_bf16 a[136:139], a[200:203], v[128:131], a[136:139]
v_mfma_f32_16x16x32_bf16 a[168:171], a[200:203], v[132:135], a[168:171]
ds_read_b64_tr_b16 a[200:201], v242 offset:0
ds_read_b64_tr_b16 a[202:203], v242 offset:4096
v_mfma_f32_16x16x32_bf16 a[140:143], a[204:207], v[128:131], a[140:143]
v_mfma_f32_16x16x32_bf16 a[172:175], a[204:207], v[132:135], a[172:175]
ds_read_b64_tr_b16 a[204:205], v243 offset:0
ds_read_b64_tr_b16 a[206:207], v243 offset:4096
v_mfma_f32_16x16x32_bf16 a[144:147], a[208:211], v[128:131], a[144:147]
v_exp_f32 v96, v96
v_mfma_f32_16x16x32_bf16 a[176:179], a[208:211], v[132:135], a[176:179]
ds_read_b64_tr_b16 a[208:209], v244 offset:0
ds_read_b64_tr_b16 a[210:211], v244 offset:4096
v_mfma_f32_16x16x32_bf16 a[148:151], a[212:215], v[128:131], a[148:151]
v_exp_f32 v97, v97
v_mfma_f32_16x16x32_bf16 a[180:183], a[212:215], v[132:135], a[180:183]
ds_read_b64_tr_b16 a[212:213], v245 offset:0
ds_read_b64_tr_b16 a[214:215], v245 offset:4096
v_mfma_f32_16x16x32_bf16 a[152:155], a[216:219], v[128:131], a[152:155]
v_mfma_f32_16x16x32_bf16 a[184:187], a[216:219], v[132:135], a[184:187]
ds_read_b64_tr_b16 a[216:217], v246 offset:0
ds_read_b64_tr_b16 a[218:219], v246 offset:4096
v_mfma_f32_16x16x32_bf16 a[156:159], a[220:223], v[128:131], a[156:159]
v_mfma_f32_16x16x32_bf16 a[188:191], a[220:223], v[132:135], a[188:191]
ds_read_b64_tr_b16 a[220:221], v247 offset:0
ds_read_b64_tr_b16 a[222:223], v247 offset:4096
v_mfma_f32_16x16x32_bf16 a[240:243], a[248:251], v[128:131], a[240:243]
v_mfma_f32_16x16x32_bf16 a[244:247], a[248:251], v[132:135], a[244:247]
s_add_u32 m0, s43, 0
s_add_u32 s35, s32, 4096
v_mfma_f32_16x16x32_bf16 v[112:115], v[192:195], v[16:19], v[160:163]
v_exp_f32 v98, v98
v_mfma_f32_16x16x32_bf16 v[112:115], v[200:203], v[40:43], v[112:115]
v_cvt_pk_bf16_f32 v128, v96, v97
v_mfma_f32_16x16x32_bf16 v[112:115], v[208:211], v[64:67], v[112:115]
buffer_load_dwordx4 v248, s[12:15], s32 offen offset:0 nt lds
v_mfma_f32_16x16x32_bf16 v[112:115], v[216:219], v[88:91], v[112:115]
v_exp_f32 v99, v99
v_mfma_f32_16x16x32_bf16 v[120:123], v[192:195], v[20:23], v[164:167]
v_exp_f32 v100, v100
v_mfma_f32_16x16x32_bf16 v[120:123], v[200:203], v[44:47], v[120:123]
ds_read_b128 v[192:195], v228 offset:0
v_cvt_pk_bf16_f32 v129, v98, v99
v_mfma_f32_16x16x32_bf16 v[120:123], v[208:211], v[68:71], v[120:123]
v_exp_f32 v101, v101
v_mfma_f32_16x16x32_bf16 v[120:123], v[216:219], v[92:95], v[120:123]
ds_read_b128 v[200:203], v229 offset:0
v_mfma_f32_16x16x32_bf16 v[116:119], v[196:199], v[16:19], v[160:163]
buffer_load_dwordx4 v249, s[12:15], s32 offen offset:1024 nt lds
v_mfma_f32_16x16x32_bf16 v[116:119], v[204:207], v[40:43], v[116:119]
ds_read_b128 v[208:211], v230 offset:0
v_mfma_f32_16x16x32_bf16 v[116:119], v[212:215], v[64:67], v[116:119]
v_exp_f32 v102, v102
v_mfma_f32_16x16x32_bf16 v[116:119], v[220:223], v[88:91], v[116:119]
ds_read_b128 v[216:219], v231 offset:0
v_cvt_pk_bf16_f32 v130, v100, v101
v_mfma_f32_16x16x32_bf16 v[124:127], v[196:199], v[20:23], v[164:167]
v_exp_f32 v103, v103
v_mfma_f32_16x16x32_bf16 v[124:127], v[204:207], v[44:47], v[124:127]
ds_read_b128 v[196:199], v228 offset:4096
v_mfma_f32_16x16x32_bf16 v[124:127], v[212:215], v[68:71], v[124:127]
buffer_load_dwordx4 v250, s[12:15], s32 offen offset:2048 nt lds
v_mfma_f32_16x16x32_bf16 v[124:127], v[220:223], v[92:95], v[124:127]
ds_read_b128 v[204:207], v229 offset:4096
s_waitcnt lgkmcnt(6)
v_mfma_f32_16x16x32_bf16 a[0:3], a[192:195], v[136:139], a[0:3]
v_exp_f32 v104, v104
v_mfma_f32_16x16x32_bf16 a[32:35], a[192:195], v[140:143], a[32:35]
ds_read_b128 v[212:215], v230 offset:4096
v_cvt_pk_bf16_f32 v131, v102, v103
v_mfma_f32_16x16x32_bf16 a[4:7], a[196:199], v[136:139], a[4:7]
v_exp_f32 v105, v105
v_mfma_f32_16x16x32_bf16 a[36:39], a[196:199], v[140:143], a[36:39]
ds_read_b128 v[220:223], v231 offset:4096
v_mfma_f32_16x16x32_bf16 a[8:11], a[200:203], v[136:139], a[8:11]
buffer_load_dwordx4 v251, s[12:15], s32 offen offset:3072 nt lds
v_mfma_f32_16x16x32_bf16 a[40:43], a[200:203], v[140:143], a[40:43]
v_exp_f32 v106, v106
v_mfma_f32_16x16x32_bf16 a[12:15], a[204:207], v[136:139], a[12:15]
v_cvt_pk_bf16_f32 v132, v104, v105
v_mfma_f32_16x16x32_bf16 a[44:47], a[204:207], v[140:143], a[44:47]
v_exp_f32 v107, v107
v_mfma_f32_16x16x32_bf16 a[16:19], a[208:211], v[136:139], a[16:19]
v_exp_f32 v108, v108
v_mfma_f32_16x16x32_bf16 a[48:51], a[208:211], v[140:143], a[48:51]
v_cvt_pk_bf16_f32 v133, v106, v107
v_mfma_f32_16x16x32_bf16 a[20:23], a[212:215], v[136:139], a[20:23]
v_exp_f32 v109, v109
v_mfma_f32_16x16x32_bf16 a[52:55], a[212:215], v[140:143], a[52:55]
v_exp_f32 v110, v110
v_mfma_f32_16x16x32_bf16 a[24:27], a[216:219], v[136:139], a[24:27]
v_cvt_pk_bf16_f32 v134, v108, v109
v_mfma_f32_16x16x32_bf16 a[56:59], a[216:219], v[140:143], a[56:59]
v_exp_f32 v112, v112
v_mfma_f32_16x16x32_bf16 a[28:31], a[220:223], v[136:139], a[28:31]
v_exp_f32 v111, v111
v_mfma_f32_16x16x32_bf16 a[60:63], a[220:223], v[140:143], a[60:63]
v_cvt_pk_bf16_f32 v135, v110, v111
v_mfma_f32_16x16x32_bf16 a[224:227], a[248:251], v[136:139], a[224:227]
v_exp_f32 v113, v113
v_mfma_f32_16x16x32_bf16 a[228:231], a[248:251], v[140:143], a[228:231]
s_add_u32 m0, s43, 4096
s_waitcnt lgkmcnt(0)
v_mfma_f32_16x16x32_bf16 v[96:99], v[192:195], v[0:3], v[144:147]
s_add_u32 s32, s32, 8192
v_mfma_f32_16x16x32_bf16 v[96:99], v[200:203], v[24:27], v[96:99]
v_exp_f32 v114, v114
v_mfma_f32_16x16x32_bf16 v[96:99], v[208:211], v[48:51], v[96:99]
v_cvt_pk_bf16_f32 v136, v112, v113
v_mfma_f32_16x16x32_bf16 v[96:99], v[216:219], v[72:75], v[96:99]
v_exp_f32 v115, v115
v_mfma_f32_16x16x32_bf16 v[104:107], v[192:195], v[4:7], v[148:151]
v_exp_f32 v116, v116
v_mfma_f32_16x16x32_bf16 v[104:107], v[200:203], v[28:31], v[104:107]
v_cvt_pk_bf16_f32 v137, v114, v115
v_mfma_f32_16x16x32_bf16 v[104:107], v[208:211], v[52:55], v[104:107]
v_exp_f32 v117, v117
v_mfma_f32_16x16x32_bf16 v[104:107], v[216:219], v[76:79], v[104:107]
v_exp_f32 v118, v118
v_mfma_f32_16x16x32_bf16 v[100:103], v[196:199], v[0:3], v[144:147]
v_cvt_pk_bf16_f32 v138, v116, v117
v_mfma_f32_16x16x32_bf16 v[100:103], v[204:207], v[24:27], v[100:103]
v_exp_f32 v119, v119
v_mfma_f32_16x16x32_bf16 v[100:103], v[212:215], v[48:51], v[100:103]
v_exp_f32 v120, v120
v_mfma_f32_16x16x32_bf16 v[100:103], v[220:223], v[72:75], v[100:103]
v_cvt_pk_bf16_f32 v139, v118, v119
v_mfma_f32_16x16x32_bf16 v[108:111], v[196:199], v[4:7], v[148:151]
s_waitcnt vmcnt(2)
v_mfma_f32_16x16x32_bf16 v[108:111], v[204:207], v[28:31], v[108:111]
v_exp_f32 v121, v121
v_mfma_f32_16x16x32_bf16 v[108:111], v[212:215], v[52:55], v[108:111]
buffer_load_dwordx4 v248, s[12:15], s35 offen offset:0 nt lds
v_mfma_f32_16x16x32_bf16 v[108:111], v[220:223], v[76:79], v[108:111]
v_exp_f32 v122, v122
v_mfma_f32_16x16x32_bf16 a[64:67], a[192:195], v[128:131], a[64:67]
v_cvt_pk_bf16_f32 v140, v120, v121
v_mfma_f32_16x16x32_bf16 a[96:99], a[192:195], v[132:135], a[96:99]
v_exp_f32 v123, v123
v_mfma_f32_16x16x32_bf16 a[68:71], a[196:199], v[128:131], a[68:71]
v_exp_f32 v124, v124
v_mfma_f32_16x16x32_bf16 a[100:103], a[196:199], v[132:135], a[100:103]
v_cvt_pk_bf16_f32 v141, v122, v123
v_mfma_f32_16x16x32_bf16 a[72:75], a[200:203], v[128:131], a[72:75]
buffer_load_dwordx4 v249, s[12:15], s35 offen offset:1024 nt lds
v_mfma_f32_16x16x32_bf16 a[104:107], a[200:203], v[132:135], a[104:107]
v_exp_f32 v125, v125
v_mfma_f32_16x16x32_bf16 a[76:79], a[204:207], v[128:131], a[76:79]
v_exp_f32 v126, v126
v_mfma_f32_16x16x32_bf16 a[108:111], a[204:207], v[132:135], a[108:111]
v_exp_f32 v96, v96
v_mfma_f32_16x16x32_bf16 a[80:83], a[208:211], v[128:131], a[80:83]
v_exp_f32 v97, v97
v_mfma_f32_16x16x32_bf16 a[112:115], a[208:211], v[132:135], a[112:115]
v_exp_f32 v98, v98
v_mfma_f32_16x16x32_bf16 a[84:87], a[212:215], v[128:131], a[84:87]
buffer_load_dwordx4 v250, s[12:15], s35 offen offset:2048 nt lds
v_cvt_pk_bf16_f32 v142, v124, v125
v_mfma_f32_16x16x32_bf16 a[116:119], a[212:215], v[132:135], a[116:119]
v_exp_f32 v99, v99
v_mfma_f32_16x16x32_bf16 a[88:91], a[216:219], v[128:131], a[88:91]
v_exp_f32 v100, v100
v_mfma_f32_16x16x32_bf16 a[120:123], a[216:219], v[132:135], a[120:123]
v_exp_f32 v127, v127
v_mfma_f32_16x16x32_bf16 a[92:95], a[220:223], v[128:131], a[92:95]
v_cvt_pk_bf16_f32 v143, v126, v127
v_mfma_f32_16x16x32_bf16 a[124:127], a[220:223], v[132:135], a[124:127]
buffer_load_dwordx4 v251, s[12:15], s35 offen offset:3072 nt lds
v_mfma_f32_16x16x32_bf16 a[232:235], a[248:251], v[128:131], a[232:235]
v_exp_f32 v101, v101
v_mfma_f32_16x16x32_bf16 a[236:239], a[248:251], v[132:135], a[236:239]
v_cvt_pk_bf16_f32 v128, v96, v97
v_cvt_pk_bf16_f32 v129, v98, v99
v_mfma_f32_16x16x32_bf16 v[112:115], v[192:195], v[8:11], v[152:155]
v_exp_f32 v102, v102
v_mfma_f32_16x16x32_bf16 v[112:115], v[200:203], v[32:35], v[112:115]
v_cvt_pk_bf16_f32 v130, v100, v101
v_mfma_f32_16x16x32_bf16 v[112:115], v[208:211], v[56:59], v[112:115]
v_exp_f32 v103, v103
v_mfma_f32_16x16x32_bf16 v[112:115], v[216:219], v[80:83], v[112:115]
v_exp_f32 v104, v104
v_mfma_f32_16x16x32_bf16 v[120:123], v[192:195], v[12:15], v[156:159]
v_cvt_pk_bf16_f32 v131, v102, v103
v_mfma_f32_16x16x32_bf16 v[120:123], v[200:203], v[36:39], v[120:123]
v_exp_f32 v105, v105
v_mfma_f32_16x16x32_bf16 v[120:123], v[208:211], v[60:63], v[120:123]
v_exp_f32 v106, v106
v_mfma_f32_16x16x32_bf16 v[120:123], v[216:219], v[84:87], v[120:123]
v_cvt_pk_bf16_f32 v132, v104, v105
v_mfma_f32_16x16x32_bf16 v[116:119], v[196:199], v[8:11], v[152:155]
v_exp_f32 v107, v107
v_mfma_f32_16x16x32_bf16 v[116:119], v[204:207], v[32:35], v[116:119]
v_exp_f32 v108, v108
v_mfma_f32_16x16x32_bf16 v[116:119], v[212:215], v[56:59], v[116:119]
v_cvt_pk_bf16_f32 v133, v106, v107
v_mfma_f32_16x16x32_bf16 v[116:119], v[220:223], v[80:83], v[116:119]
v_exp_f32 v109, v109
v_mfma_f32_16x16x32_bf16 v[124:127], v[196:199], v[12:15], v[156:159]
v_exp_f32 v110, v110
v_mfma_f32_16x16x32_bf16 v[124:127], v[204:207], v[36:39], v[124:127]
v_cvt_pk_bf16_f32 v134, v108, v109
v_mfma_f32_16x16x32_bf16 v[124:127], v[212:215], v[60:63], v[124:127]
v_exp_f32 v111, v111
v_mfma_f32_16x16x32_bf16 v[124:127], v[220:223], v[84:87], v[124:127]
s_waitcnt vmcnt(8)
s_barrier
v_mfma_f32_16x16x32_bf16 a[128:131], a[192:195], v[136:139], a[128:131]
v_cvt_pk_bf16_f32 v135, v110, v111
v_mfma_f32_16x16x32_bf16 a[160:163], a[192:195], v[140:143], a[160:163]
ds_read_b64_tr_b16 a[192:193], v240 offset:32768
ds_read_b64_tr_b16 a[194:195], v240 offset:36864
v_mfma_f32_16x16x32_bf16 a[132:135], a[196:199], v[136:139], a[132:135]
v_mfma_f32_16x16x32_bf16 a[164:167], a[196:199], v[140:143], a[164:167]
ds_read_b64_tr_b16 a[196:197], v241 offset:32768
ds_read_b64_tr_b16 a[198:199], v241 offset:36864
v_mfma_f32_16x16x32_bf16 a[136:139], a[200:203], v[136:139], a[136:139]
v_mfma_f32_16x16x32_bf16 a[168:171], a[200:203], v[140:143], a[168:171]
ds_read_b64_tr_b16 a[200:201], v242 offset:32768
ds_read_b64_tr_b16 a[202:203], v242 offset:36864
v_mfma_f32_16x16x32_bf16 a[140:143], a[204:207], v[136:139], a[140:143]
v_mfma_f32_16x16x32_bf16 a[172:175], a[204:207], v[140:143], a[172:175]
ds_read_b64_tr_b16 a[204:205], v243 offset:32768
ds_read_b64_tr_b16 a[206:207], v243 offset:36864
v_mfma_f32_16x16x32_bf16 a[144:147], a[208:211], v[136:139], a[144:147]
v_exp_f32 v112, v112
v_mfma_f32_16x16x32_bf16 a[176:179], a[208:211], v[140:143], a[176:179]
ds_read_b64_tr_b16 a[208:209], v244 offset:32768
ds_read_b64_tr_b16 a[210:211], v244 offset:36864
v_mfma_f32_16x16x32_bf16 a[148:151], a[212:215], v[136:139], a[148:151]
v_exp_f32 v113, v113
v_mfma_f32_16x16x32_bf16 a[180:183], a[212:215], v[140:143], a[180:183]
ds_read_b64_tr_b16 a[212:213], v245 offset:32768
ds_read_b64_tr_b16 a[214:215], v245 offset:36864
v_mfma_f32_16x16x32_bf16 a[152:155], a[216:219], v[136:139], a[152:155]
v_mfma_f32_16x16x32_bf16 a[184:187], a[216:219], v[140:143], a[184:187]
ds_read_b64_tr_b16 a[216:217], v246 offset:32768
ds_read_b64_tr_b16 a[218:219], v246 offset:36864
v_mfma_f32_16x16x32_bf16 a[156:159], a[220:223], v[136:139], a[156:159]
v_mfma_f32_16x16x32_bf16 a[188:191], a[220:223], v[140:143], a[188:191]
ds_read_b64_tr_b16 a[220:221], v247 offset:32768
ds_read_b64_tr_b16 a[222:223], v247 offset:36864
v_mfma_f32_16x16x32_bf16 a[240:243], a[248:251], v[136:139], a[240:243]
v_mfma_f32_16x16x32_bf16 a[244:247], a[248:251], v[140:143], a[244:247]
s_add_u32 m0, s43, 32768
s_add_u32 s35, s32, 4096
v_mfma_f32_16x16x32_bf16 v[96:99], v[192:195], v[16:19], v[160:163]
v_exp_f32 v114, v114
v_mfma_f32_16x16x32_bf16 v[96:99], v[200:203], v[40:43], v[96:99]
v_cvt_pk_bf16_f32 v136, v112, v113
v_mfma_f32_16x16x32_bf16 v[96:99], v[208:211], v[64:67], v[96:99]
buffer_load_dwordx4 v248, s[12:15], s32 offen offset:0 nt lds
v_mfma_f32_16x16x32_bf16 v[96:99], v[216:219], v[88:91], v[96:99]
v_exp_f32 v115, v115
v_mfma_f32_16x16x32_bf16 v[104:107], v[192:195], v[20:23], v[164:167]
v_exp_f32 v116, v116
v_mfma_f32_16x16x32_bf16 v[104:107], v[200:203], v[44:47], v[104:107]
ds_read_b128 v[192:195], v228 offset:32768
v_cvt_pk_bf16_f32 v137, v114, v115
v_mfma_f32_16x16x32_bf16 v[104:107], v[208:211], v[68:71], v[104:107]
v_exp_f32 v117, v117
v_mfma_f32_16x16x32_bf16 v[104:107], v[216:219], v[92:95], v[104:107]
ds_read_b128 v[200:203], v229 offset:32768
v_mfma_f32_16x16x32_bf16 v[100:103], v[196:199], v[16:19], v[160:163]
buffer_load_dwordx4 v249, s[12:15], s32 offen offset:1024 nt lds
v_mfma_f32_16x16x32_bf16 v[100:103], v[204:207], v[40:43], v[100:103]
ds_read_b128 v[208:211], v230 offset:32768
v_mfma_f32_16x16x32_bf16 v[100:103], v[212:215], v[64:67], v[100:103]
v_exp_f32 v118, v118
v_mfma_f32_16x16x32_bf16 v[100:103], v[220:223], v[88:91], v[100:103]
ds_read_b128 v[216:219], v231 offset:32768
v_cvt_pk_bf16_f32 v138, v116, v117
v_mfma_f32_16x16x32_bf16 v[108:111], v[196:199], v[20:23], v[164:167]
v_exp_f32 v119, v119
v_mfma_f32_16x16x32_bf16 v[108:111], v[204:207], v[44:47], v[108:111]
ds_read_b128 v[196:199], v228 offset:36864
v_mfma_f32_16x16x32_bf16 v[108:111], v[212:215], v[68:71], v[108:111]
buffer_load_dwordx4 v250, s[12:15], s32 offen offset:2048 nt lds
v_mfma_f32_16x16x32_bf16 v[108:111], v[220:223], v[92:95], v[108:111]
ds_read_b128 v[204:207], v229 offset:36864
s_waitcnt lgkmcnt(6)
v_mfma_f32_16x16x32_bf16 a[0:3], a[192:195], v[128:131], a[0:3]
v_exp_f32 v120, v120
v_mfma_f32_16x16x32_bf16 a[32:35], a[192:195], v[132:135], a[32:35]
ds_read_b128 v[212:215], v230 offset:36864
v_cvt_pk_bf16_f32 v139, v118, v119
v_mfma_f32_16x16x32_bf16 a[4:7], a[196:199], v[128:131], a[4:7]
v_exp_f32 v121, v121
v_mfma_f32_16x16x32_bf16 a[36:39], a[196:199], v[132:135], a[36:39]
ds_read_b128 v[220:223], v231 offset:36864
v_mfma_f32_16x16x32_bf16 a[8:11], a[200:203], v[128:131], a[8:11]
buffer_load_dwordx4 v251, s[12:15], s32 offen offset:3072 nt lds
v_mfma_f32_16x16x32_bf16 a[40:43], a[200:203], v[132:135], a[40:43]
v_exp_f32 v122, v122
v_mfma_f32_16x16x32_bf16 a[12:15], a[204:207], v[128:131], a[12:15]
v_cvt_pk_bf16_f32 v140, v120, v121
v_mfma_f32_16x16x32_bf16 a[44:47], a[204:207], v[132:135], a[44:47]
v_exp_f32 v123, v123
v_mfma_f32_16x16x32_bf16 a[16:19], a[208:211], v[128:131], a[16:19]
v_exp_f32 v124, v124
v_mfma_f32_16x16x32_bf16 a[48:51], a[208:211], v[132:135], a[48:51]
v_cvt_pk_bf16_f32 v141, v122, v123
v_mfma_f32_16x16x32_bf16 a[20:23], a[212:215], v[128:131], a[20:23]
v_exp_f32 v125, v125
v_mfma_f32_16x16x32_bf16 a[52:55], a[212:215], v[132:135], a[52:55]
v_exp_f32 v126, v126
v_mfma_f32_16x16x32_bf16 a[24:27], a[216:219], v[128:131], a[24:27]
v_cvt_pk_bf16_f32 v142, v124, v125
v_mfma_f32_16x16x32_bf16 a[56:59], a[216:219], v[132:135], a[56:59]
v_exp_f32 v96, v96
v_mfma_f32_16x16x32_bf16 a[28:31], a[220:223], v[128:131], a[28:31]
v_exp_f32 v127, v127
v_mfma_f32_16x16x32_bf16 a[60:63], a[220:223], v[132:135], a[60:63]
v_cvt_pk_bf16_f32 v143, v126, v127
v_mfma_f32_16x16x32_bf16 a[224:227], a[248:251], v[128:131], a[224:227]
v_exp_f32 v97, v97
v_mfma_f32_16x16x32_bf16 a[228:231], a[248:251], v[132:135], a[228:231]
s_add_u32 m0, s43, 36864
s_waitcnt lgkmcnt(0)
v_mfma_f32_16x16x32_bf16 v[112:115], v[192:195], v[0:3], v[144:147]
s_add_u32 s32, s32, 8192
v_mfma_f32_16x16x32_bf16 v[112:115], v[200:203], v[24:27], v[112:115]
v_exp_f32 v98, v98
v_mfma_f32_16x16x32_bf16 v[112:115], v[208:211], v[48:51], v[112:115]
v_cvt_pk_bf16_f32 v128, v96, v97
v_mfma_f32_16x16x32_bf16 v[112:115], v[216:219], v[72:75], v[112:115]
v_exp_f32 v99, v99
v_mfma_f32_16x16x32_bf16 v[120:123], v[192:195], v[4:7], v[148:151]
v_exp_f32 v100, v100
v_mfma_f32_16x16x32_bf16 v[120:123], v[200:203], v[28:31], v[120:123]
v_cvt_pk_bf16_f32 v129, v98, v99
v_mfma_f32_16x16x32_bf16 v[120:123], v[208:211], v[52:55], v[120:123]
v_exp_f32 v101, v101
v_mfma_f32_16x16x32_bf16 v[120:123], v[216:219], v[76:79], v[120:123]
v_exp_f32 v102, v102
v_mfma_f32_16x16x32_bf16 v[116:119], v[196:199], v[0:3], v[144:147]
v_cvt_pk_bf16_f32 v130, v100, v101
v_mfma_f32_16x16x32_bf16 v[116:119], v[204:207], v[24:27], v[116:119]
v_exp_f32 v103, v103
v_mfma_f32_16x16x32_bf16 v[116:119], v[212:215], v[48:51], v[116:119]
v_exp_f32 v104, v104
v_mfma_f32_16x16x32_bf16 v[116:119], v[220:223], v[72:75], v[116:119]
v_cvt_pk_bf16_f32 v131, v102, v103
v_mfma_f32_16x16x32_bf16 v[124:127], v[196:199], v[4:7], v[148:151]
s_waitcnt vmcnt(3)
v_mfma_f32_16x16x32_bf16 v[124:127], v[204:207], v[28:31], v[124:127]
v_exp_f32 v105, v105
v_mfma_f32_16x16x32_bf16 v[124:127], v[212:215], v[52:55], v[124:127]
buffer_load_dwordx4 v248, s[12:15], s35 offen offset:0 nt lds
v_mfma_f32_16x16x32_bf16 v[124:127], v[220:223], v[76:79], v[124:127]
v_exp_f32 v106, v106
v_mfma_f32_16x16x32_bf16 a[64:67], a[192:195], v[136:139], a[64:67]
v_cvt_pk_bf16_f32 v132, v104, v105
v_mfma_f32_16x16x32_bf16 a[96:99], a[192:195], v[140:143], a[96:99]
v_exp_f32 v107, v107
v_mfma_f32_16x16x32_bf16 a[68:71], a[196:199], v[136:139], a[68:71]
v_exp_f32 v108, v108
v_mfma_f32_16x16x32_bf16 a[100:103], a[196:199], v[140:143], a[100:103]
v_cvt_pk_bf16_f32 v133, v106, v107
v_mfma_f32_16x16x32_bf16 a[72:75], a[200:203], v[136:139], a[72:75]
buffer_load_dwordx4 v249, s[12:15], s35 offen offset:1024 nt lds
v_mfma_f32_16x16x32_bf16 a[104:107], a[200:203], v[140:143], a[104:107]
v_exp_f32 v109, v109
v_mfma_f32_16x16x32_bf16 a[76:79], a[204:207], v[136:139], a[76:79]
v_exp_f32 v110, v110
v_mfma_f32_16x16x32_bf16 a[108:111], a[204:207], v[140:143], a[108:111]
v_exp_f32 v112, v112
v_mfma_f32_16x16x32_bf16 a[80:83], a[208:211], v[136:139], a[80:83]
v_exp_f32 v113, v113
v_mfma_f32_16x16x32_bf16 a[112:115], a[208:211], v[140:143], a[112:115]
v_exp_f32 v114, v114
v_mfma_f32_16x16x32_bf16 a[84:87], a[212:215], v[136:139], a[84:87]
buffer_load_dwordx4 v250, s[12:15], s35 offen offset:2048 nt lds
v_cvt_pk_bf16_f32 v134, v108, v109
v_mfma_f32_16x16x32_bf16 a[116:119], a[212:215], v[140:143], a[116:119]
v_exp_f32 v115, v115
v_mfma_f32_16x16x32_bf16 a[88:91], a[216:219], v[136:139], a[88:91]
v_exp_f32 v116, v116
v_mfma_f32_16x16x32_bf16 a[120:123], a[216:219], v[140:143], a[120:123]
v_exp_f32 v111, v111
v_mfma_f32_16x16x32_bf16 a[92:95], a[220:223], v[136:139], a[92:95]
v_cvt_pk_bf16_f32 v135, v110, v111
v_mfma_f32_16x16x32_bf16 a[124:127], a[220:223], v[140:143], a[124:127]
buffer_load_dwordx4 v251, s[12:15], s35 offen offset:3072 nt lds
v_mfma_f32_16x16x32_bf16 a[232:235], a[248:251], v[136:139], a[232:235]
v_exp_f32 v117, v117
v_mfma_f32_16x16x32_bf16 a[236:239], a[248:251], v[140:143], a[236:239]
s_cmp_eq_u32 s94, s29
s_cbranch_scc1 L_count
L_counted:
s_sub_u32 s94, s94, 1
s_cmp_lg_u32 s94, 0
s_cbranch_scc1 L_loop
v_cvt_pk_bf16_f32 v136, v112, v113
v_cvt_pk_bf16_f32 v137, v114, v115
v_mfma_f32_16x16x32_bf16 v[96:99], v[192:195], v[8:11], v[152:155]
v_exp_f32 v118, v118
v_mfma_f32_16x16x32_bf16 v[96:99], v[200:203], v[32:35], v[96:99]
v_cvt_pk_bf16_f32 v138, v116, v117
v_mfma_f32_16x16x32_bf16 v[96:99], v[208:211], v[56:59], v[96:99]
v_exp_f32 v119, v119
v_mfma_f32_16x16x32_bf16 v[96:99], v[216:219], v[80:83], v[96:99]
v_exp_f32 v120, v120
v_mfma_f32_16x16x32_bf16 v[104:107], v[192:195], v[12:15], v[156:159]
v_cvt_pk_bf16_f32 v139, v118, v119
v_mfma_f32_16x16x32_bf16 v[104:107], v[200:203], v[36:39], v[104:107]
v_exp_f32 v121, v121
v_mfma_f32_16x16x32_bf16 v[104:107], v[208:211], v[60:63], v[104:107]
v_exp_f32 v122, v122
v_mfma_f32_16x16x32_bf16 v[104:107], v[216:219], v[84:87], v[104:107]
v_cvt_pk_bf16_f32 v140, v120, v121
v_mfma_f32_16x16x32_bf16 v[100:103], v[196:199], v[8:11], v[152:155]
v_exp_f32 v123, v123
v_mfma_f32_16x16x32_bf16 v[100:103], v[204:207], v[32:35], v[100:103]
v_exp_f32 v124, v124
v_mfma_f32_16x16x32_bf16 v[100:103], v[212:215], v[56:59], v[100:103]
v_cvt_pk_bf16_f32 v141, v122, v123
v_mfma_f32_16x16x32_bf16 v[100:103], v[220:223], v[80:83], v[100:103]
v_exp_f32 v125, v125
v_mfma_f32_16x16x32_bf16 v[108:111], v[196:199], v[12:15], v[156:159]
v_exp_f32 v126, v126
v_mfma_f32_16x16x32_bf16 v[108:111], v[204:207], v[36:39], v[108:111]
v_cvt_pk_bf16_f32 v142, v124, v125
v_mfma_f32_16x16x32_bf16 v[108:111], v[212:215], v[60:63], v[108:111]
v_exp_f32 v127, v127
v_mfma_f32_16x16x32_bf16 v[108:111], v[220:223], v[84:87], v[108:111]
s_waitcnt vmcnt(8)
s_barrier
v_mfma_f32_16x16x32_bf16 a[128:131], a[192:195], v[128:131], a[128:131]
v_cvt_pk_bf16_f32 v143, v126, v127
v_mfma_f32_16x16x32_bf16 a[160:163], a[192:195], v[132:135], a[160:163]
ds_read_b64_tr_b16 a[192:193], v232 offset:0
ds_read_b64_tr_b16 a[194:195], v232 offset:4096
v_mfma_f32_16x16x32_bf16 a[132:135], a[196:199], v[128:131], a[132:135]
v_mfma_f32_16x16x32_bf16 a[164:167], a[196:199], v[132:135], a[164:167]
ds_read_b64_tr_b16 a[196:197], v233 offset:0
ds_read_b64_tr_b16 a[198:199], v233 offset:4096
v_mfma_f32_16x16x32_bf16 a[136:139], a[200:203], v[128:131], a[136:139]
v_mfma_f32_16x16x32_bf16 a[168:171], a[200:203], v[132:135], a[168:171]
ds_read_b64_tr_b16 a[200:201], v234 offset:0
ds_read_b64_tr_b16 a[202:203], v234 offset:4096
v_mfma_f32_16x16x32_bf16 a[140:143], a[204:207], v[128:131], a[140:143]
v_mfma_f32_16x16x32_bf16 a[172:175], a[204:207], v[132:135], a[172:175]
ds_read_b64_tr_b16 a[204:205], v235 offset:0
ds_read_b64_tr_b16 a[206:207], v235 offset:4096
v_mfma_f32_16x16x32_bf16 a[144:147], a[208:211], v[128:131], a[144:147]
v_exp_f32 v96, v96
v_mfma_f32_16x16x32_bf16 a[176:179], a[208:211], v[132:135], a[176:179]
ds_read_b64_tr_b16 a[208:209], v236 offset:0
ds_read_b64_tr_b16 a[210:211], v236 offset:4096
v_mfma_f32_16x16x32_bf16 a[148:151], a[212:215], v[128:131], a[148:151]
v_exp_f32 v97, v97
v_mfma_f32_16x16x32_bf16 a[180:183], a[212:215], v[132:135], a[180:183]
ds_read_b64_tr_b16 a[212:213], v237 offset:0
ds_read_b64_tr_b16 a[214:215], v237 offset:4096
v_mfma_f32_16x16x32_bf16 a[152:155], a[216:219], v[128:131], a[152:155]
v_mfma_f32_16x16x32_bf16 a[184:187], a[216:219], v[132:135], a[184:187]
ds_read_b64_tr_b16 a[216:217], v238 offset:0
ds_read_b64_tr_b16 a[218:219], v238 offset:4096
v_mfma_f32_16x16x32_bf16 a[156:159], a[220:223], v[128:131], a[156:159]
v_mfma_f32_16x16x32_bf16 a[188:191], a[220:223], v[132:135], a[188:191]
ds_read_b64_tr_b16 a[220:221], v239 offset:0
ds_read_b64_tr_b16 a[222:223], v239 offset:4096
v_mfma_f32_16x16x32_bf16 a[240:243], a[248:251], v[128:131], a[240:243]
v_mfma_f32_16x16x32_bf16 a[244:247], a[248:251], v[132:135], a[244:247]
s_cmp_eq_u32 s32, s33
s_cselect_b32 s34, 0x7ff00000, s32
v_mfma_f32_16x16x32_bf16 v[112:115], v[192:195], v[16:19], v[160:163]
s_add_u32 m0, s43, 65536
s_add_u32 s35, s34, 4096
v_mfma_f32_16x16x32_bf16 v[112:115], v[200:203], v[40:43], v[112:115]
v_exp_f32 v98, v98
v_mfma_f32_16x16x32_bf16 v[112:115], v[208:211], v[64:67], v[112:115]
buffer_load_dwordx4 v248, s[12:15], s34 offen offset:0 nt lds
v_cvt_pk_bf16_f32 v128, v96, v97
v_mfma_f32_16x16x32_bf16 v[112:115], v[216:219], v[88:91], v[112:115]
v_exp_f32 v99, v99
v_mfma_f32_16x16x32_bf16 v[120:123], v[192:195], v[20:23], v[164:167]
v_exp_f32 v100, v100
v_mfma_f32_16x16x32_bf16 v[120:123], v[200:203], v[44:47], v[120:123]
ds_read_b128 v[192:195], v224 offset:0
v_cvt_pk_bf16_f32 v129, v98, v99
v_mfma_f32_16x16x32_bf16 v[120:123], v[208:211], v[68:71], v[120:123]
v_exp_f32 v101, v101
v_mfma_f32_16x16x32_bf16 v[120:123], v[216:219], v[92:95], v[120:123]
ds_read_b128 v[200:203], v225 offset:0
v_mfma_f32_16x16x32_bf16 v[116:119], v[196:199], v[16:19], v[160:163]
buffer_load_dwordx4 v249, s[12:15], s34 offen offset:1024 nt lds
v_mfma_f32_16x16x32_bf16 v[116:119], v[204:207], v[40:43], v[116:119]
ds_read_b128 v[208:211], v226 offset:0
v_mfma_f32_16x16x32_bf16 v[116:119], v[212:215], v[64:67], v[116:119]
v_exp_f32 v102, v102
v_mfma_f32_16x16x32_bf16 v[116:119], v[220:223], v[88:91], v[116:119]
ds_read_b128 v[216:219], v227 offset:0
v_cvt_pk_bf16_f32 v130, v100, v101
v_mfma_f32_16x16x32_bf16 v[124:127], v[196:199], v[20:23], v[164:167]
v_exp_f32 v103, v103
v_mfma_f32_16x16x32_bf16 v[124:127], v[204:207], v[44:47], v[124:127]
ds_read_b128 v[196:199], v224 offset:4096
v_mfma_f32_16x16x32_bf16 v[124:127], v[212:215], v[68:71], v[124:127]
buffer_load_dwordx4 v250, s[12:15], s34 offen offset:2048 nt lds
v_mfma_f32_16x16x32_bf16 v[124:127], v[220:223], v[92:95], v[124:127]
ds_read_b128 v[204:207], v225 offset:4096
s_waitcnt lgkmcnt(6)
v_mfma_f32_16x16x32_bf16 a[0:3], a[192:195], v[136:139], a[0:3]
v_exp_f32 v104, v104
v_mfma_f32_16x16x32_bf16 a[32:35], a[192:195], v[140:143], a[32:35]
ds_read_b128 v[212:215], v226 offset:4096
v_cvt_pk_bf16_f32 v131, v102, v103
v_mfma_f32_16x16x32_bf16 a[4:7], a[196:199], v[136:139], a[4:7]
v_exp_f32 v105, v105
v_mfma_f32_16x16x32_bf16 a[36:39], a[196:199], v[140:143], a[36:39]
ds_read_b128 v[220:223], v227 offset:4096
v_mfma_f32_16x16x32_bf16 a[8:11], a[200:203], v[136:139], a[8:11]
buffer_load_dwordx4 v251, s[12:15], s34 offen offset:3072 nt lds
v_mfma_f32_16x16x32_bf16 a[40:43], a[200:203], v[140:143], a[40:43]
v_exp_f32 v106, v106
v_mfma_f32_16x16x32_bf16 a[12:15], a[204:207], v[136:139], a[12:15]
v_cvt_pk_bf16_f32 v132, v104, v105
v_mfma_f32_16x16x32_bf16 a[44:47], a[204:207], v[140:143], a[44:47]
v_exp_f32 v107, v107
v_mfma_f32_16x16x32_bf16 a[16:19], a[208:211], v[136:139], a[16:19]
v_exp_f32 v108, v108
v_mfma_f32_16x16x32_bf16 a[48:51], a[208:211], v[140:143], a[48:51]
v_cvt_pk_bf16_f32 v133, v106, v107
v_mfma_f32_16x16x32_bf16 a[20:23], a[212:215], v[136:139], a[20:23]
v_exp_f32 v109, v109
v_mfma_f32_16x16x32_bf16 a[52:55], a[212:215], v[140:143], a[52:55]
v_exp_f32 v110, v110
v_mfma_f32_16x16x32_bf16 a[24:27], a[216:219], v[136:139], a[24:27]
v_cvt_pk_bf16_f32 v134, v108, v109
v_mfma_f32_16x16x32_bf16 a[56:59], a[216:219], v[140:143], a[56:59]
v_exp_f32 v112, v112
v_mfma_f32_16x16x32_bf16 a[28:31], a[220:223], v[136:139], a[28:31]
v_exp_f32 v111, v111
v_mfma_f32_16x16x32_bf16 a[60:63], a[220:223], v[140:143], a[60:63]
v_cvt_pk_bf16_f32 v135, v110, v111
v_mfma_f32_16x16x32_bf16 a[224:227], a[248:251], v[136:139], a[224:227]
v_exp_f32 v113, v113
v_mfma_f32_16x16x32_bf16 a[228:231], a[248:251], v[140:143], a[228:231]
s_add_u32 m0, s43, 69632
s_waitcnt lgkmcnt(0)
v_mfma_f32_16x16x32_bf16 v[96:99], v[192:195], v[0:3], v[144:147]
buffer_load_dword v188, off, s[96:99], s44 offset:32 sc1
s_add_u32 s32, s32, 8192
v_mfma_f32_16x16x32_bf16 v[96:99], v[200:203], v[24:27], v[96:99]
v_exp_f32 v114, v114
v_mfma_f32_16x16x32_bf16 v[96:99], v[208:211], v[48:51], v[96:99]
v_cvt_pk_bf16_f32 v136, v112, v113
v_mfma_f32_16x16x32_bf16 v[96:99], v[216:219], v[72:75], v[96:99]
v_exp_f32 v115, v115
v_mfma_f32_16x16x32_bf16 v[104:107], v[192:195], v[4:7], v[148:151]
v_exp_f32 v116, v116
v_mfma_f32_16x16x32_bf16 v[104:107], v[200:203], v[28:31], v[104:107]
v_cvt_pk_bf16_f32 v137, v114, v115
v_mfma_f32_16x16x32_bf16 v[104:107], v[208:211], v[52:55], v[104:107]
v_exp_f32 v117, v117
v_mfma_f32_16x16x32_bf16 v[104:107], v[216:219], v[76:79], v[104:107]
v_exp_f32 v118, v118
v_mfma_f32_16x16x32_bf16 v[100:103], v[196:199], v[0:3], v[144:147]
v_cvt_pk_bf16_f32 v138, v116, v117
v_mfma_f32_16x16x32_bf16 v[100:103], v[204:207], v[24:27], v[100:103]
v_exp_f32 v119, v119
v_mfma_f32_16x16x32_bf16 v[100:103], v[212:215], v[48:51], v[100:103]
v_exp_f32 v120, v120
v_mfma_f32_16x16x32_bf16 v[100:103], v[220:223], v[72:75], v[100:103]
v_cvt_pk_bf16_f32 v139, v118, v119
v_mfma_f32_16x16x32_bf16 v[108:111], v[196:199], v[4:7], v[148:151]
v_exp_f32 v121, v121
v_mfma_f32_16x16x32_bf16 v[108:111], v[204:207], v[28:31], v[108:111]
v_exp_f32 v122, v122
v_mfma_f32_16x16x32_bf16 v[108:111], v[212:215], v[52:55], v[108:111]
buffer_load_dwordx4 v248, s[12:15], s35 offen offset:0 nt lds
v_cvt_pk_bf16_f32 v140, v120, v121
v_mfma_f32_16x16x32_bf16 v[108:111], v[220:223], v[76:79], v[108:111]
v_exp_f32 v123, v123
v_mfma_f32_16x16x32_bf16 a[64:67], a[192:195], v[128:131], a[64:67]
v_exp_f32 v124, v124
v_mfma_f32_16x16x32_bf16 a[96:99], a[192:195], v[132:135], a[96:99]
v_cvt_pk_bf16_f32 v141, v122, v123
v_mfma_f32_16x16x32_bf16 a[68:71], a[196:199], v[128:131], a[68:71]
v_exp_f32 v125, v125
v_mfma_f32_16x16x32_bf16 a[100:103], a[196:199], v[132:135], a[100:103]
v_exp_f32 v126, v126
v_mfma_f32_16x16x32_bf16 a[72:75], a[200:203], v[128:131], a[72:75]
buffer_load_dwordx4 v249, s[12:15], s35 offen offset:1024 nt lds
v_cvt_pk_bf16_f32 v142, v124, v125
v_mfma_f32_16x16x32_bf16 a[104:107], a[200:203], v[132:135], a[104:107]
v_exp_f32 v127, v127
v_mfma_f32_16x16x32_bf16 a[76:79], a[204:207], v[128:131], a[76:79]
v_cvt_pk_bf16_f32 v143, v126, v127
v_mfma_f32_16x16x32_bf16 a[108:111], a[204:207], v[132:135], a[108:111]
v_exp_f32 v96, v96
v_mfma_f32_16x16x32_bf16 a[80:83], a[208:211], v[128:131], a[80:83]
v_exp_f32 v97, v97
v_mfma_f32_16x16x32_bf16 a[112:115], a[208:211], v[132:135], a[112:115]
v_exp_f32 v98, v98
v_mfma_f32_16x16x32_bf16 a[84:87], a[212:215], v[128:131], a[84:87]
buffer_load_dwordx4 v250, s[12:15], s35 offen offset:2048 nt lds
v_mfma_f32_16x16x32_bf16 a[116:119], a[212:215], v[132:135], a[116:119]
v_exp_f32 v99, v99
v_mfma_f32_16x16x32_bf16 a[88:91], a[216:219], v[128:131], a[88:91]
v_exp_f32 v100, v100
v_mfma_f32_16x16x32_bf16 a[120:123], a[216:219], v[132:135], a[120:123]
v_exp_f32 v101, v101
v_mfma_f32_16x16x32_bf16 a[92:95], a[220:223], v[128:131], a[92:95]
v_mfma_f32_16x16x32_bf16 a[124:127], a[220:223], v[132:135], a[124:127]
buffer_load_dwordx4 v251, s[12:15], s35 offen offset:3072 nt lds
v_mfma_f32_16x16x32_bf16 a[232:235], a[248:251], v[128:131], a[232:235]
v_mfma_f32_16x16x32_bf16 a[236:239], a[248:251], v[132:135], a[236:239]
v_cvt_pk_bf16_f32 v128, v96, v97
v_cvt_pk_bf16_f32 v129, v98, v99
v_mfma_f32_16x16x32_bf16 v[112:115], v[192:195], v[8:11], v[152:155]
v_exp_f32 v102, v102
v_mfma_f32_16x16x32_bf16 v[112:115], v[200:203], v[32:35], v[112:115]
v_cvt_pk_bf16_f32 v130, v100, v101
v_mfma_f32_16x16x32_bf16 v[112:115], v[208:211], v[56:59], v[112:115]
v_exp_f32 v103, v103
v_mfma_f32_16x16x32_bf16 v[112:115], v[216:219], v[80:83], v[112:115]
v_exp_f32 v104, v104
v_mfma_f32_16x16x32_bf16 v[120:123], v[192:195], v[12:15], v[156:159]
v_cvt_pk_bf16_f32 v131, v102, v103
v_mfma_f32_16x16x32_bf16 v[120:123], v[200:203], v[36:39], v[120:123]
v_exp_f32 v105, v105
v_mfma_f32_16x16x32_bf16 v[120:123], v[208:211], v[60:63], v[120:123]
v_exp_f32 v106, v106
v_mfma_f32_16x16x32_bf16 v[120:123], v[216:219], v[84:87], v[120:123]
v_cvt_pk_bf16_f32 v132, v104, v105
v_mfma_f32_16x16x32_bf16 v[116:119], v[196:199], v[8:11], v[152:155]
v_exp_f32 v107, v107
v_mfma_f32_16x16x32_bf16 v[116:119], v[204:207], v[32:35], v[116:119]
v_exp_f32 v108, v108
v_mfma_f32_16x16x32_bf16 v[116:119], v[212:215], v[56:59], v[116:119]
v_cvt_pk_bf16_f32 v133, v106, v107
v_mfma_f32_16x16x32_bf16 v[116:119], v[220:223], v[80:83], v[116:119]
v_exp_f32 v109, v109
v_mfma_f32_16x16x32_bf16 v[124:127], v[196:199], v[12:15], v[156:159]
v_exp_f32 v110, v110
v_mfma_f32_16x16x32_bf16 v[124:127], v[204:207], v[36:39], v[124:127]
v_cvt_pk_bf16_f32 v134, v108, v109
v_mfma_f32_16x16x32_bf16 v[124:127], v[212:215], v[60:63], v[124:127]
v_exp_f32 v111, v111
v_mfma_f32_16x16x32_bf16 v[124:127], v[220:223], v[84:87], v[124:127]
s_waitcnt vmcnt(9)
s_barrier
v_mfma_f32_16x16x32_bf16 a[128:131], a[192:195], v[136:139], a[128:131]
v_cvt_pk_bf16_f32 v135, v110, v111
v_mfma_f32_16x16x32_bf16 a[160:163], a[192:195], v[140:143], a[160:163]
ds_read_b64_tr_b16 a[192:193], v232 offset:32768
ds_read_b64_tr_b16 a[194:195], v232 offset:36864
v_mfma_f32_16x16x32_bf16 a[132:135], a[196:199], v[136:139], a[132:135]
v_mfma_f32_16x16x32_bf16 a[164:167], a[196:199], v[140:143], a[164:167]
ds_read_b64_tr_b16 a[196:197], v233 offset:32768
ds_read_b64_tr_b16 a[198:199], v233 offset:36864
v_mfma_f32_16x16x32_bf16 a[136:139], a[200:203], v[136:139], a[136:139]
v_mfma_f32_16x16x32_bf16 a[168:171], a[200:203], v[140:143], a[168:171]
ds_read_b64_tr_b16 a[200:201], v234 offset:32768
ds_read_b64_tr_b16 a[202:203], v234 offset:36864
v_mfma_f32_16x16x32_bf16 a[140:143], a[204:207], v[136:139], a[140:143]
v_mfma_f32_16x16x32_bf16 a[172:175], a[204:207], v[140:143], a[172:175]
ds_read_b64_tr_b16 a[204:205], v235 offset:32768
ds_read_b64_tr_b16 a[206:207], v235 offset:36864
v_mfma_f32_16x16x32_bf16 a[144:147], a[208:211], v[136:139], a[144:147]
v_exp_f32 v112, v112
v_mfma_f32_16x16x32_bf16 a[176:179], a[208:211], v[140:143], a[176:179]
ds_read_b64_tr_b16 a[208:209], v236 offset:32768
ds_read_b64_tr_b16 a[210:211], v236 offset:36864
v_mfma_f32_16x16x32_bf16 a[148:151], a[212:215], v[136:139], a[148:151]
v_exp_f32 v113, v113
v_mfma_f32_16x16x32_bf16 a[180:183], a[212:215], v[140:143], a[180:183]
ds_read_b64_tr_b16 a[212:213], v237 offset:32768
ds_read_b64_tr_b16 a[214:215], v237 offset:36864
v_mfma_f32_16x16x32_bf16 a[152:155], a[216:219], v[136:139], a[152:155]
v_mfma_f32_16x16x32_bf16 a[184:187], a[216:219], v[140:143], a[184:187]
ds_read_b64_tr_b16 a[216:217], v238 offset:32768
ds_read_b64_tr_b16 a[218:219], v238 offset:36864
v_mfma_f32_16x16x32_bf16 a[156:159], a[220:223], v[136:139], a[156:159]
v_mfma_f32_16x16x32_bf16 a[188:191], a[220:223], v[140:143], a[188:191]
ds_read_b64_tr_b16 a[220:221], v239 offset:32768
ds_read_b64_tr_b16 a[222:223], v239 offset:36864
v_mfma_f32_16x16x32_bf16 a[240:243], a[248:251], v[136:139], a[240:243]
v_mfma_f32_16x16x32_bf16 a[244:247], a[248:251], v[140:143], a[244:247]
s_add_u32 m0, s43, 0
s_add_u32 s37, s76, s48
v_mfma_f32_16x16x32_bf16 v[96:99], v[192:195], v[16:19], v[160:163]
s_add_u32 s35, s37, 0
v_mfma_f32_16x16x32_bf16 v[96:99], v[200:203], v[40:43], v[96:99]
v_exp_f32 v114, v114
v_mfma_f32_16x16x32_bf16 v[96:99], v[208:211], v[64:67], v[96:99]
buffer_load_dwordx4 v176, s[20:23], s35 offen offset:0  lds
v_cvt_pk_bf16_f32 v136, v112, v113
v_mfma_f32_16x16x32_bf16 v[96:99], v[216:219], v[88:91], v[96:99]
v_exp_f32 v115, v115
v_mfma_f32_16x16x32_bf16 v[104:107], v[192:195], v[20:23], v[164:167]
v_exp_f32 v116, v116
v_mfma_f32_16x16x32_bf16 v[104:107], v[200:203], v[44:47], v[104:107]
ds_read_b128 v[192:195], v224 offset:32768
v_cvt_pk_bf16_f32 v137, v114, v115
v_mfma_f32_16x16x32_bf16 v[104:107], v[208:211], v[68:71], v[104:107]
v_exp_f32 v117, v117
v_mfma_f32_16x16x32_bf16 v[104:107], v[216:219], v[92:95], v[104:107]
ds_read_b128 v[200:203], v225 offset:32768
v_mfma_f32_16x16x32_bf16 v[100:103], v[196:199], v[16:19], v[160:163]
buffer_load_dwordx4 v177, s[20:23], s35 offen offset:1024  lds
v_mfma_f32_16x16x32_bf16 v[100:103], v[204:207], v[40:43], v[100:103]
ds_read_b128 v[208:211], v226 offset:32768
v_mfma_f32_16x16x32_bf16 v[100:103], v[212:215], v[64:67], v[100:103]
v_exp_f32 v118, v118
v_mfma_f32_16x16x32_bf16 v[100:103], v[220:223], v[88:91], v[100:103]
ds_read_b128 v[216:219], v227 offset:32768
v_cvt_pk_bf16_f32 v138, v116, v117
v_mfma_f32_16x16x32_bf16 v[108:111], v[196:199], v[20:23], v[164:167]
v_exp_f32 v119, v119
v_mfma_f32_16x16x32_bf16 v[108:111], v[204:207], v[44:47], v[108:111]
ds_read_b128 v[196:199], v224 offset:36864
v_mfma_f32_16x16x32_bf16 v[108:111], v[212:215], v[68:71], v[108:111]
buffer_load_dwordx4 v178, s[20:23], s35 offen offset:2048  lds
v_mfma_f32_16x16x32_bf16 v[108:111], v[220:223], v[92:95], v[108:111]
ds_read_b128 v[204:207], v225 offset:36864
s_waitcnt lgkmcnt(6)
v_mfma_f32_16x16x32_bf16 a[0:3], a[192:195], v[128:131], a[0:3]
v_exp_f32 v120, v120
v_mfma_f32_16x16x32_bf16 a[32:35], a[192:195], v[132:135], a[32:35]
ds_read_b128 v[212:215], v226 offset:36864
v_cvt_pk_bf16_f32 v139, v118, v119
v_mfma_f32_16x16x32_bf16 a[4:7], a[196:199], v[128:131], a[4:7]
v_exp_f32 v121, v121
v_mfma_f32_16x16x32_bf16 a[36:39], a[196:199], v[132:135], a[36:39]
ds_read_b128 v[220:223], v227 offset:36864
v_mfma_f32_16x16x32_bf16 a[8:11], a[200:203], v[128:131], a[8:11]
buffer_load_dwordx4 v179, s[20:23], s35 offen offset:3072  lds
v_mfma_f32_16x16x32_bf16 a[40:43], a[200:203], v[132:135], a[40:43]
v_exp_f32 v122, v122
v_mfma_f32_16x16x32_bf16 a[12:15], a[204:207], v[128:131], a[12:15]
v_cvt_pk_bf16_f32 v140, v120, v121
v_mfma_f32_16x16x32_bf16 a[44:47], a[204:207], v[132:135], a[44:47]
v_exp_f32 v123, v123
v_mfma_f32_16x16x32_bf16 a[16:19], a[208:211], v[128:131], a[16:19]
v_exp_f32 v124, v124
v_mfma_f32_16x16x32_bf16 a[48:51], a[208:211], v[132:135], a[48:51]
v_cvt_pk_bf16_f32 v141, v122, v123
v_mfma_f32_16x16x32_bf16 a[20:23], a[212:215], v[128:131], a[20:23]
v_exp_f32 v125, v125
v_mfma_f32_16x16x32_bf16 a[52:55], a[212:215], v[132:135], a[52:55]
v_exp_f32 v126, v126
v_mfma_f32_16x16x32_bf16 a[24:27], a[216:219], v[128:131], a[24:27]
v_cvt_pk_bf16_f32 v142, v124, v125
v_mfma_f32_16x16x32_bf16 a[56:59], a[216:219], v[132:135], a[56:59]
v_exp_f32 v96, v96
v_mfma_f32_16x16x32_bf16 a[28:31], a[220:223], v[128:131], a[28:31]
v_exp_f32 v127, v127
v_mfma_f32_16x16x32_bf16 a[60:63], a[220:223], v[132:135], a[60:63]
v_cvt_pk_bf16_f32 v143, v126, v127
v_mfma_f32_16x16x32_bf16 a[224:227], a[248:251], v[128:131], a[224:227]
v_exp_f32 v97, v97
v_mfma_f32_16x16x32_bf16 a[228:231], a[248:251], v[132:135], a[228:231]
s_add_u32 m0, s43, 4096
s_waitcnt lgkmcnt(0)
v_mfma_f32_16x16x32_bf16 v[112:115], v[192:195], v[0:3], v[144:147]
s_add_u32 s35, s37, 36864
v_mfma_f32_16x16x32_bf16 v[112:115], v[200:203], v[24:27], v[112:115]
v_exp_f32 v98, v98
v_mfma_f32_16x16x32_bf16 v[112:115], v[208:211], v[48:51], v[112:115]
v_cvt_pk_bf16_f32 v128, v96, v97
v_mfma_f32_16x16x32_bf16 v[112:115], v[216:219], v[72:75], v[112:115]
v_exp_f32 v99, v99
v_mfma_f32_16x16x32_bf16 v[120:123], v[192:195], v[4:7], v[148:151]
v_exp_f32 v100, v100
v_mfma_f32_16x16x32_bf16 v[120:123], v[200:203], v[28:31], v[120:123]
v_cvt_pk_bf16_f32 v129, v98, v99
v_mfma_f32_16x16x32_bf16 v[120:123], v[208:211], v[52:55], v[120:123]
v_exp_f32 v101, v101
v_mfma_f32_16x16x32_bf16 v[120:123], v[216:219], v[76:79], v[120:123]
v_exp_f32 v102, v102
v_mfma_f32_16x16x32_bf16 v[116:119], v[196:199], v[0:3], v[144:147]
v_cvt_pk_bf16_f32 v130, v100, v101
v_mfma_f32_16x16x32_bf16 v[116:119], v[204:207], v[24:27], v[116:119]
v_exp_f32 v103, v103
v_mfma_f32_16x16x32_bf16 v[116:119], v[212:215], v[48:51], v[116:119]
v_exp_f32 v104, v104
v_mfma_f32_16x16x32_bf16 v[116:119], v[220:223], v[72:75], v[116:119]
v_cvt_pk_bf16_f32 v131, v102, v103
v_mfma_f32_16x16x32_bf16 v[124:127], v[196:199], v[4:7], v[148:151]
v_exp_f32 v105, v105
v_mfma_f32_16x16x32_bf16 v[124:127], v[204:207], v[28:31], v[124:127]
v_exp_f32 v106, v106
v_mfma_f32_16x16x32_bf16 v[124:127], v[212:215], v[52:55], v[124:127]
buffer_load_dwordx4 v176, s[20:23], s35 offen offset:0  lds
v_cvt_pk_bf16_f32 v132, v104, v105
v_mfma_f32_16x16x32_bf16 v[124:127], v[220:223], v[76:79], v[124:127]
v_exp_f32 v107, v107
v_mfma_f32_16x16x32_bf16 a[64:67], a[192:195], v[136:139], a[64:67]
v_exp_f32 v108, v108
v_mfma_f32_16x16x32_bf16 a[96:99], a[192:195], v[140:143], a[96:99]
v_cvt_pk_bf16_f32 v133, v106, v107
v_mfma_f32_16x16x32_bf16 a[68:71], a[196:199], v[136:139], a[68:71]
v_exp_f32 v109, v109
v_mfma_f32_16x16x32_bf16 a[100:103], a[196:199], v[140:143], a[100:103]
v_exp_f32 v110, v110
v_mfma_f32_16x16x32_bf16 a[72:75], a[200:203], v[136:139], a[72:75]
buffer_load_dwordx4 v177, s[20:23], s35 offen offset:1024  lds
v_cvt_pk_bf16_f32 v134, v108, v109
v_mfma_f32_16x16x32_bf16 a[104:107], a[200:203], v[140:143], a[104:107]
v_exp_f32 v111, v111
v_mfma_f32_16x16x32_bf16 a[76:79], a[204:207], v[136:139], a[76:79]
v_cvt_pk_bf16_f32 v135, v110, v111
v_mfma_f32_16x16x32_bf16 a[108:111], a[204:207], v[140:143], a[108:111]
v_exp_f32 v112, v112
v_mfma_f32_16x16x32_bf16 a[80:83], a[208:211], v[136:139], a[80:83]
v_exp_f32 v113, v113
v_mfma_f32_16x16x32_bf16 a[112:115], a[208:211], v[140:143], a[112:115]
v_exp_f32 v114, v114
v_mfma_f32_16x16x32_bf16 a[84:87], a[212:215], v[136:139], a[84:87]
buffer_load_dwordx4 v178, s[20:23], s35 offen offset:2048  lds
v_mfma_f32_16x16x32_bf16 a[116:119], a[212:215], v[140:143], a[116:119]
v_exp_f32 v115, v115
v_mfma_f32_16x16x32_bf16 a[88:91], a[216:219], v[136:139], a[88:91]
v_exp_f32 v116, v116
v_mfma_f32_16x16x32_bf16 a[120:123], a[216:219], v[140:143], a[120:123]
v_exp_f32 v117, v117
v_mfma_f32_16x16x32_bf16 a[92:95], a[220:223], v[136:139], a[92:95]
v_mfma_f32_16x16x32_bf16 a[124:127], a[220:223], v[140:143], a[124:127]
buffer_load_dwordx4 v179, s[20:23], s35 offen offset:3072  lds
v_mfma_f32_16x16x32_bf16 a[232:235], a[248:251], v[136:139], a[232:235]
v_mfma_f32_16x16x32_bf16 a[236:239], a[248:251], v[140:143], a[236:239]
v_cvt_pk_bf16_f32 v136, v112, v113
v_cvt_pk_bf16_f32 v137, v114, v115
v_mfma_f32_16x16x32_bf16 v[96:99], v[192:195], v[8:11], v[152:155]
v_exp_f32 v118, v118
v_mfma_f32_16x16x32_bf16 v[96:99], v[200:203], v[32:35], v[96:99]
v_cvt_pk_bf16_f32 v138, v116, v117
v_mfma_f32_16x16x32_bf16 v[96:99], v[208:211], v[56:59], v[96:99]
v_exp_f32 v119, v119
v_mfma_f32_16x16x32_bf16 v[96:99], v[216:219], v[80:83], v[96:99]
v_exp_f32 v120, v120
v_mfma_f32_16x16x32_bf16 v[104:107], v[192:195], v[12:15], v[156:159]
v_cvt_pk_bf16_f32 v139, v118, v119
v_mfma_f32_16x16x32_bf16 v[104:107], v[200:203], v[36:39], v[104:107]
v_exp_f32 v121, v121
v_mfma_f32_16x16x32_bf16 v[104:107], v[208:211], v[60:63], v[104:107]
v_exp_f32 v122, v122
v_mfma_f32_16x16x32_bf16 v[104:107], v[216:219], v[84:87], v[104:107]
v_cvt_pk_bf16_f32 v140, v120, v121
v_mfma_f32_16x16x32_bf16 v[100:103], v[196:199], v[8:11], v[152:155]
v_exp_f32 v123, v123
v_mfma_f32_16x16x32_bf16 v[100:103], v[204:207], v[32:35], v[100:103]
v_exp_f32 v124, v124
v_mfma_f32_16x16x32_bf16 v[100:103], v[212:215], v[56:59], v[100:103]
v_cvt_pk_bf16_f32 v141, v122, v123
v_mfma_f32_16x16x32_bf16 v[100:103], v[220:223], v[80:83], v[100:103]
v_exp_f32 v125, v125
v_mfma_f32_16x16x32_bf16 v[108:111], v[196:199], v[12:15], v[156:159]
v_exp_f32 v126, v126
v_mfma_f32_16x16x32_bf16 v[108:111], v[204:207], v[36:39], v[108:111]
v_cvt_pk_bf16_f32 v142, v124, v125
v_mfma_f32_16x16x32_bf16 v[108:111], v[212:215], v[60:63], v[108:111]
v_exp_f32 v127, v127
v_mfma_f32_16x16x32_bf16 v[108:111], v[220:223], v[84:87], v[108:111]
s_waitcnt vmcnt(8)
s_barrier
v_mfma_f32_16x16x32_bf16 a[128:131], a[192:195], v[128:131], a[128:131]
v_readfirstlane_b32 s34, v188
s_nop 0
s_cmp_lt_u32 s34, 8
s_cbranch_scc1 L_cntwait
L_cntok:
v_mfma_f32_16x16x32_bf16 a[160:163], a[192:195], v[132:135], a[160:163]
ds_read_b64_tr_b16 a[192:193], v240 offset:0
ds_read_b64_tr_b16 a[194:195], v240 offset:4096
s_add_u32 m0, s43, 32768
s_add_u32 s37, s76, s48
s_add_u32 s35, s37, 294912
v_mfma_f32_16x16x32_bf16 a[132:135], a[196:199], v[128:131], a[132:135]
buffer_load_dwordx4 v176, s[20:23], s35 offen offset:0  lds
v_cvt_pk_bf16_f32 v143, v126, v127
v_mfma_f32_16x16x32_bf16 a[164:167], a[196:199], v[132:135], a[164:167]
ds_read_b64_tr_b16 a[196:197], v241 offset:0
ds_read_b64_tr_b16 a[198:199], v241 offset:4096
v_mfma_f32_16x16x32_bf16 a[136:139], a[200:203], v[128:131], a[136:139]
v_mfma_f32_16x16x32_bf16 a[168:171], a[200:203], v[132:135], a[168:171]
ds_read_b64_tr_b16 a[200:201], v242 offset:0
ds_read_b64_tr_b16 a[202:203], v242 offset:4096
v_mfma_f32_16x16x32_bf16 a[140:143], a[204:207], v[128:131], a[140:143]
buffer_load_dwordx4 v177, s[20:23], s35 offen offset:1024  lds
v_mfma_f32_16x16x32_bf16 a[172:175], a[204:207], v[132:135], a[172:175]
ds_read_b64_tr_b16 a[204:205], v243 offset:0
ds_read_b64_tr_b16 a[206:207], v243 offset:4096
v_mfma_f32_16x16x32_bf16 a[144:147], a[208:211], v[128:131], a[144:147]
v_exp_f32 v96, v96
v_mfma_f32_16x16x32_bf16 a[176:179], a[208:211], v[132:135], a[176:179]
ds_read_b64_tr_b16 a[208:209], v244 offset:0
ds_read_b64_tr_b16 a[210:211], v244 offset:4096
v_mfma_f32_16x16x32_bf16 a[148:151], a[212:215], v[128:131], a[148:151]
buffer_load_dwordx4 v178, s[20:23], s35 offen offset:2048  lds
v_mfma_f32_16x16x32_bf16 a[180:183], a[212:215], v[132:135], a[180:183]
ds_read_b64_tr_b16 a[212:213], v245 offset:0
ds_read_b64_tr_b16 a[214:215], v245 offset:4096
v_mfma_f32_16x16x32_bf16 a[152:155], a[216:219], v[128:131], a[152:155]
v_exp_f32 v97, v97
v_mfma_f32_16x16x32_bf16 a[184:187], a[216:219], v[132:135], a[184:187]
ds_read_b64_tr_b16 a[216:217], v246 offset:0
ds_read_b64_tr_b16 a[218:219], v246 offset:4096
v_mfma_f32_16x16x32_bf16 a[156:159], a[220:223], v[128:131], a[156:159]
buffer_load_dwordx4 v179, s[20:23], s35 offen offset:3072  lds
v_mfma_f32_16x16x32_bf16 a[188:191], a[220:223], v[132:135], a[188:191]
ds_read_b64_tr_b16 a[220:221], v247 offset:0
ds_read_b64_tr_b16 a[222:223], v247 offset:4096
v_mfma_f32_16x16x32_bf16 a[240:243], a[248:251], v[128:131], a[240:243]
v_mfma_f32_16x16x32_bf16 a[244:247], a[248:251], v[132:135], a[244:247]
s_add_u32 m0, s43, 36864
s_add_u32 s35, s37, 331776
v_mfma_f32_16x16x32_bf16 v[112:115], v[192:195], v[16:19], v[160:163]
v_exp_f32 v98, v98
v_mfma_f32_16x16x32_bf16 v[112:115], v[200:203], v[40:43], v[112:115]
v_cvt_pk_bf16_f32 v128, v96, v97
v_mfma_f32_16x16x32_bf16 v[112:115], v[208:211], v[64:67], v[112:115]
buffer_load_dwordx4 v176, s[20:23], s35 offen offset:0  lds
v_mfma_f32_16x16x32_bf16 v[112:115], v[216:219], v[88:91], v[112:115]
v_exp_f32 v99, v99
v_mfma_f32_16x16x32_bf16 v[120:123], v[192:195], v[20:23], v[164:167]
v_exp_f32 v100, v100
v_mfma_f32_16x16x32_bf16 v[120:123], v[200:203], v[44:47], v[120:123]
v_cvt_pk_bf16_f32 v129, v98, v99
v_mfma_f32_16x16x32_bf16 v[120:123], v[208:211], v[68:71], v[120:123]
buffer_load_dwordx4 v177, s[20:23], s35 offen offset:1024  lds
v_mfma_f32_16x16x32_bf16 v[120:123], v[216:219], v[92:95], v[120:123]
v_exp_f32 v101, v101
v_mfma_f32_16x16x32_bf16 v[116:119], v[196:199], v[16:19], v[160:163]
v_exp_f32 v102, v102
v_mfma_f32_16x16x32_bf16 v[116:119], v[204:207], v[40:43], v[116:119]
v_cvt_pk_bf16_f32 v130, v100, v101
v_mfma_f32_16x16x32_bf16 v[116:119], v[212:215], v[64:67], v[116:119]
buffer_load_dwordx4 v178, s[20:23], s35 offen offset:2048  lds
v_mfma_f32_16x16x32_bf16 v[116:119], v[220:223], v[88:91], v[116:119]
v_exp_f32 v103, v103
v_mfma_f32_16x16x32_bf16 v[124:127], v[196:199], v[20:23], v[164:167]
v_exp_f32 v104, v104
v_mfma_f32_16x16x32_bf16 v[124:127], v[204:207], v[44:47], v[124:127]
v_cvt_pk_bf16_f32 v131, v102, v103
v_mfma_f32_16x16x32_bf16 v[124:127], v[212:215], v[68:71], v[124:127]
buffer_load_dwordx4 v179, s[20:23], s35 offen offset:3072  lds
v_mfma_f32_16x16x32_bf16 v[124:127], v[220:223], v[92:95], v[124:127]
s_waitcnt lgkmcnt(0)
v_mfma_f32_16x16x32_bf16 a[0:3], a[192:195], v[136:139], a[0:3]
s_barrier
v_mfma_f32_16x16x32_bf16 a[32:35], a[192:195], v[140:143], a[32:35]
v_exp_f32 v105, v105
v_mfma_f32_16x16x32_bf16 a[4:7], a[196:199], v[136:139], a[4:7]
v_exp_f32 v106, v106
v_mfma_f32_16x16x32_bf16 a[36:39], a[196:199], v[140:143], a[36:39]
v_cvt_pk_bf16_f32 v132, v104, v105
v_mfma_f32_16x16x32_bf16 a[8:11], a[200:203], v[136:139], a[8:11]
v_exp_f32 v107, v107
v_mfma_f32_16x16x32_bf16 a[40:43], a[200:203], v[140:143], a[40:43]
v_exp_f32 v108, v108
v_mfma_f32_16x16x32_bf16 a[12:15], a[204:207], v[136:139], a[12:15]
v_cvt_pk_bf16_f32 v133, v106, v107
v_mfma_f32_16x16x32_bf16 a[44:47], a[204:207], v[140:143], a[44:47]
v_exp_f32 v109, v109
v_mfma_f32_16x16x32_bf16 a[16:19], a[208:211], v[136:139], a[16:19]
v_exp_f32 v110, v110
v_mfma_f32_16x16x32_bf16 a[48:51], a[208:211], v[140:143], a[48:51]
v_cvt_pk_bf16_f32 v134, v108, v109
v_mfma_f32_16x16x32_bf16 a[20:23], a[212:215], v[136:139], a[20:23]
v_exp_f32 v112, v112
v_mfma_f32_16x16x32_bf16 a[52:55], a[212:215], v[140:143], a[52:55]
v_exp_f32 v111, v111
v_mfma_f32_16x16x32_bf16 a[24:27], a[216:219], v[136:139], a[24:27]
v_cvt_pk_bf16_f32 v135, v110, v111
v_mfma_f32_16x16x32_bf16 a[56:59], a[216:219], v[140:143], a[56:59]
v_exp_f32 v113, v113
v_mfma_f32_16x16x32_bf16 a[28:31], a[220:223], v[136:139], a[28:31]
v_mfma_f32_16x16x32_bf16 a[60:63], a[220:223], v[140:143], a[60:63]
v_mfma_f32_16x16x32_bf16 a[224:227], a[248:251], v[136:139], a[224:227]
v_mfma_f32_16x16x32_bf16 a[228:231], a[248:251], v[140:143], a[228:231]
v_exp_f32 v114, v114
v_mfma_f32_16x16x32_bf16 a[64:67], a[192:195], v[128:131], a[64:67]
v_cvt_pk_bf16_f32 v136, v112, v113
v_mfma_f32_16x16x32_bf16 a[96:99], a[192:195], v[132:135], a[96:99]
v_exp_f32 v115, v115
v_mfma_f32_16x16x32_bf16 a[68:71], a[196:199], v[128:131], a[68:71]
v_exp_f32 v116, v116
v_mfma_f32_16x16x32_bf16 a[100:103], a[196:199], v[132:135], a[100:103]
v_cvt_pk_bf16_f32 v137, v114, v115
v_mfma_f32_16x16x32_bf16 a[72:75], a[200:203], v[128:131], a[72:75]
v_exp_f32 v117, v117
v_mfma_f32_16x16x32_bf16 a[104:107], a[200:203], v[132:135], a[104:107]
v_exp_f32 v118, v118
v_mfma_f32_16x16x32_bf16 a[76:79], a[204:207], v[128:131], a[76:79]
v_cvt_pk_bf16_f32 v138, v116, v117
v_mfma_f32_16x16x32_bf16 a[108:111], a[204:207], v[132:135], a[108:111]
v_exp_f32 v119, v119
v_mfma_f32_16x16x32_bf16 a[80:83], a[208:211], v[128:131], a[80:83]
v_exp_f32 v120, v120
v_mfma_f32_16x16x32_bf16 a[112:115], a[208:211], v[132:135], a[112:115]
v_cvt_pk_bf16_f32 v139, v118, v119
v_mfma_f32_16x16x32_bf16 a[84:87], a[212:215], v[128:131], a[84:87]
v_exp_f32 v121, v121
v_mfma_f32_16x16x32_bf16 a[116:119], a[212:215], v[132:135], a[116:119]
v_exp_f32 v122, v122
v_mfma_f32_16x16x32_bf16 a[88:91], a[216:219], v[128:131], a[88:91]
v_cvt_pk_bf16_f32 v140, v120, v121
v_mfma_f32_16x16x32_bf16 a[120:123], a[216:219], v[132:135], a[120:123]
v_exp_f32 v123, v123
v_mfma_f32_16x16x32_bf16 a[92:95], a[220:223], v[128:131], a[92:95]
v_exp_f32 v124, v124
v_mfma_f32_16x16x32_bf16 a[124:127], a[220:223], v[132:135], a[124:127]
v_cvt_pk_bf16_f32 v141, v122, v123
v_mfma_f32_16x16x32_bf16 a[232:235], a[248:251], v[128:131], a[232:235]
v_exp_f32 v125, v125
v_mfma_f32_16x16x32_bf16 a[236:239], a[248:251], v[132:135], a[236:239]
v_exp_f32 v126, v126
v_cvt_pk_bf16_f32 v142, v124, v125
v_exp_f32 v127, v127
s_nop 0
v_cvt_pk_bf16_f32 v143, v126, v127
v_accvgpr_read_b32 v144, a224
v_rcp_f32 v170, v144
v_accvgpr_read_b32 v148, a228
v_rcp_f32 v171, v148
v_accvgpr_read_b32 v192, a0
v_accvgpr_read_b32 v193, a1
v_accvgpr_read_b32 v194, a2
v_accvgpr_read_b32 v195, a3
v_accvgpr_read_b32 v196, a4
v_accvgpr_read_b32 v197, a5
v_accvgpr_read_b32 v198, a6
v_accvgpr_read_b32 v199, a7
v_pk_mul_f32 v[192:193], v[192:193], v[170:171] op_sel:[0,0] op_sel_hi:[1,0]
v_pk_mul_f32 v[194:195], v[194:195], v[170:171] op_sel:[0,0] op_sel_hi:[1,0]
v_pk_mul_f32 v[196:197], v[196:197], v[170:171] op_sel:[0,0] op_sel_hi:[1,0]
v_pk_mul_f32 v[198:199], v[198:199], v[170:171] op_sel:[0,0] op_sel_hi:[1,0]
v_cvt_pk_bf16_f32 v208, v192, v193
v_cvt_pk_bf16_f32 v209, v194, v195
v_cvt_pk_bf16_f32 v210, v196, v197
v_cvt_pk_bf16_f32 v211, v198, v199
ds_write_b128 v181, v[208:211] offset:0
v_accvgpr_read_b32 v200, a8
v_accvgpr_read_b32 v201, a9
v_accvgpr_read_b32 v202, a10
v_accvgpr_read_b32 v203, a11
v_accvgpr_read_b32 v204, a12
v_accvgpr_read_b32 v205, a13
v_accvgpr_read_b32 v206, a14
v_accvgpr_read_b32 v207, a15
v_pk_mul_f32 v[200:201], v[200:201], v[170:171] op_sel:[0,0] op_sel_hi:[1,0]
v_pk_mul_f32 v[202:203], v[202:203], v[170:171] op_sel:[0,0] op_sel_hi:[1,0]
v_pk_mul_f32 v[204:205], v[204:205], v[170:171] op_sel:[0,0] op_sel_hi:[1,0]
v_pk_mul_f32 v[206:207], v[206:207], v[170:171] op_sel:[0,0] op_sel_hi:[1,0]
v_cvt_pk_bf16_f32 v212, v200, v201
v_cvt_pk_bf16_f32 v213, v202, v203
v_cvt_pk_bf16_f32 v214, v204, v205
v_cvt_pk_bf16_f32 v215, v206, v207
ds_write_b128 v181, v[212:215] offset:6144
v_accvgpr_read_b32 v192, a16
v_accvgpr_read_b32 v193, a17
v_accvgpr_read_b32 v194, a18
v_accvgpr_read_b32 v195, a19
v_accvgpr_read_b32 v196, a20
v_accvgpr_read_b32 v197, a21
v_accvgpr_read_b32 v198, a22
v_accvgpr_read_b32 v199, a23
v_pk_mul_f32 v[192:193], v[192:193], v[170:171] op_sel:[0,0] op_sel_hi:[1,0]
v_pk_mul_f32 v[194:195], v[194:195], v[170:171] op_sel:[0,0] op_sel_hi:[1,0]
v_pk_mul_f32 v[196:197], v[196:197], v[170:171] op_sel:[0,0] op_sel_hi:[1,0]
v_pk_mul_f32 v[198:199], v[198:199], v[170:171] op_sel:[0,0] op_sel_hi:[1,0]
v_cvt_pk_bf16_f32 v216, v192, v193
v_cvt_pk_bf16_f32 v217, v194, v195
v_cvt_pk_bf16_f32 v218, v196, v197
v_cvt_pk_bf16_f32 v219, v198, v199
ds_write_b128 v181, v[216:219] offset:12288
v_accvgpr_read_b32 v200, a24
v_accvgpr_read_b32 v201, a25
v_accvgpr_read_b32 v202, a26
v_accvgpr_read_b32 v203, a27
v_accvgpr_read_b32 v204, a28
v_accvgpr_read_b32 v205, a29
v_accvgpr_read_b32 v206, a30
v_accvgpr_read_b32 v207, a31
v_pk_mul_f32 v[200:201], v[200:201], v[170:171] op_sel:[0,0] op_sel_hi:[1,0]
v_pk_mul_f32 v[202:203], v[202:203], v[170:171] op_sel:[0,0] op_sel_hi:[1,0]
v_pk_mul_f32 v[204:205], v[204:205], v[170:171] op_sel:[0,0] op_sel_hi:[1,0]
v_pk_mul_f32 v[206:207], v[206:207], v[170:171] op_sel:[0,0] op_sel_hi:[1,0]
v_cvt_pk_bf16_f32 v220, v200, v201
v_cvt_pk_bf16_f32 v221, v202, v203
v_cvt_pk_bf16_f32 v222, v204, v205
v_cvt_pk_bf16_f32 v223, v206, v207
ds_write_b128 v181, v[220:223] offset:18432
v_accvgpr_read_b32 v192, a32
v_accvgpr_read_b32 v193, a33
v_accvgpr_read_b32 v194, a34
v_accvgpr_read_b32 v195, a35
v_accvgpr_read_b32 v196, a36
v_accvgpr_read_b32 v197, a37
v_accvgpr_read_b32 v198, a38
v_accvgpr_read_b32 v199, a39
v_pk_mul_f32 v[192:193], v[192:193], v[170:171] op_sel:[0,1] op_sel_hi:[1,1]
v_pk_mul_f32 v[194:195], v[194:195], v[170:171] op_sel:[0,1] op_sel_hi:[1,1]
v_pk_mul_f32 v[196:197], v[196:197], v[170:171] op_sel:[0,1] op_sel_hi:[1,1]
v_pk_mul_f32 v[198:199], v[198:199], v[170:171] op_sel:[0,1] op_sel_hi:[1,1]
v_cvt_pk_bf16_f32 v208, v192, v193
v_cvt_pk_bf16_f32 v209, v194, v195
v_cvt_pk_bf16_f32 v210, v196, v197
v_cvt_pk_bf16_f32 v211, v198, v199
ds_write_b128 v181, v[208:211] offset:1024
v_accvgpr_read_b32 v200, a40
v_accvgpr_read_b32 v201, a41
v_accvgpr_read_b32 v202, a42
v_accvgpr_read_b32 v203, a43
v_accvgpr_read_b32 v204, a44
v_accvgpr_read_b32 v205, a45
v_accvgpr_read_b32 v206, a46
v_accvgpr_read_b32 v207, a47
v_pk_mul_f32 v[200:201], v[200:201], v[170:171] op_sel:[0,1] op_sel_hi:[1,1]
v_pk_mul_f32 v[202:203], v[202:203], v[170:171] op_sel:[0,1] op_sel_hi:[1,1]
v_pk_mul_f32 v[204:205], v[204:205], v[170:171] op_sel:[0,1] op_sel_hi:[1,1]
v_pk_mul_f32 v[206:207], v[206:207], v[170:171] op_sel:[0,1] op_sel_hi:[1,1]
v_cvt_pk_bf16_f32 v212, v200, v201
v_cvt_pk_bf16_f32 v213, v202, v203
v_cvt_pk_bf16_f32 v214, v204, v205
v_cvt_pk_bf16_f32 v215, v206, v207
ds_write_b128 v181, v[212:215] offset:7168
v_accvgpr_read_b32 v192, a48
v_accvgpr_read_b32 v193, a49
v_accvgpr_read_b32 v194, a50
v_accvgpr_read_b32 v195, a51
v_accvgpr_read_b32 v196, a52
v_accvgpr_read_b32 v197, a53
v_accvgpr_read_b32 v198, a54
v_accvgpr_read_b32 v199, a55
v_pk_mul_f32 v[192:193], v[192:193], v[170:171] op_sel:[0,1] op_sel_hi:[1,1]
v_pk_mul_f32 v[194:195], v[194:195], v[170:171] op_sel:[0,1] op_sel_hi:[1,1]
v_pk_mul_f32 v[196:197], v[196:197], v[170:171] op_sel:[0,1] op_sel_hi:[1,1]
v_pk_mul_f32 v[198:199], v[198:199], v[170:171] op_sel:[0,1] op_sel_hi:[1,1]
v_cvt_pk_bf16_f32 v216, v192, v193
v_cvt_pk_bf16_f32 v217, v194, v195
v_cvt_pk_bf16_f32 v218, v196, v197
v_cvt_pk_bf16_f32 v219, v198, v199
ds_write_b128 v181, v[216:219] offset:13312
v_accvgpr_read_b32 v200, a56
v_accvgpr_read_b32 v201, a57
v_accvgpr_read_b32 v202, a58
v_accvgpr_read_b32 v203, a59
v_accvgpr_read_b32 v204, a60
v_accvgpr_read_b32 v205, a61
v_accvgpr_read_b32 v206, a62
v_accvgpr_read_b32 v207, a63
v_pk_mul_f32 v[200:201], v[200:201], v[170:171] op_sel:[0,1] op_sel_hi:[1,1]
v_pk_mul_f32 v[202:203], v[202:203], v[170:171] op_sel:[0,1] op_sel_hi:[1,1]
v_pk_mul_f32 v[204:205], v[204:205], v[170:171] op_sel:[0,1] op_sel_hi:[1,1]
v_pk_mul_f32 v[206:207], v[206:207], v[170:171] op_sel:[0,1] op_sel_hi:[1,1]
v_cvt_pk_bf16_f32 v220, v200, v201
v_cvt_pk_bf16_f32 v221, v202, v203
v_cvt_pk_bf16_f32 v222, v204, v205
v_cvt_pk_bf16_f32 v223, v206, v207
ds_write_b128 v181, v[220:223] offset:19456
v_accvgpr_read_b32 v152, a232
v_mfma_f32_16x16x32_bf16 a[128:131], a[192:195], v[136:139], a[128:131]
v_rcp_f32 v172, v152
v_mfma_f32_16x16x32_bf16 a[160:163], a[192:195], v[140:143], a[160:163]
v_accvgpr_read_b32 v156, a236
v_mfma_f32_16x16x32_bf16 a[132:135], a[196:199], v[136:139], a[132:135]
v_rcp_f32 v173, v156
v_mfma_f32_16x16x32_bf16 a[164:167], a[196:199], v[140:143], a[164:167]
v_accvgpr_read_b32 v192, a64
v_accvgpr_read_b32 v193, a65
v_mfma_f32_16x16x32_bf16 a[136:139], a[200:203], v[136:139], a[136:139]
v_accvgpr_read_b32 v194, a66
v_accvgpr_read_b32 v195, a67
v_mfma_f32_16x16x32_bf16 a[168:171], a[200:203], v[140:143], a[168:171]
v_accvgpr_read_b32 v196, a68
v_accvgpr_read_b32 v197, a69
v_mfma_f32_16x16x32_bf16 a[140:143], a[204:207], v[136:139], a[140:143]
v_accvgpr_read_b32 v198, a70
v_accvgpr_read_b32 v199, a71
v_mfma_f32_16x16x32_bf16 a[172:175], a[204:207], v[140:143], a[172:175]
v_pk_mul_f32 v[192:193], v[192:193], v[172:173] op_sel:[0,0] op_sel_hi:[1,0]
v_pk_mul_f32 v[194:195], v[194:195], v[172:173] op_sel:[0,0] op_sel_hi:[1,0]
v_mfma_f32_16x16x32_bf16 a[144:147], a[208:211], v[136:139], a[144:147]
v_pk_mul_f32 v[196:197], v[196:197], v[172:173] op_sel:[0,0] op_sel_hi:[1,0]
v_pk_mul_f32 v[198:199], v[198:199], v[172:173] op_sel:[0,0] op_sel_hi:[1,0]
v_mfma_f32_16x16x32_bf16 a[176:179], a[208:211], v[140:143], a[176:179]
v_cvt_pk_bf16_f32 v208, v192, v193
v_cvt_pk_bf16_f32 v209, v194, v195
v_mfma_f32_16x16x32_bf16 a[148:151], a[212:215], v[136:139], a[148:151]
v_cvt_pk_bf16_f32 v210, v196, v197
v_cvt_pk_bf16_f32 v211, v198, v199
v_mfma_f32_16x16x32_bf16 a[180:183], a[212:215], v[140:143], a[180:183]
ds_write_b128 v181, v[208:211] offset:2048
v_accvgpr_read_b32 v200, a72
v_mfma_f32_16x16x32_bf16 a[152:155], a[216:219], v[136:139], a[152:155]
v_accvgpr_read_b32 v201, a73
v_accvgpr_read_b32 v202, a74
v_mfma_f32_16x16x32_bf16 a[184:187], a[216:219], v[140:143], a[184:187]
v_accvgpr_read_b32 v203, a75
v_accvgpr_read_b32 v204, a76
v_mfma_f32_16x16x32_bf16 a[156:159], a[220:223], v[136:139], a[156:159]
v_accvgpr_read_b32 v205, a77
v_accvgpr_read_b32 v206, a78
v_mfma_f32_16x16x32_bf16 a[188:191], a[220:223], v[140:143], a[188:191]
v_accvgpr_read_b32 v207, a79
v_pk_mul_f32 v[200:201], v[200:201], v[172:173] op_sel:[0,0] op_sel_hi:[1,0]
v_mfma_f32_16x16x32_bf16 a[240:243], a[248:251], v[136:139], a[240:243]
v_pk_mul_f32 v[202:203], v[202:203], v[172:173] op_sel:[0,0] op_sel_hi:[1,0]
v_pk_mul_f32 v[204:205], v[204:205], v[172:173] op_sel:[0,0] op_sel_hi:[1,0]
v_mfma_f32_16x16x32_bf16 a[244:247], a[248:251], v[140:143], a[244:247]
v_pk_mul_f32 v[206:207], v[206:207], v[172:173] op_sel:[0,0] op_sel_hi:[1,0]
v_cvt_pk_bf16_f32 v212, v200, v201
v_cvt_pk_bf16_f32 v213, v202, v203
v_cvt_pk_bf16_f32 v214, v204, v205
v_cvt_pk_bf16_f32 v215, v206, v207
ds_write_b128 v181, v[212:215] offset:8192
v_accvgpr_read_b32 v192, a80
v_accvgpr_read_b32 v193, a81
v_accvgpr_read_b32 v194, a82
v_accvgpr_read_b32 v195, a83
v_accvgpr_read_b32 v196, a84
v_accvgpr_read_b32 v197, a85
v_accvgpr_read_b32 v198, a86
v_accvgpr_read_b32 v199, a87
v_pk_mul_f32 v[192:193], v[192:193], v[172:173] op_sel:[0,0] op_sel_hi:[1,0]
v_pk_mul_f32 v[194:195], v[194:195], v[172:173] op_sel:[0,0] op_sel_hi:[1,0]
v_pk_mul_f32 v[196:197], v[196:197], v[172:173] op_sel:[0,0] op_sel_hi:[1,0]
v_pk_mul_f32 v[198:199], v[198:199], v[172:173] op_sel:[0,0] op_sel_hi:[1,0]
v_cvt_pk_bf16_f32 v216, v192, v193
v_cvt_pk_bf16_f32 v217, v194, v195
v_cvt_pk_bf16_f32 v218, v196, v197
v_cvt_pk_bf16_f32 v219, v198, v199
ds_write_b128 v181, v[216:219] offset:14336
v_accvgpr_read_b32 v200, a88
v_accvgpr_read_b32 v201, a89
v_accvgpr_read_b32 v202, a90
v_accvgpr_read_b32 v203, a91
v_accvgpr_read_b32 v204, a92
v_accvgpr_read_b32 v205, a93
v_accvgpr_read_b32 v206, a94
v_accvgpr_read_b32 v207, a95
v_pk_mul_f32 v[200:201], v[200:201], v[172:173] op_sel:[0,0] op_sel_hi:[1,0]
v_pk_mul_f32 v[202:203], v[202:203], v[172:173] op_sel:[0,0] op_sel_hi:[1,0]
v_pk_mul_f32 v[204:205], v[204:205], v[172:173] op_sel:[0,0] op_sel_hi:[1,0]
v_pk_mul_f32 v[206:207], v[206:207], v[172:173] op_sel:[0,0] op_sel_hi:[1,0]
v_cvt_pk_bf16_f32 v220, v200, v201
v_cvt_pk_bf16_f32 v221, v202, v203
v_cvt_pk_bf16_f32 v222, v204, v205
v_cvt_pk_bf16_f32 v223, v206, v207
ds_write_b128 v181, v[220:223] offset:20480
v_accvgpr_read_b32 v192, a96
v_accvgpr_read_b32 v193, a97
v_accvgpr_read_b32 v194, a98
v_accvgpr_read_b32 v195, a99
v_accvgpr_read_b32 v196, a100
v_accvgpr_read_b32 v197, a101
v_accvgpr_read_b32 v198, a102
v_accvgpr_read_b32 v199, a103
v_pk_mul_f32 v[192:193], v[192:193], v[172:173] op_sel:[0,1] op_sel_hi:[1,1]
v_pk_mul_f32 v[194:195], v[194:195], v[172:173] op_sel:[0,1] op_sel_hi:[1,1]
v_pk_mul_f32 v[196:197], v[196:197], v[172:173] op_sel:[0,1] op_sel_hi:[1,1]
v_pk_mul_f32 v[198:199], v[198:199], v[172:173] op_sel:[0,1] op_sel_hi:[1,1]
v_cvt_pk_bf16_f32 v208, v192, v193
v_cvt_pk_bf16_f32 v209, v194, v195
v_cvt_pk_bf16_f32 v210, v196, v197
v_cvt_pk_bf16_f32 v211, v198, v199
ds_write_b128 v181, v[208:211] offset:3072
v_accvgpr_read_b32 v200, a104
v_accvgpr_read_b32 v201, a105
v_accvgpr_read_b32 v202, a106
v_accvgpr_read_b32 v203, a107
v_accvgpr_read_b32 v204, a108
v_accvgpr_read_b32 v205, a109
v_accvgpr_read_b32 v206, a110
v_accvgpr_read_b32 v207, a111
v_pk_mul_f32 v[200:201], v[200:201], v[172:173] op_sel:[0,1] op_sel_hi:[1,1]
v_pk_mul_f32 v[202:203], v[202:203], v[172:173] op_sel:[0,1] op_sel_hi:[1,1]
v_pk_mul_f32 v[204:205], v[204:205], v[172:173] op_sel:[0,1] op_sel_hi:[1,1]
v_pk_mul_f32 v[206:207], v[206:207], v[172:173] op_sel:[0,1] op_sel_hi:[1,1]
v_cvt_pk_bf16_f32 v212, v200, v201
v_cvt_pk_bf16_f32 v213, v202, v203
v_cvt_pk_bf16_f32 v214, v204, v205
v_cvt_pk_bf16_f32 v215, v206, v207
ds_write_b128 v181, v[212:215] offset:9216
v_accvgpr_read_b32 v192, a112
v_accvgpr_read_b32 v193, a113
v_accvgpr_read_b32 v194, a114
v_accvgpr_read_b32 v195, a115
v_accvgpr_read_b32 v196, a116
v_accvgpr_read_b32 v197, a117
v_accvgpr_read_b32 v198, a118
v_accvgpr_read_b32 v199, a119
v_pk_mul_f32 v[192:193], v[192:193], v[172:173] op_sel:[0,1] op_sel_hi:[1,1]
v_pk_mul_f32 v[194:195], v[194:195], v[172:173] op_sel:[0,1] op_sel_hi:[1,1]
v_pk_mul_f32 v[196:197], v[196:197], v[172:173] op_sel:[0,1] op_sel_hi:[1,1]
v_pk_mul_f32 v[198:199], v[198:199], v[172:173] op_sel:[0,1] op_sel_hi:[1,1]
v_cvt_pk_bf16_f32 v216, v192, v193
v_cvt_pk_bf16_f32 v217, v194, v195
v_cvt_pk_bf16_f32 v218, v196, v197
v_cvt_pk_bf16_f32 v219, v198, v199
ds_write_b128 v181, v[216:219] offset:15360
v_accvgpr_read_b32 v200, a120
v_accvgpr_read_b32 v201, a121
v_accvgpr_read_b32 v202, a122
v_accvgpr_read_b32 v203, a123
v_accvgpr_read_b32 v204, a124
v_accvgpr_read_b32 v205, a125
v_accvgpr_read_b32 v206, a126
v_accvgpr_read_b32 v207, a127
v_pk_mul_f32 v[200:201], v[200:201], v[172:173] op_sel:[0,1] op_sel_hi:[1,1]
v_pk_mul_f32 v[202:203], v[202:203], v[172:173] op_sel:[0,1] op_sel_hi:[1,1]
v_pk_mul_f32 v[204:205], v[204:205], v[172:173] op_sel:[0,1] op_sel_hi:[1,1]
v_pk_mul_f32 v[206:207], v[206:207], v[172:173] op_sel:[0,1] op_sel_hi:[1,1]
v_cvt_pk_bf16_f32 v220, v200, v201
v_cvt_pk_bf16_f32 v221, v202, v203
v_cvt_pk_bf16_f32 v222, v204, v205
v_cvt_pk_bf16_f32 v223, v206, v207
ds_write_b128 v181, v[220:223] offset:21504
v_accvgpr_read_b32 v160, a240
v_rcp_f32 v174, v160
v_accvgpr_read_b32 v164, a244
v_rcp_f32 v175, v164
v_max3_f32 v168, v144, v148, v152
v_max3_f32 v169, v156, v160, v164
v_max_f32 v168, v168, v169
v_cmp_lt_f32 vcc, s95, v168
s_cbranch_vccnz L_flag
L_flagged:
v_accvgpr_read_b32 v192, a128
v_accvgpr_read_b32 v193, a129
v_accvgpr_read_b32 v194, a130
v_accvgpr_read_b32 v195, a131
v_accvgpr_read_b32 v196, a132
v_accvgpr_read_b32 v197, a133
v_accvgpr_read_b32 v198, a134
v_accvgpr_read_b32 v199, a135
v_pk_mul_f32 v[192:193], v[192:193], v[174:175] op_sel:[0,0] op_sel_hi:[1,0]
v_pk_mul_f32 v[194:195], v[194:195], v[174:175] op_sel:[0,0] op_sel_hi:[1,0]
v_pk_mul_f32 v[196:197], v[196:197], v[174:175] op_sel:[0,0] op_sel_hi:[1,0]
v_pk_mul_f32 v[198:199], v[198:199], v[174:175] op_sel:[0,0] op_sel_hi:[1,0]
v_cvt_pk_bf16_f32 v208, v192, v193
v_cvt_pk_bf16_f32 v209, v194, v195
v_cvt_pk_bf16_f32 v210, v196, v197
v_cvt_pk_bf16_f32 v211, v198, v199
ds_write_b128 v181, v[208:211] offset:4096
v_accvgpr_read_b32 v200, a136
v_accvgpr_read_b32 v201, a137
v_accvgpr_read_b32 v202, a138
v_accvgpr_read_b32 v203, a139
v_accvgpr_read_b32 v204, a140
v_accvgpr_read_b32 v205, a141
v_accvgpr_read_b32 v206, a142
v_accvgpr_read_b32 v207, a143
v_pk_mul_f32 v[200:201], v[200:201], v[174:175] op_sel:[0,0] op_sel_hi:[1,0]
v_pk_mul_f32 v[202:203], v[202:203], v[174:175] op_sel:[0,0] op_sel_hi:[1,0]
v_pk_mul_f32 v[204:205], v[204:205], v[174:175] op_sel:[0,0] op_sel_hi:[1,0]
v_pk_mul_f32 v[206:207], v[206:207], v[174:175] op_sel:[0,0] op_sel_hi:[1,0]
v_cvt_pk_bf16_f32 v212, v200, v201
v_cvt_pk_bf16_f32 v213, v202, v203
v_cvt_pk_bf16_f32 v214, v204, v205
v_cvt_pk_bf16_f32 v215, v206, v207
ds_write_b128 v181, v[212:215] offset:10240
v_accvgpr_read_b32 v192, a144
v_accvgpr_read_b32 v193, a145
v_accvgpr_read_b32 v194, a146
v_accvgpr_read_b32 v195, a147
v_accvgpr_read_b32 v196, a148
v_accvgpr_read_b32 v197, a149
v_accvgpr_read_b32 v198, a150
v_accvgpr_read_b32 v199, a151
v_pk_mul_f32 v[192:193], v[192:193], v[174:175] op_sel:[0,0] op_sel_hi:[1,0]
v_pk_mul_f32 v[194:195], v[194:195], v[174:175] op_sel:[0,0] op_sel_hi:[1,0]
v_pk_mul_f32 v[196:197], v[196:197], v[174:175] op_sel:[0,0] op_sel_hi:[1,0]
v_pk_mul_f32 v[198:199], v[198:199], v[174:175] op_sel:[0,0] op_sel_hi:[1,0]
v_cvt_pk_bf16_f32 v216, v192, v193
v_cvt_pk_bf16_f32 v217, v194, v195
v_cvt_pk_bf16_f32 v218, v196, v197
v_cvt_pk_bf16_f32 v219, v198, v199
ds_write_b128 v181, v[216:219] offset:16384
v_accvgpr_read_b32 v200, a152
v_accvgpr_read_b32 v201, a153
v_accvgpr_read_b32 v202, a154
v_accvgpr_read_b32 v203, a155
v_accvgpr_read_b32 v204, a156
v_accvgpr_read_b32 v205, a157
v_accvgpr_read_b32 v206, a158
v_accvgpr_read_b32 v207, a159
v_pk_mul_f32 v[200:201], v[200:201], v[174:175] op_sel:[0,0] op_sel_hi:[1,0]
v_pk_mul_f32 v[202:203], v[202:203], v[174:175] op_sel:[0,0] op_sel_hi:[1,0]
v_pk_mul_f32 v[204:205], v[204:205], v[174:175] op_sel:[0,0] op_sel_hi:[1,0]
v_pk_mul_f32 v[206:207], v[206:207], v[174:175] op_sel:[0,0] op_sel_hi:[1,0]
v_cvt_pk_bf16_f32 v220, v200, v201
v_cvt_pk_bf16_f32 v221, v202, v203
v_cvt_pk_bf16_f32 v222, v204, v205
v_cvt_pk_bf16_f32 v223, v206, v207
ds_write_b128 v181, v[220:223] offset:22528
v_accvgpr_read_b32 v192, a160
v_accvgpr_read_b32 v193, a161
v_accvgpr_read_b32 v194, a162
v_accvgpr_read_b32 v195, a163
v_accvgpr_read_b32 v196, a164
v_accvgpr_read_b32 v197, a165
v_accvgpr_read_b32 v198, a166
v_accvgpr_read_b32 v199, a167
v_pk_mul_f32 v[192:193], v[192:193], v[174:175] op_sel:[0,1] op_sel_hi:[1,1]
v_pk_mul_f32 v[194:195], v[194:195], v[174:175] op_sel:[0,1] op_sel_hi:[1,1]
v_pk_mul_f32 v[196:197], v[196:197], v[174:175] op_sel:[0,1] op_sel_hi:[1,1]
v_pk_mul_f32 v[198:199], v[198:199], v[174:175] op_sel:[0,1] op_sel_hi:[1,1]
v_cvt_pk_bf16_f32 v208, v192, v193
v_cvt_pk_bf16_f32 v209, v194, v195
v_cvt_pk_bf16_f32 v210, v196, v197
v_cvt_pk_bf16_f32 v211, v198, v199
ds_write_b128 v181, v[208:211] offset:5120
v_accvgpr_read_b32 v200, a168
v_accvgpr_read_b32 v201, a169
v_accvgpr_read_b32 v202, a170
v_accvgpr_read_b32 v203, a171
v_accvgpr_read_b32 v204, a172
v_accvgpr_read_b32 v205, a173
v_accvgpr_read_b32 v206, a174
v_accvgpr_read_b32 v207, a175
v_pk_mul_f32 v[200:201], v[200:201], v[174:175] op_sel:[0,1] op_sel_hi:[1,1]
v_pk_mul_f32 v[202:203], v[202:203], v[174:175] op_sel:[0,1] op_sel_hi:[1,1]
v_pk_mul_f32 v[204:205], v[204:205], v[174:175] op_sel:[0,1] op_sel_hi:[1,1]
v_pk_mul_f32 v[206:207], v[206:207], v[174:175] op_sel:[0,1] op_sel_hi:[1,1]
v_cvt_pk_bf16_f32 v212, v200, v201
v_cvt_pk_bf16_f32 v213, v202, v203
v_cvt_pk_bf16_f32 v214, v204, v205
v_cvt_pk_bf16_f32 v215, v206, v207
ds_write_b128 v181, v[212:215] offset:11264
v_accvgpr_read_b32 v192, a176
v_accvgpr_read_b32 v193, a177
v_accvgpr_read_b32 v194, a178
v_accvgpr_read_b32 v195, a179
v_accvgpr_read_b32 v196, a180
v_accvgpr_read_b32 v197, a181
v_accvgpr_read_b32 v198, a182
v_accvgpr_read_b32 v199, a183
v_pk_mul_f32 v[192:193], v[192:193], v[174:175] op_sel:[0,1] op_sel_hi:[1,1]
v_pk_mul_f32 v[194:195], v[194:195], v[174:175] op_sel:[0,1] op_sel_hi:[1,1]
v_pk_mul_f32 v[196:197], v[196:197], v[174:175] op_sel:[0,1] op_sel_hi:[1,1]
v_pk_mul_f32 v[198:199], v[198:199], v[174:175] op_sel:[0,1] op_sel_hi:[1,1]
v_cvt_pk_bf16_f32 v216, v192, v193
v_cvt_pk_bf16_f32 v217, v194, v195
v_cvt_pk_bf16_f32 v218, v196, v197
v_cvt_pk_bf16_f32 v219, v198, v199
ds_write_b128 v181, v[216:219] offset:17408
v_accvgpr_read_b32 v200, a184
v_accvgpr_read_b32 v201, a185
v_accvgpr_read_b32 v202, a186
v_accvgpr_read_b32 v203, a187
v_accvgpr_read_b32 v204, a188
v_accvgpr_read_b32 v205, a189
v_accvgpr_read_b32 v206, a190
v_accvgpr_read_b32 v207, a191
v_pk_mul_f32 v[200:201], v[200:201], v[174:175] op_sel:[0,1] op_sel_hi:[1,1]
v_pk_mul_f32 v[202:203], v[202:203], v[174:175] op_sel:[0,1] op_sel_hi:[1,1]
v_pk_mul_f32 v[204:205], v[204:205], v[174:175] op_sel:[0,1] op_sel_hi:[1,1]
v_pk_mul_f32 v[206:207], v[206:207], v[174:175] op_sel:[0,1] op_sel_hi:[1,1]
v_cvt_pk_bf16_f32 v220, v200, v201
v_cvt_pk_bf16_f32 v221, v202, v203
v_cvt_pk_bf16_f32 v222, v204, v205
v_cvt_pk_bf16_f32 v223, v206, v207
ds_write_b128 v181, v[220:223] offset:23552
s_waitcnt vmcnt(8) lgkmcnt(0)
s_barrier
buffer_load_dword v187, off, s[24:27], s47 sc1
ds_read_b128 a[0:3], v182 offset:0
ds_read_b128 a[4:7], v182 offset:1024
ds_read_b128 a[8:11], v182 offset:2048
ds_read_b128 a[12:15], v182 offset:3072
ds_read_b128 a[16:19], v182 offset:4096
ds_read_b128 a[20:23], v182 offset:5120
ds_read_b64_tr_b16 v[192:193], v180 offset:0
ds_read_b64_tr_b16 v[194:195], v180 offset:2048
ds_read_b128 a[24:27], v182 offset:6144
ds_read_b128 a[28:31], v182 offset:7168
ds_read_b128 a[32:35], v182 offset:8192
ds_read_b128 a[36:39], v182 offset:9216
ds_read_b128 a[40:43], v182 offset:10240
ds_read_b128 a[44:47], v182 offset:11264
ds_read_b64_tr_b16 v[196:197], v180 offset:4096
ds_read_b64_tr_b16 v[198:199], v180 offset:6144
ds_read_b128 a[48:51], v182 offset:12288
s_waitcnt lgkmcnt(9)
v_mfma_f32_16x16x32_bf16 v[128:131], v[192:195], a[0:3], 0
ds_read_b64_tr_b16 v[200:201], v180 offset:8192
ds_read_b128 a[52:55], v182 offset:13312
v_mfma_f32_16x16x32_bf16 v[132:135], v[192:195], a[4:7], 0
ds_read_b64_tr_b16 v[202:203], v180 offset:10240
ds_read_b128 a[56:59], v182 offset:14336
v_mfma_f32_16x16x32_bf16 v[136:139], v[192:195], a[8:11], 0
ds_read_b128 a[60:63], v182 offset:15360
ds_read_b128 a[64:67], v182 offset:16384
v_mfma_f32_16x16x32_bf16 v[140:143], v[192:195], a[12:15], 0
ds_read_b128 a[68:71], v182 offset:17408
ds_read_b128 a[72:75], v182 offset:18432
v_mfma_f32_16x16x32_bf16 v[144:147], v[192:195], a[16:19], 0
ds_read_b128 a[76:79], v182 offset:19456
ds_read_b128 a[80:83], v182 offset:20480
v_mfma_f32_16x16x32_bf16 v[148:151], v[192:195], a[20:23], 0
ds_read_b128 a[84:87], v182 offset:21504
s_waitcnt lgkmcnt(12)
v_mfma_f32_16x16x32_bf16 v[128:131], v[196:199], a[24:27], v[128:131]
ds_read_b64_tr_b16 v[204:205], v180 offset:12288
ds_read_b128 a[88:91], v182 offset:22528
v_mfma_f32_16x16x32_bf16 v[132:135], v[196:199], a[28:31], v[132:135]
ds_read_b64_tr_b16 v[206:207], v180 offset:14336
ds_read_b128 a[92:95], v182 offset:23552
v_mfma_f32_16x16x32_bf16 v[136:139], v[196:199], a[32:35], v[136:139]
ds_read_b128 a[96:99], v182 offset:24576
ds_read_b128 a[100:103], v182 offset:25600
v_mfma_f32_16x16x32_bf16 v[140:143], v[196:199], a[36:39], v[140:143]
ds_read_b128 a[104:107], v182 offset:26624
ds_read_b128 a[108:111], v182 offset:27648
v_mfma_f32_16x16x32_bf16 v[144:147], v[196:199], a[40:43], v[144:147]
ds_read_b128 a[112:115], v182 offset:28672
ds_read_b128 a[116:119], v182 offset:29696
v_mfma_f32_16x16x32_bf16 v[148:151], v[196:199], a[44:47], v[148:151]
ds_read_b128 a[120:123], v182 offset:30720
s_waitcnt lgkmcnt(15)
v_mfma_f32_16x16x32_bf16 v[128:131], v[200:203], a[48:51], v[128:131]
ds_read_b64_tr_b16 v[192:193], v180 offset:16384
ds_read_b128 a[124:127], v182 offset:31744
v_mfma_f32_16x16x32_bf16 v[132:135], v[200:203], a[52:55], v[132:135]
ds_read_b64_tr_b16 v[194:195], v180 offset:18432
ds_read_b128 a[128:131], v182 offset:32768
v_mfma_f32_16x16x32_bf16 v[136:139], v[200:203], a[56:59], v[136:139]
ds_read_b128 a[132:135], v182 offset:33792
ds_read_b128 a[136:139], v182 offset:34816
v_mfma_f32_16x16x32_bf16 v[140:143], v[200:203], a[60:63], v[140:143]
ds_read_b128 a[140:143], v182 offset:35840
ds_read_b128 a[144:147], v182 offset:36864
v_mfma_f32_16x16x32_bf16 v[144:147], v[200:203], a[64:67], v[144:147]
ds_read_b128 a[148:151], v182 offset:37888
ds_read_b128 a[152:155], v182 offset:38912
v_mfma_f32_16x16x32_bf16 v[148:151], v[200:203], a[68:71], v[148:151]
ds_read_b128 a[156:159], v182 offset:39936
s_waitcnt lgkmcnt(15)
v_mfma_f32_16x16x32_bf16 v[128:131], v[204:207], a[72:75], v[128:131]
ds_read_b64_tr_b16 v[196:197], v180 offset:20480
ds_read_b128 a[160:163], v182 offset:40960
v_mfma_f32_16x16x32_bf16 v[132:135], v[204:207], a[76:79], v[132:135]
ds_read_b64_tr_b16 v[198:199], v180 offset:22528
ds_read_b128 a[164:167], v182 offset:41984
v_mfma_f32_16x16x32_bf16 v[136:139], v[204:207], a[80:83], v[136:139]
ds_read_b128 a[168:171], v182 offset:43008
ds_read_b128 a[172:175], v182 offset:44032
v_mfma_f32_16x16x32_bf16 v[140:143], v[204:207], a[84:87], v[140:143]
ds_read_b128 a[176:179], v182 offset:45056
ds_read_b128 a[180:183], v182 offset:46080
v_mfma_f32_16x16x32_bf16 v[144:147], v[204:207], a[88:91], v[144:147]
ds_read_b128 a[184:187], v182 offset:47104
ds_read_b128 a[188:191], v182 offset:48128
v_mfma_f32_16x16x32_bf16 v[148:151], v[204:207], a[92:95], v[148:151]
s_waitcnt lgkmcnt(15)
v_mfma_f32_16x16x32_bf16 v[128:131], v[192:195], a[96:99], v[128:131]
ds_read_b64_tr_b16 v[200:201], v180 offset:24576
v_mfma_f32_16x16x32_bf16 v[132:135], v[192:195], a[100:103], v[132:135]
ds_read_b64_tr_b16 v[202:203], v180 offset:26624
v_mfma_f32_16x16x32_bf16 v[136:139], v[192:195], a[104:107], v[136:139]
v_mfma_f32_16x16x32_bf16 v[140:143], v[192:195], a[108:111], v[140:143]
v_mfma_f32_16x16x32_bf16 v[144:147], v[192:195], a[112:115], v[144:147]
v_mfma_f32_16x16x32_bf16 v[148:151], v[192:195], a[116:119], v[148:151]
s_waitcnt lgkmcnt(9)
v_mfma_f32_16x16x32_bf16 v[128:131], v[196:199], a[120:123], v[128:131]
ds_read_b64_tr_b16 v[204:205], v180 offset:28672
v_mfma_f32_16x16x32_bf16 v[132:135], v[196:199], a[124:127], v[132:135]
ds_read_b64_tr_b16 v[206:207], v180 offset:30720
v_mfma_f32_16x16x32_bf16 v[136:139], v[196:199], a[128:131], v[136:139]
v_mfma_f32_16x16x32_bf16 v[140:143], v[196:199], a[132:135], v[140:143]
v_mfma_f32_16x16x32_bf16 v[144:147], v[196:199], a[136:139], v[144:147]
s_add_u32 m0, s43, 0
s_add_u32 s37, s76, s49
v_mfma_f32_16x16x32_bf16 v[148:151], v[196:199], a[140:143], v[148:151]
s_waitcnt vmcnt(1) lgkmcnt(0)
s_barrier
s_add_u32 s35, s37, 0
v_mfma_f32_16x16x32_bf16 v[128:131], v[200:203], a[144:147], v[128:131]
ds_read_b64_tr_b16 v[192:193], v180 offset:32768
buffer_load_dwordx4 v176, s[20:23], s35 offen offset:0  lds
v_mfma_f32_16x16x32_bf16 v[132:135], v[200:203], a[148:151], v[132:135]
ds_read_b64_tr_b16 v[194:195], v180 offset:34816
ds_read_b128 a[192:195], v183 offset:0
v_mfma_f32_16x16x32_bf16 v[136:139], v[200:203], a[152:155], v[136:139]
ds_read_b128 a[196:199], v183 offset:1024
ds_read_b128 a[200:203], v183 offset:2048
v_mfma_f32_16x16x32_bf16 v[140:143], v[200:203], a[156:159], v[140:143]
buffer_load_dwordx4 v177, s[20:23], s35 offen offset:1024  lds
ds_read_b128 a[204:207], v183 offset:3072
v_mfma_f32_16x16x32_bf16 v[144:147], v[200:203], a[160:163], v[144:147]
ds_read_b128 a[208:211], v183 offset:4096
ds_read_b128 a[212:215], v183 offset:5120
v_mfma_f32_16x16x32_bf16 v[148:151], v[200:203], a[164:167], v[148:151]
ds_read_b128 a[216:219], v183 offset:6144
v_mfma_f32_16x16x32_bf16 v[128:131], v[204:207], a[168:171], v[128:131]
ds_read_b64_tr_b16 v[196:197], v180 offset:36864
buffer_load_dwordx4 v178, s[20:23], s35 offen offset:2048  lds
v_mfma_f32_16x16x32_bf16 v[132:135], v[204:207], a[172:175], v[132:135]
ds_read_b64_tr_b16 v[198:199], v180 offset:38912
ds_read_b128 a[220:223], v183 offset:7168
v_mfma_f32_16x16x32_bf16 v[136:139], v[204:207], a[176:179], v[136:139]
ds_read_b128 a[224:227], v183 offset:8192
ds_read_b128 a[228:231], v183 offset:9216
v_mfma_f32_16x16x32_bf16 v[140:143], v[204:207], a[180:183], v[140:143]
buffer_load_dwordx4 v179, s[20:23], s35 offen offset:3072  lds
s_add_u32 m0, s43, 4096
v_mfma_f32_16x16x32_bf16 v[144:147], v[204:207], a[184:187], v[144:147]
s_add_u32 s35, s37, 36864
ds_read_b128 a[232:235], v183 offset:10240
v_mfma_f32_16x16x32_bf16 v[148:151], v[204:207], a[188:191], v[148:151]
ds_read_b128 a[236:239], v183 offset:11264
s_waitcnt lgkmcnt(13)
v_mfma_f32_16x16x32_bf16 v[128:131], v[192:195], a[192:195], v[128:131]
ds_read_b64_tr_b16 v[200:201], v180 offset:40960
buffer_load_dwordx4 v176, s[20:23], s35 offen offset:0  lds
s_waitcnt lgkmcnt(13)
v_mfma_f32_16x16x32_bf16 v[132:135], v[192:195], a[196:199], v[132:135]
ds_read_b64_tr_b16 v[202:203], v180 offset:43008
ds_read_b128 a[240:243], v183 offset:12288
s_waitcnt lgkmcnt(14)
v_mfma_f32_16x16x32_bf16 v[136:139], v[192:195], a[200:203], v[136:139]
ds_read_b128 a[244:247], v183 offset:13312
ds_read_b128 a[248:251], v183 offset:14336
s_waitcnt lgkmcnt(15)
v_mfma_f32_16x16x32_bf16 v[140:143], v[192:195], a[204:207], v[140:143]
buffer_load_dwordx4 v177, s[20:23], s35 offen offset:1024  lds
ds_read_b128 a[252:255], v183 offset:15360
s_waitcnt lgkmcnt(15)
v_mfma_f32_16x16x32_bf16 v[144:147], v[192:195], a[208:211], v[144:147]
ds_read_b128 v[0:3], v183 offset:16384
ds_read_b128 v[4:7], v183 offset:17408
s_waitcnt lgkmcnt(15)
v_mfma_f32_16x16x32_bf16 v[148:151], v[192:195], a[212:215], v[148:151]
ds_read_b128 v[8:11], v183 offset:18432
s_waitcnt lgkmcnt(14)
v_mfma_f32_16x16x32_bf16 v[128:131], v[196:199], a[216:219], v[128:131]
ds_read_b64_tr_b16 v[204:205], v180 offset:45056
buffer_load_dwordx4 v178, s[20:23], s35 offen offset:2048  lds
s_waitcnt lgkmcnt(14)
v_mfma_f32_16x16x32_bf16 v[132:135], v[196:199], a[220:223], v[132:135]
ds_read_b64_tr_b16 v[206:207], v180 offset:47104
ds_read_b128 v[12:15], v183 offset:19456
s_waitcnt lgkmcnt(15)
v_mfma_f32_16x16x32_bf16 v[136:139], v[196:199], a[224:227], v[136:139]
ds_read_b128 v[16:19], v183 offset:20480
ds_read_b128 v[20:23], v183 offset:21504
s_waitcnt lgkmcnt(15)
v_mfma_f32_16x16x32_bf16 v[140:143], v[196:199], a[228:231], v[140:143]
buffer_load_dwordx4 v179, s[20:23], s35 offen offset:3072  lds
s_add_u32 m0, s43, 65536
v_mfma_f32_16x16x32_bf16 v[144:147], v[196:199], a[232:235], v[144:147]
s_add_u32 s37, s76, s49
s_add_u32 s35, s37, 294912
s_waitcnt lgkmcnt(14)
v_mfma_f32_16x16x32_bf16 v[148:151], v[196:199], a[236:239], v[148:151]
ds_read_b128 v[24:27], v183 offset:22528
s_waitcnt lgkmcnt(12)
v_mfma_f32_16x16x32_bf16 v[128:131], v[200:203], a[240:243], v[128:131]
ds_read_b64_tr_b16 v[192:193], v180 offset:49152
buffer_load_dwordx4 v176, s[20:23], s35 offen offset:0  lds
s_waitcnt lgkmcnt(12)
v_mfma_f32_16x16x32_bf16 v[132:135], v[200:203], a[244:247], v[132:135]
ds_read_b64_tr_b16 v[194:195], v180 offset:51200
ds_read_b128 v[28:31], v183 offset:23552
s_waitcnt lgkmcnt(13)
v_mfma_f32_16x16x32_bf16 v[136:139], v[200:203], a[248:251], v[136:139]
ds_read_b128 v[32:35], v183 offset:24576
ds_read_b128 v[36:39], v183 offset:25600
s_waitcnt lgkmcnt(14)
v_mfma_f32_16x16x32_bf16 v[140:143], v[200:203], a[252:255], v[140:143]
buffer_load_dwordx4 v177, s[20:23], s35 offen offset:1024  lds
ds_read_b128 v[40:43], v183 offset:26624
s_waitcnt lgkmcnt(14)
v_mfma_f32_16x16x32_bf16 v[144:147], v[200:203], v[0:3], v[144:147]
ds_read_b128 v[44:47], v183 offset:27648
ds_read_b128 v[48:51], v183 offset:28672
s_waitcnt lgkmcnt(15)
v_mfma_f32_16x16x32_bf16 v[148:151], v[200:203], v[4:7], v[148:151]
ds_read_b128 v[52:55], v183 offset:29696
s_waitcnt lgkmcnt(13)
v_mfma_f32_16x16x32_bf16 v[128:131], v[204:207], v[8:11], v[128:131]
ds_read_b64_tr_b16 v[196:197], v180 offset:53248
buffer_load_dwordx4 v178, s[20:23], s35 offen offset:2048  lds
s_waitcnt lgkmcnt(13)
v_mfma_f32_16x16x32_bf16 v[132:135], v[204:207], v[12:15], v[132:135]
ds_read_b64_tr_b16 v[198:199], v180 offset:55296
ds_read_b128 v[56:59], v183 offset:30720
s_waitcnt lgkmcnt(14)
v_mfma_f32_16x16x32_bf16 v[136:139], v[204:207], v[16:19], v[136:139]
ds_read_b128 v[60:63], v183 offset:31744
ds_read_b128 v[64:67], v183 offset:32768
s_waitcnt lgkmcnt(15)
v_mfma_f32_16x16x32_bf16 v[140:143], v[204:207], v[20:23], v[140:143]
buffer_load_dwordx4 v179, s[20:23], s35 offen offset:3072  lds
s_add_u32 m0, s43, 69632
s_waitcnt lgkmcnt(14)
v_mfma_f32_16x16x32_bf16 v[144:147], v[204:207], v[24:27], v[144:147]
s_add_u32 s35, s37, 331776
ds_read_b128 v[68:71], v183 offset:33792
s_waitcnt lgkmcnt(12)
v_mfma_f32_16x16x32_bf16 v[148:151], v[204:207], v[28:31], v[148:151]
ds_read_b128 v[72:75], v183 offset:34816
s_waitcnt lgkmcnt(12)
v_mfma_f32_16x16x32_bf16 v[128:131], v[192:195], v[32:35], v[128:131]
ds_read_b64_tr_b16 v[200:201], v180 offset:57344
buffer_load_dwordx4 v176, s[20:23], s35 offen offset:0  lds
s_waitcnt lgkmcnt(12)
v_mfma_f32_16x16x32_bf16 v[132:135], v[192:195], v[36:39], v[132:135]
ds_read_b64_tr_b16 v[202:203], v180 offset:59392
ds_read_b128 v[76:79], v183 offset:35840
s_waitcnt lgkmcnt(13)
v_mfma_f32_16x16x32_bf16 v[136:139], v[192:195], v[40:43], v[136:139]
ds_read_b128 v[80:83], v183 offset:36864
ds_read_b128 v[84:87], v183 offset:37888
s_waitcnt lgkmcnt(14)
v_mfma_f32_16x16x32_bf16 v[140:143], v[192:195], v[44:47], v[140:143]
buffer_load_dwordx4 v177, s[20:23], s35 offen offset:1024  lds
ds_read_b128 v[88:91], v183 offset:38912
s_waitcnt lgkmcnt(14)
v_mfma_f32_16x16x32_bf16 v[144:147], v[192:195], v[48:51], v[144:147]
ds_read_b128 v[92:95], v183 offset:39936
ds_read_b128 v[96:99], v183 offset:40960
s_waitcnt lgkmcnt(15)
v_mfma_f32_16x16x32_bf16 v[148:151], v[192:195], v[52:55], v[148:151]
ds_read_b128 v[100:103], v183 offset:41984
ds_read_b128 v[104:107], v183 offset:43008
ds_read_b128 v[108:111], v183 offset:44032
ds_read_b128 v[112:115], v183 offset:45056
ds_read_b128 v[116:119], v183 offset:46080
ds_read_b128 v[120:123], v183 offset:47104
ds_read_b128 v[124:127], v183 offset:48128
s_waitcnt lgkmcnt(15)
v_mfma_f32_16x16x32_bf16 v[128:131], v[196:199], v[56:59], v[128:131]
ds_read_b64_tr_b16 v[204:205], v180 offset:61440
buffer_load_dwordx4 v178, s[20:23], s35 offen offset:2048  lds
v_mfma_f32_16x16x32_bf16 v[132:135], v[196:199], v[60:63], v[132:135]
ds_read_b64_tr_b16 v[206:207], v180 offset:63488
v_mfma_f32_16x16x32_bf16 v[136:139], v[196:199], v[64:67], v[136:139]
v_mfma_f32_16x16x32_bf16 v[140:143], v[196:199], v[68:71], v[140:143]
buffer_load_dwordx4 v179, s[20:23], s35 offen offset:3072  lds
v_mfma_f32_16x16x32_bf16 v[144:147], v[196:199], v[72:75], v[144:147]
s_add_u32 m0, s43, 32768
s_add_u32 s37, s76, s50
s_waitcnt lgkmcnt(14)
v_mfma_f32_16x16x32_bf16 v[148:151], v[196:199], v[76:79], v[148:151]
s_waitcnt vmcnt(8) lgkmcnt(0)
s_barrier
s_add_u32 s35, s37, 0
v_mfma_f32_16x16x32_bf16 v[128:131], v[200:203], v[80:83], v[128:131]
ds_read_b64_tr_b16 v[192:193], v180 offset:0
buffer_load_dwordx4 v176, s[20:23], s35 offen offset:0  lds
v_mfma_f32_16x16x32_bf16 v[132:135], v[200:203], v[84:87], v[132:135]
ds_read_b64_tr_b16 v[194:195], v180 offset:2048
v_mfma_f32_16x16x32_bf16 v[136:139], v[200:203], v[88:91], v[136:139]
v_mfma_f32_16x16x32_bf16 v[140:143], v[200:203], v[92:95], v[140:143]
buffer_load_dwordx4 v177, s[20:23], s35 offen offset:1024  lds
v_mfma_f32_16x16x32_bf16 v[144:147], v[200:203], v[96:99], v[144:147]
v_mfma_f32_16x16x32_bf16 v[148:151], v[200:203], v[100:103], v[148:151]
v_mfma_f32_16x16x32_bf16 v[128:131], v[204:207], v[104:107], v[128:131]
ds_read_b64_tr_b16 v[196:197], v180 offset:4096
buffer_load_dwordx4 v178, s[20:23], s35 offen offset:2048  lds
v_mfma_f32_16x16x32_bf16 v[132:135], v[204:207], v[108:111], v[132:135]
ds_read_b64_tr_b16 v[198:199], v180 offset:6144
v_mfma_f32_16x16x32_bf16 v[136:139], v[204:207], v[112:115], v[136:139]
v_mfma_f32_16x16x32_bf16 v[140:143], v[204:207], v[116:119], v[140:143]
buffer_load_dwordx4 v179, s[20:23], s35 offen offset:3072  lds
s_add_u32 m0, s43, 36864
v_mfma_f32_16x16x32_bf16 v[144:147], v[204:207], v[120:123], v[144:147]
s_add_u32 s35, s37, 36864
v_mfma_f32_16x16x32_bf16 v[148:151], v[204:207], v[124:127], v[148:151]
s_waitcnt lgkmcnt(0)
v_mfma_f32_16x16x32_bf16 v[152:155], v[192:195], a[0:3], 0
ds_read_b64_tr_b16 v[200:201], v180 offset:8192
buffer_load_dwordx4 v176, s[20:23], s35 offen offset:0  lds
v_mfma_f32_16x16x32_bf16 v[152:155], v[196:199], a[24:27], v[152:155]
ds_read_b64_tr_b16 v[202:203], v180 offset:10240
v_mfma_f32_16x16x32_bf16 v[156:159], v[192:195], a[4:7], 0
ds_read_b64_tr_b16 v[204:205], v180 offset:12288
v_readfirstlane_b32 s34, v187
s_nop 0
s_andn2_b32 s34, s34, s77
s_bitcmp1_b32 s34, 0
s_cbranch_scc1 L_redo
v_mfma_f32_16x16x32_bf16 v[156:159], v[196:199], a[28:31], v[156:159]
ds_read_b64_tr_b16 v[206:207], v180 offset:14336
buffer_load_dwordx4 v177, s[20:23], s35 offen offset:1024  lds
v_mfma_f32_16x16x32_bf16 v[160:163], v[192:195], a[8:11], 0
v_mfma_f32_16x16x32_bf16 v[160:163], v[196:199], a[32:35], v[160:163]
s_mul_i32 s41, s48, 96
s_add_u32 s41, s41, s42
v_mfma_f32_16x16x32_bf16 v[164:167], v[192:195], a[12:15], 0
buffer_load_dwordx4 v178, s[20:23], s35 offen offset:2048  lds
v_cvt_pk_bf16_f32 v208, v128, v129
v_mfma_f32_16x16x32_bf16 v[164:167], v[196:199], a[36:39], v[164:167]
v_cvt_pk_bf16_f32 v209, v130, v131
v_cvt_pk_bf16_f32 v210, v132, v133
v_mfma_f32_16x16x32_bf16 v[168:171], v[192:195], a[16:19], 0
v_cvt_pk_bf16_f32 v211, v134, v135
buffer_store_dwordx4 v[208:211], v184, s[24:27], s41 offen offset:0 sc1
v_mfma_f32_16x16x32_bf16 v[168:171], v[196:199], a[40:43], v[168:171]
buffer_load_dwordx4 v179, s[20:23], s35 offen offset:3072  lds
s_add_u32 m0, s43, 98304
v_mfma_f32_16x16x32_bf16 v[172:175], v[192:195], a[20:23], 0
s_add_u32 s37, s76, s50
s_add_u32 s35, s37, 294912
v_mfma_f32_16x16x32_bf16 v[172:175], v[196:199], a[44:47], v[172:175]
v_cvt_pk_bf16_f32 v212, v136, v137
s_waitcnt lgkmcnt(0)
v_mfma_f32_16x16x32_bf16 v[152:155], v[200:203], a[48:51], v[152:155]
ds_read_b64_tr_b16 v[192:193], v180 offset:16384
v_cvt_pk_bf16_f32 v213, v138, v139
v_mfma_f32_16x16x32_bf16 v[152:155], v[204:207], a[72:75], v[152:155]
ds_read_b64_tr_b16 v[194:195], v180 offset:18432
v_cvt_pk_bf16_f32 v214, v140, v141
v_mfma_f32_16x16x32_bf16 v[156:159], v[200:203], a[52:55], v[156:159]
ds_read_b64_tr_b16 v[196:197], v180 offset:20480
buffer_load_dwordx4 v176, s[20:23], s35 offen offset:0  lds
v_mfma_f32_16x16x32_bf16 v[156:159], v[204:207], a[76:79], v[156:159]
ds_read_b64_tr_b16 v[198:199], v180 offset:22528
v_cvt_pk_bf16_f32 v215, v142, v143
v_mfma_f32_16x16x32_bf16 v[160:163], v[200:203], a[56:59], v[160:163]
buffer_store_dwordx4 v[212:215], v184, s[24:27], s41 offen offset:1024 sc1
v_cvt_pk_bf16_f32 v216, v144, v145
v_mfma_f32_16x16x32_bf16 v[160:163], v[204:207], a[80:83], v[160:163]
v_cvt_pk_bf16_f32 v217, v146, v147
v_cvt_pk_bf16_f32 v218, v148, v149
v_mfma_f32_16x16x32_bf16 v[164:167], v[200:203], a[60:63], v[164:167]
v_cvt_pk_bf16_f32 v219, v150, v151
buffer_store_dwordx4 v[216:219], v184, s[24:27], s41 offen offset:2048 sc1
v_mfma_f32_16x16x32_bf16 v[164:167], v[204:207], a[84:87], v[164:167]
buffer_load_dwordx4 v177, s[20:23], s35 offen offset:1024  lds
v_mfma_f32_16x16x32_bf16 v[168:171], v[200:203], a[64:67], v[168:171]
v_mfma_f32_16x16x32_bf16 v[168:171], v[204:207], a[88:91], v[168:171]
v_mfma_f32_16x16x32_bf16 v[172:175], v[200:203], a[68:71], v[172:175]
v_mfma_f32_16x16x32_bf16 v[172:175], v[204:207], a[92:95], v[172:175]
s_waitcnt lgkmcnt(0)
v_mfma_f32_16x16x32_bf16 v[152:155], v[192:195], a[96:99], v[152:155]
ds_read_b64_tr_b16 v[200:201], v180 offset:24576
buffer_load_dwordx4 v178, s[20:23], s35 offen offset:2048  lds
v_mfma_f32_16x16x32_bf16 v[152:155], v[196:199], a[120:123], v[152:155]
ds_read_b64_tr_b16 v[202:203], v180 offset:26624
v_mfma_f32_16x16x32_bf16 v[156:159], v[192:195], a[100:103], v[156:159]
ds_read_b64_tr_b16 v[204:205], v180 offset:28672
v_mfma_f32_16x16x32_bf16 v[156:159], v[196:199], a[124:127], v[156:159]
ds_read_b64_tr_b16 v[206:207], v180 offset:30720
v_mfma_f32_16x16x32_bf16 v[160:163], v[192:195], a[104:107], v[160:163]
v_mfma_f32_16x16x32_bf16 v[160:163], v[196:199], a[128:131], v[160:163]
buffer_load_dwordx4 v179, s[20:23], s35 offen offset:3072  lds
s_add_u32 m0, s43, 102400
v_mfma_f32_16x16x32_bf16 v[164:167], v[192:195], a[108:111], v[164:167]
s_add_u32 s35, s37, 331776
v_mfma_f32_16x16x32_bf16 v[164:167], v[196:199], a[132:135], v[164:167]
v_mfma_f32_16x16x32_bf16 v[168:171], v[192:195], a[112:115], v[168:171]
v_mfma_f32_16x16x32_bf16 v[168:171], v[196:199], a[136:139], v[168:171]
v_mfma_f32_16x16x32_bf16 v[172:175], v[192:195], a[116:119], v[172:175]
buffer_load_dwordx4 v176, s[20:23], s35 offen offset:0  lds
v_mfma_f32_16x16x32_bf16 v[172:175], v[196:199], a[140:143], v[172:175]
s_waitcnt vmcnt(16) lgkmcnt(0)
s_barrier
v_mfma_f32_16x16x32_bf16 v[152:155], v[200:203], a[144:147], v[152:155]
ds_read_b64_tr_b16 v[192:193], v185 offset:0
v_mfma_f32_16x16x32_bf16 v[152:155], v[204:207], a[168:171], v[152:155]
ds_read_b64_tr_b16 v[194:195], v185 offset:2048
v_mfma_f32_16x16x32_bf16 v[156:159], v[200:203], a[148:151], v[156:159]
ds_read_b64_tr_b16 v[196:197], v185 offset:4096
v_mfma_f32_16x16x32_bf16 v[156:159], v[204:207], a[172:175], v[156:159]
ds_read_b64_tr_b16 v[198:199], v185 offset:6144
buffer_load_dwordx4 v177, s[20:23], s35 offen offset:1024  lds
v_mfma_f32_16x16x32_bf16 v[160:163], v[200:203], a[152:155], v[160:163]
v_mfma_f32_16x16x32_bf16 v[160:163], v[204:207], a[176:179], v[160:163]
v_mfma_f32_16x16x32_bf16 v[164:167], v[200:203], a[156:159], v[164:167]
v_mfma_f32_16x16x32_bf16 v[164:167], v[204:207], a[180:183], v[164:167]
v_mfma_f32_16x16x32_bf16 v[168:171], v[200:203], a[160:163], v[168:171]
buffer_load_dwordx4 v178, s[20:23], s35 offen offset:2048  lds
v_mfma_f32_16x16x32_bf16 v[168:171], v[204:207], a[184:187], v[168:171]
v_mfma_f32_16x16x32_bf16 v[172:175], v[200:203], a[164:167], v[172:175]
v_mfma_f32_16x16x32_bf16 v[172:175], v[204:207], a[188:191], v[172:175]
s_mov_b32 s4, s30
s_waitcnt lgkmcnt(0)
v_mfma_f32_16x16x32_bf16 v[152:155], v[192:195], a[192:195], v[152:155]
ds_read_b64_tr_b16 v[200:201], v185 offset:8192
s_mov_b32 s5, s31
v_mfma_f32_16x16x32_bf16 v[152:155], v[196:199], a[216:219], v[152:155]
ds_read_b64_tr_b16 v[202:203], v185 offset:10240
buffer_load_dwordx4 v179, s[20:23], s35 offen offset:3072  lds
v_mfma_f32_16x16x32_bf16 v[156:159], v[192:195], a[196:199], v[156:159]
ds_read_b64_tr_b16 v[204:205], v185 offset:12288
s_add_u32 m0, s43, 131072
v_mfma_f32_16x16x32_bf16 v[156:159], v[196:199], a[220:223], v[156:159]
ds_read_b64_tr_b16 v[206:207], v185 offset:14336
s_add_u32 s37, s76, s51
v_mfma_f32_16x16x32_bf16 v[160:163], v[192:195], a[200:203], v[160:163]
s_add_u32 s35, s37, 0
s_mov_b32 s6, 3538944
v_mfma_f32_16x16x32_bf16 v[160:163], v[196:199], a[224:227], v[160:163]
s_mov_b32 s7, 0x20000
s_mov_b32 s63, 0x3f80
v_mfma_f32_16x16x32_bf16 v[164:167], v[192:195], a[204:207], v[164:167]
buffer_load_dwordx4 v176, s[20:23], s35 offen offset:0  lds
s_mov_b32 s64, 0x3f800000
v_mfma_f32_16x16x32_bf16 v[164:167], v[196:199], a[228:231], v[164:167]
s_lshl_b32 s18, s44, 7
s_lshl_b32 s65, s28, 5
v_mfma_f32_16x16x32_bf16 v[168:171], v[192:195], a[208:211], v[168:171]
s_add_u32 s18, s18, s65
s_add_u32 s18, s18, 32505856
v_mfma_f32_16x16x32_bf16 v[168:171], v[196:199], a[232:235], v[168:171]
s_lshl_b32 s65, s71, 2
s_add_u32 s19, s18, s65
v_mfma_f32_16x16x32_bf16 v[172:175], v[192:195], a[212:215], v[172:175]
s_mul_i32 s65, s71, 110592
s_sub_u32 s15, s42, s65
v_mfma_f32_16x16x32_bf16 v[172:175], v[196:199], a[236:239], v[172:175]
buffer_load_dwordx4 v177, s[20:23], s35 offen offset:1024  lds
s_waitcnt lgkmcnt(0)
v_mfma_f32_16x16x32_bf16 v[152:155], v[200:203], a[240:243], v[152:155]
ds_read_b64_tr_b16 v[192:193], v185 offset:16384
s_mul_i32 s66, s56, 96
v_mfma_f32_16x16x32_bf16 v[152:155], v[204:207], v[8:11], v[152:155]
ds_read_b64_tr_b16 v[194:195], v185 offset:18432
s_add_u32 s66, s66, s15
v_mfma_f32_16x16x32_bf16 v[156:159], v[200:203], a[244:247], v[156:159]
ds_read_b64_tr_b16 v[196:197], v185 offset:20480
s_sub_u32 s65, s71, 1
v_mfma_f32_16x16x32_bf16 v[156:159], v[204:207], v[12:15], v[156:159]
ds_read_b64_tr_b16 v[198:199], v185 offset:22528
s_and_b32 s65, s65, 7
v_mfma_f32_16x16x32_bf16 v[160:163], v[200:203], a[248:251], v[160:163]
buffer_load_dwordx4 v178, s[20:23], s35 offen offset:2048  lds
s_mul_i32 s65, s65, 110592
v_mfma_f32_16x16x32_bf16 v[160:163], v[204:207], v[16:19], v[160:163]
s_add_u32 s8, s65, s66
s_sub_u32 s65, s71, 2
v_mfma_f32_16x16x32_bf16 v[164:167], v[200:203], a[252:255], v[164:167]
s_and_b32 s65, s65, 7
s_mul_i32 s65, s65, 110592
v_mfma_f32_16x16x32_bf16 v[164:167], v[204:207], v[20:23], v[164:167]
s_add_u32 s9, s65, s66
s_sub_u32 s65, s71, 3
v_mfma_f32_16x16x32_bf16 v[168:171], v[200:203], v[0:3], v[168:171]
s_and_b32 s65, s65, 7
s_mul_i32 s65, s65, 110592
v_mfma_f32_16x16x32_bf16 v[168:171], v[204:207], v[24:27], v[168:171]
buffer_load_dwordx4 v179, s[20:23], s35 offen offset:3072  lds
s_add_u32 m0, s43, 135168
v_mfma_f32_16x16x32_bf16 v[172:175], v[200:203], v[4:7], v[172:175]
s_add_u32 s35, s37, 36864
s_add_u32 s10, s65, s66
v_mfma_f32_16x16x32_bf16 v[172:175], v[204:207], v[28:31], v[172:175]
s_sub_u32 s65, s71, 4
s_waitcnt lgkmcnt(0)
v_mfma_f32_16x16x32_bf16 v[152:155], v[192:195], v[32:35], v[152:155]
ds_read_b64_tr_b16 v[200:201], v185 offset:24576
s_and_b32 s65, s65, 7
v_mfma_f32_16x16x32_bf16 v[152:155], v[196:199], v[56:59], v[152:155]
ds_read_b64_tr_b16 v[202:203], v185 offset:26624
s_mul_i32 s65, s65, 110592
v_mfma_f32_16x16x32_bf16 v[156:159], v[192:195], v[36:39], v[156:159]
ds_read_b64_tr_b16 v[204:205], v185 offset:28672
buffer_load_dwordx4 v176, s[20:23], s35 offen offset:0  lds
v_mfma_f32_16x16x32_bf16 v[156:159], v[196:199], v[60:63], v[156:159]
ds_read_b64_tr_b16 v[206:207], v185 offset:30720
s_add_u32 s11, s65, s66
v_mfma_f32_16x16x32_bf16 v[160:163], v[192:195], v[40:43], v[160:163]
s_sub_u32 s65, s71, 5
s_and_b32 s65, s65, 7
v_mfma_f32_16x16x32_bf16 v[160:163], v[196:199], v[64:67], v[160:163]
s_mul_i32 s65, s65, 110592
s_add_u32 s12, s65, s66
v_mfma_f32_16x16x32_bf16 v[164:167], v[192:195], v[44:47], v[164:167]
s_sub_u32 s65, s71, 6
s_and_b32 s65, s65, 7
v_mfma_f32_16x16x32_bf16 v[164:167], v[196:199], v[68:71], v[164:167]
buffer_load_dwordx4 v177, s[20:23], s35 offen offset:1024  lds
s_mul_i32 s65, s65, 110592
v_mfma_f32_16x16x32_bf16 v[168:171], v[192:195], v[48:51], v[168:171]
s_add_u32 s13, s65, s66
s_sub_u32 s65, s71, 7
v_mfma_f32_16x16x32_bf16 v[168:171], v[196:199], v[72:75], v[168:171]
s_and_b32 s65, s65, 7
s_mul_i32 s65, s65, 110592
v_mfma_f32_16x16x32_bf16 v[172:175], v[192:195], v[52:55], v[172:175]
s_add_u32 s14, s65, s66
s_mul_i32 s65, s48, 96
v_mfma_f32_16x16x32_bf16 v[172:175], v[196:199], v[76:79], v[172:175]
s_waitcnt vmcnt(16) lgkmcnt(0)
s_barrier
v_mfma_f32_16x16x32_bf16 v[152:155], v[200:203], v[80:83], v[152:155]
ds_read_b64_tr_b16 v[192:193], v180 offset:32768
buffer_load_dwordx4 v178, s[20:23], s35 offen offset:2048  lds
v_mfma_f32_16x16x32_bf16 v[152:155], v[204:207], v[104:107], v[152:155]
ds_read_b64_tr_b16 v[194:195], v180 offset:34816
s_add_u32 s15, s15, s65
v_mfma_f32_16x16x32_bf16 v[156:159], v[200:203], v[84:87], v[156:159]
ds_read_b64_tr_b16 v[196:197], v180 offset:36864
s_lshl_b32 s65, s71, 10
v_mfma_f32_16x16x32_bf16 v[156:159], v[204:207], v[108:111], v[156:159]
ds_read_b64_tr_b16 v[198:199], v180 offset:38912
s_add_u32 s15, s15, s65
v_mfma_f32_16x16x32_bf16 v[160:163], v[200:203], v[88:91], v[160:163]
s_mul_i32 s65, s70, 221184
s_mul_i32 s66, s72, 1152
v_mfma_f32_16x16x32_bf16 v[160:163], v[204:207], v[112:115], v[160:163]
buffer_load_dwordx4 v179, s[20:23], s35 offen offset:3072  lds
s_add_u32 m0, s43, 0
v_mfma_f32_16x16x32_bf16 v[164:167], v[200:203], v[92:95], v[164:167]
s_add_u32 s37, s76, s51
s_add_u32 s35, s37, 294912
v_mfma_f32_16x16x32_bf16 v[164:167], v[204:207], v[116:119], v[164:167]
s_add_u32 s65, s65, s66
s_add_u32 s16, s65, s56
v_mfma_f32_16x16x32_bf16 v[168:171], v[200:203], v[96:99], v[168:171]
s_add_u32 s17, s65, s48
s_mul_i32 s66, s71, 73728
v_mfma_f32_16x16x32_bf16 v[168:171], v[204:207], v[120:123], v[168:171]
s_add_u32 s17, s17, s66
s_cmp_lt_u32 s71, 3
s_cselect_b32 s15, s15, 2146435072
s_cselect_b32 s17, s17, 2146435072
v_mfma_f32_16x16x32_bf16 v[172:175], v[200:203], v[100:103], v[172:175]
buffer_load_dwordx4 v176, s[20:23], s35 offen offset:0  lds
v_sub_u32 v233, s71, v252
v_mfma_f32_16x16x32_bf16 v[172:175], v[204:207], v[124:127], v[172:175]
v_and_b32 v233, 7, v233
s_waitcnt lgkmcnt(0)
v_mfma_f32_16x16x32_bf16 v[128:131], v[192:195], a[0:3], 0
ds_read_b64_tr_b16 v[200:201], v180 offset:40960
v_add_u32 v233, 1, v233
v_mfma_f32_16x16x32_bf16 v[128:131], v[196:199], a[24:27], v[128:131]
ds_read_b64_tr_b16 v[202:203], v180 offset:43008
v_cmp_gt_u32 vcc, 7, v233
v_mov_b32 v232, 1
s_nop 0
v_cndmask_b32 v232, v232, v233, vcc
v_mfma_f32_16x16x32_bf16 v[132:135], v[192:195], a[4:7], 0
ds_read_b64_tr_b16 v[204:205], v180 offset:45056
v_and_b32 v240, 7, v252
v_mfma_f32_16x16x32_bf16 v[132:135], v[196:199], a[28:31], v[132:135]
ds_read_b64_tr_b16 v[206:207], v180 offset:47104
buffer_load_dwordx4 v177, s[20:23], s35 offen offset:1024  lds
v_mfma_f32_16x16x32_bf16 v[136:139], v[192:195], a[8:11], 0
v_lshlrev_b32 v240, 2, v240
v_mov_b32 v243, 2146435072
v_mfma_f32_16x16x32_bf16 v[136:139], v[196:199], a[32:35], v[136:139]
s_mul_i32 s41, s49, 96
s_add_u32 s41, s41, s42
v_mfma_f32_16x16x32_bf16 v[140:143], v[192:195], a[12:15], 0
v_cvt_pk_bf16_f32 v220, v152, v153
v_cvt_pk_bf16_f32 v221, v154, v155
v_mfma_f32_16x16x32_bf16 v[140:143], v[196:199], a[36:39], v[140:143]
v_cvt_pk_bf16_f32 v222, v156, v157
v_cvt_pk_bf16_f32 v223, v158, v159
v_mfma_f32_16x16x32_bf16 v[144:147], v[192:195], a[16:19], 0
buffer_load_dwordx4 v178, s[20:23], s35 offen offset:2048  lds
buffer_store_dwordx4 v[220:223], v184, s[24:27], s41 offen offset:0 sc1
v_mfma_f32_16x16x32_bf16 v[144:147], v[196:199], a[40:43], v[144:147]
v_cmp_eq_u32 vcc, 0, v252
s_nop 1
v_cndmask_b32 v241, v243, v252, vcc
v_and_b32 v242, 31, v252
v_mfma_f32_16x16x32_bf16 v[148:151], v[192:195], a[20:23], 0
v_cvt_pk_bf16_f32 v224, v160, v161
v_cvt_pk_bf16_f32 v225, v162, v163
v_mfma_f32_16x16x32_bf16 v[148:151], v[196:199], a[44:47], v[148:151]
v_cvt_pk_bf16_f32 v226, v164, v165
s_waitcnt lgkmcnt(0)
v_mfma_f32_16x16x32_bf16 v[128:131], v[200:203], a[48:51], v[128:131]
ds_read_b64_tr_b16 v[192:193], v180 offset:49152
v_cvt_pk_bf16_f32 v227, v166, v167
v_mfma_f32_16x16x32_bf16 v[128:131], v[204:207], a[72:75], v[128:131]
ds_read_b64_tr_b16 v[194:195], v180 offset:51200
buffer_load_dwordx4 v179, s[20:23], s35 offen offset:3072  lds
v_mfma_f32_16x16x32_bf16 v[132:135], v[200:203], a[52:55], v[132:135]
ds_read_b64_tr_b16 v[196:197], v180 offset:53248
s_add_u32 m0, s43, 4096
v_mfma_f32_16x16x32_bf16 v[132:135], v[204:207], a[76:79], v[132:135]
ds_read_b64_tr_b16 v[198:199], v180 offset:55296
s_add_u32 s35, s37, 331776
v_mfma_f32_16x16x32_bf16 v[136:139], v[200:203], a[56:59], v[136:139]
buffer_store_dwordx4 v[224:227], v184, s[24:27], s41 offen offset:1024 sc1
v_cvt_pk_bf16_f32 v228, v168, v169
v_mfma_f32_16x16x32_bf16 v[136:139], v[204:207], a[80:83], v[136:139]
v_cvt_pk_bf16_f32 v229, v170, v171
v_cvt_pk_bf16_f32 v230, v172, v173
v_mfma_f32_16x16x32_bf16 v[140:143], v[200:203], a[60:63], v[140:143]
buffer_load_dwordx4 v176, s[20:23], s35 offen offset:0  lds
v_cvt_pk_bf16_f32 v231, v174, v175
v_mfma_f32_16x16x32_bf16 v[140:143], v[204:207], a[84:87], v[140:143]
buffer_store_dwordx4 v[228:231], v184, s[24:27], s41 offen offset:2048 sc1
v_mul_u32_u24 v242, 2304, v242
v_mfma_f32_16x16x32_bf16 v[144:147], v[200:203], a[64:67], v[144:147]
v_lshrrev_b32 v244, 5, v252
v_lshl_add_u32 v242, v244, 4, v242
v_mfma_f32_16x16x32_bf16 v[144:147], v[204:207], a[88:91], v[144:147]
s_lshl_b32 s65, s28, 5
v_add_u32 v242, s65, v242
v_mfma_f32_16x16x32_bf16 v[148:151], v[200:203], a[68:71], v[148:151]
v_add_u32 v235, 442368, v184
v_mfma_f32_16x16x32_bf16 v[148:151], v[204:207], a[92:95], v[148:151]
buffer_load_dwordx4 v177, s[20:23], s35 offen offset:1024  lds
s_waitcnt lgkmcnt(0)
v_mfma_f32_16x16x32_bf16 v[128:131], v[192:195], a[96:99], v[128:131]
ds_read_b64_tr_b16 v[200:201], v180 offset:57344
v_mfma_f32_16x16x32_bf16 v[128:131], v[196:199], a[120:123], v[128:131]
ds_read_b64_tr_b16 v[202:203], v180 offset:59392
v_mfma_f32_16x16x32_bf16 v[132:135], v[192:195], a[100:103], v[132:135]
ds_read_b64_tr_b16 v[204:205], v180 offset:61440
v_mfma_f32_16x16x32_bf16 v[132:135], v[196:199], a[124:127], v[132:135]
ds_read_b64_tr_b16 v[206:207], v180 offset:63488
v_mfma_f32_16x16x32_bf16 v[136:139], v[192:195], a[104:107], v[136:139]
buffer_load_dwordx4 v178, s[20:23], s35 offen offset:2048  lds
v_mfma_f32_16x16x32_bf16 v[136:139], v[196:199], a[128:131], v[136:139]
v_mfma_f32_16x16x32_bf16 v[140:143], v[192:195], a[108:111], v[140:143]
v_mfma_f32_16x16x32_bf16 v[140:143], v[196:199], a[132:135], v[140:143]
v_mfma_f32_16x16x32_bf16 v[144:147], v[192:195], a[112:115], v[144:147]
v_mfma_f32_16x16x32_bf16 v[144:147], v[196:199], a[136:139], v[144:147]
buffer_load_dwordx4 v179, s[20:23], s35 offen offset:3072  lds
s_add_u32 m0, s43, 65536
v_mfma_f32_16x16x32_bf16 v[148:151], v[192:195], a[116:119], v[148:151]
s_add_u32 s37, s76, s52
s_add_u32 s35, s37, 0
v_mfma_f32_16x16x32_bf16 v[148:151], v[196:199], a[140:143], v[148:151]
s_waitcnt vmcnt(19) lgkmcnt(0)
s_barrier
v_mfma_f32_16x16x32_bf16 v[128:131], v[200:203], a[144:147], v[128:131]
ds_read_b64_tr_b16 v[192:193], v185 offset:32768
v_mfma_f32_16x16x32_bf16 v[128:131], v[204:207], a[168:171], v[128:131]
ds_read_b64_tr_b16 v[194:195], v185 offset:34816
v_mfma_f32_16x16x32_bf16 v[132:135], v[200:203], a[148:151], v[132:135]
ds_read_b64_tr_b16 v[196:197], v185 offset:36864
buffer_load_dwordx4 v176, s[20:23], s35 offen offset:0  lds
v_mfma_f32_16x16x32_bf16 v[132:135], v[204:207], a[172:175], v[132:135]
ds_read_b64_tr_b16 v[198:199], v185 offset:38912
v_mfma_f32_16x16x32_bf16 v[136:139], v[200:203], a[152:155], v[136:139]
v_mfma_f32_16x16x32_bf16 v[136:139], v[204:207], a[176:179], v[136:139]
v_mfma_f32_16x16x32_bf16 v[140:143], v[200:203], a[156:159], v[140:143]
v_mfma_f32_16x16x32_bf16 v[140:143], v[204:207], a[180:183], v[140:143]
buffer_load_dwordx4 v177, s[20:23], s35 offen offset:1024  lds
v_mfma_f32_16x16x32_bf16 v[144:147], v[200:203], a[160:163], v[144:147]
v_mfma_f32_16x16x32_bf16 v[144:147], v[204:207], a[184:187], v[144:147]
v_mfma_f32_16x16x32_bf16 v[148:151], v[200:203], a[164:167], v[148:151]
v_mfma_f32_16x16x32_bf16 v[148:151], v[204:207], a[188:191], v[148:151]
s_waitcnt lgkmcnt(0)
v_mfma_f32_16x16x32_bf16 v[128:131], v[192:195], a[192:195], v[128:131]
ds_read_b64_tr_b16 v[200:201], v185 offset:40960
buffer_load_dwordx4 v178, s[20:23], s35 offen offset:2048  lds
v_mfma_f32_16x16x32_bf16 v[128:131], v[196:199], a[216:219], v[128:131]
ds_read_b64_tr_b16 v[202:203], v185 offset:43008
v_mfma_f32_16x16x32_bf16 v[132:135], v[192:195], a[196:199], v[132:135]
ds_read_b64_tr_b16 v[204:205], v185 offset:45056
v_mfma_f32_16x16x32_bf16 v[132:135], v[196:199], a[220:223], v[132:135]
ds_read_b64_tr_b16 v[206:207], v185 offset:47104
v_mfma_f32_16x16x32_bf16 v[136:139], v[192:195], a[200:203], v[136:139]
v_mfma_f32_16x16x32_bf16 v[136:139], v[196:199], a[224:227], v[136:139]
buffer_load_dwordx4 v179, s[20:23], s35 offen offset:3072  lds
s_add_u32 m0, s43, 69632
v_mfma_f32_16x16x32_bf16 v[140:143], v[192:195], a[204:207], v[140:143]
s_add_u32 s35, s37, 36864
v_mfma_f32_16x16x32_bf16 v[140:143], v[196:199], a[228:231], v[140:143]
v_mfma_f32_16x16x32_bf16 v[144:147], v[192:195], a[208:211], v[144:147]
v_mfma_f32_16x16x32_bf16 v[144:147], v[196:199], a[232:235], v[144:147]
v_mfma_f32_16x16x32_bf16 v[148:151], v[192:195], a[212:215], v[148:151]
buffer_load_dwordx4 v176, s[20:23], s35 offen offset:0  lds
v_mfma_f32_16x16x32_bf16 v[148:151], v[196:199], a[236:239], v[148:151]
s_waitcnt lgkmcnt(0)
v_mfma_f32_16x16x32_bf16 v[128:131], v[200:203], a[240:243], v[128:131]
ds_read_b64_tr_b16 v[192:193], v185 offset:49152
v_mfma_f32_16x16x32_bf16 v[128:131], v[204:207], v[8:11], v[128:131]
ds_read_b64_tr_b16 v[194:195], v185 offset:51200
v_mfma_f32_16x16x32_bf16 v[132:135], v[200:203], a[244:247], v[132:135]
ds_read_b64_tr_b16 v[196:197], v185 offset:53248
v_mfma_f32_16x16x32_bf16 v[132:135], v[204:207], v[12:15], v[132:135]
ds_read_b64_tr_b16 v[198:199], v185 offset:55296
buffer_load_dwordx4 v177, s[20:23], s35 offen offset:1024  lds
v_mfma_f32_16x16x32_bf16 v[136:139], v[200:203], a[248:251], v[136:139]
v_mfma_f32_16x16x32_bf16 v[136:139], v[204:207], v[16:19], v[136:139]
v_mfma_f32_16x16x32_bf16 v[140:143], v[200:203], a[252:255], v[140:143]
v_mfma_f32_16x16x32_bf16 v[140:143], v[204:207], v[20:23], v[140:143]
v_mfma_f32_16x16x32_bf16 v[144:147], v[200:203], v[0:3], v[144:147]
buffer_load_dwordx4 v178, s[20:23], s35 offen offset:2048  lds
v_mfma_f32_16x16x32_bf16 v[144:147], v[204:207], v[24:27], v[144:147]
v_mfma_f32_16x16x32_bf16 v[148:151], v[200:203], v[4:7], v[148:151]
v_mfma_f32_16x16x32_bf16 v[148:151], v[204:207], v[28:31], v[148:151]
s_waitcnt lgkmcnt(0)
v_mfma_f32_16x16x32_bf16 v[128:131], v[192:195], v[32:35], v[128:131]
ds_read_b64_tr_b16 v[200:201], v185 offset:57344
v_mfma_f32_16x16x32_bf16 v[128:131], v[196:199], v[56:59], v[128:131]
ds_read_b64_tr_b16 v[202:203], v185 offset:59392
buffer_load_dwordx4 v179, s[20:23], s35 offen offset:3072  lds
v_mfma_f32_16x16x32_bf16 v[132:135], v[192:195], v[36:39], v[132:135]
ds_read_b64_tr_b16 v[204:205], v185 offset:61440
s_add_u32 m0, s43, 32768
v_mfma_f32_16x16x32_bf16 v[132:135], v[196:199], v[60:63], v[132:135]
ds_read_b64_tr_b16 v[206:207], v185 offset:63488
s_add_u32 s37, s76, s52
v_mfma_f32_16x16x32_bf16 v[136:139], v[192:195], v[40:43], v[136:139]
s_add_u32 s35, s37, 294912
v_mfma_f32_16x16x32_bf16 v[136:139], v[196:199], v[64:67], v[136:139]
v_mfma_f32_16x16x32_bf16 v[140:143], v[192:195], v[44:47], v[140:143]
buffer_load_dwordx4 v176, s[20:23], s35 offen offset:0  lds
v_mfma_f32_16x16x32_bf16 v[140:143], v[196:199], v[68:71], v[140:143]
v_mfma_f32_16x16x32_bf16 v[144:147], v[192:195], v[48:51], v[144:147]
v_mfma_f32_16x16x32_bf16 v[144:147], v[196:199], v[72:75], v[144:147]
v_mfma_f32_16x16x32_bf16 v[148:151], v[192:195], v[52:55], v[148:151]
v_mfma_f32_16x16x32_bf16 v[148:151], v[196:199], v[76:79], v[148:151]
s_waitcnt vmcnt(20) lgkmcnt(0)
s_barrier
buffer_load_dwordx4 v177, s[20:23], s35 offen offset:1024  lds
v_mfma_f32_16x16x32_bf16 v[128:131], v[200:203], v[80:83], v[128:131]
ds_read_b64_tr_b16 v[192:193], v186 offset:0
v_mfma_f32_16x16x32_bf16 v[128:131], v[204:207], v[104:107], v[128:131]
ds_read_b64_tr_b16 v[194:195], v186 offset:2048
v_mfma_f32_16x16x32_bf16 v[132:135], v[200:203], v[84:87], v[132:135]
ds_read_b64_tr_b16 v[196:197], v186 offset:4096
v_mfma_f32_16x16x32_bf16 v[132:135], v[204:207], v[108:111], v[132:135]
ds_read_b64_tr_b16 v[198:199], v186 offset:6144
v_mfma_f32_16x16x32_bf16 v[136:139], v[200:203], v[88:91], v[136:139]
buffer_load_dwordx4 v178, s[20:23], s35 offen offset:2048  lds
v_mfma_f32_16x16x32_bf16 v[136:139], v[204:207], v[112:115], v[136:139]
v_mfma_f32_16x16x32_bf16 v[140:143], v[200:203], v[92:95], v[140:143]
v_mfma_f32_16x16x32_bf16 v[140:143], v[204:207], v[116:119], v[140:143]
v_mfma_f32_16x16x32_bf16 v[144:147], v[200:203], v[96:99], v[144:147]
v_mfma_f32_16x16x32_bf16 v[144:147], v[204:207], v[120:123], v[144:147]
buffer_load_dwordx4 v179, s[20:23], s35 offen offset:3072  lds
s_add_u32 m0, s43, 36864
v_mfma_f32_16x16x32_bf16 v[148:151], v[200:203], v[100:103], v[148:151]
s_add_u32 s35, s37, 331776
v_mfma_f32_16x16x32_bf16 v[148:151], v[204:207], v[124:127], v[148:151]
s_waitcnt lgkmcnt(0)
v_mfma_f32_16x16x32_bf16 v[152:155], v[192:195], a[0:3], 0
ds_read_b64_tr_b16 v[200:201], v186 offset:8192
v_mfma_f32_16x16x32_bf16 v[152:155], v[196:199], a[24:27], v[152:155]
ds_read_b64_tr_b16 v[202:203], v186 offset:10240
v_mfma_f32_16x16x32_bf16 v[156:159], v[192:195], a[4:7], 0
ds_read_b64_tr_b16 v[204:205], v186 offset:12288
buffer_load_dwordx4 v176, s[20:23], s35 offen offset:0  lds
v_mfma_f32_16x16x32_bf16 v[156:159], v[196:199], a[28:31], v[156:159]
ds_read_b64_tr_b16 v[206:207], v186 offset:14336
v_mfma_f32_16x16x32_bf16 v[160:163], v[192:195], a[8:11], 0
v_mfma_f32_16x16x32_bf16 v[160:163], v[196:199], a[32:35], v[160:163]
s_mul_i32 s41, s50, 96
s_add_u32 s41, s41, s42
v_mfma_f32_16x16x32_bf16 v[164:167], v[192:195], a[12:15], 0
v_cvt_pk_bf16_f32 v208, v128, v129
v_cvt_pk_bf16_f32 v209, v130, v131
v_mfma_f32_16x16x32_bf16 v[164:167], v[196:199], a[36:39], v[164:167]
buffer_load_dwordx4 v177, s[20:23], s35 offen offset:1024  lds
v_cvt_pk_bf16_f32 v210, v132, v133
v_mfma_f32_16x16x32_bf16 v[168:171], v[192:195], a[16:19], 0
v_cvt_pk_bf16_f32 v211, v134, v135
buffer_store_dwordx4 v[208:211], v184, s[24:27], s41 offen offset:0 sc1
v_mfma_f32_16x16x32_bf16 v[168:171], v[196:199], a[40:43], v[168:171]
v_mfma_f32_16x16x32_bf16 v[172:175], v[192:195], a[20:23], 0
v_cvt_pk_bf16_f32 v212, v136, v137
v_cvt_pk_bf16_f32 v213, v138, v139
v_mfma_f32_16x16x32_bf16 v[172:175], v[196:199], a[44:47], v[172:175]
v_cvt_pk_bf16_f32 v214, v140, v141
s_waitcnt lgkmcnt(0)
v_mfma_f32_16x16x32_bf16 v[152:155], v[200:203], a[48:51], v[152:155]
ds_read_b64_tr_b16 v[192:193], v186 offset:16384
buffer_load_dwordx4 v178, s[20:23], s35 offen offset:2048  lds
v_mfma_f32_16x16x32_bf16 v[152:155], v[204:207], a[72:75], v[152:155]
ds_read_b64_tr_b16 v[194:195], v186 offset:18432
v_cvt_pk_bf16_f32 v215, v142, v143
v_mfma_f32_16x16x32_bf16 v[156:159], v[200:203], a[52:55], v[156:159]
ds_read_b64_tr_b16 v[196:197], v186 offset:20480
buffer_store_dwordx4 v[212:215], v184, s[24:27], s41 offen offset:1024 sc1
v_mfma_f32_16x16x32_bf16 v[156:159], v[204:207], a[76:79], v[156:159]
ds_read_b64_tr_b16 v[198:199], v186 offset:22528
v_cvt_pk_bf16_f32 v216, v144, v145
v_mfma_f32_16x16x32_bf16 v[160:163], v[200:203], a[56:59], v[160:163]
v_cvt_pk_bf16_f32 v217, v146, v147
v_cvt_pk_bf16_f32 v218, v148, v149
v_mfma_f32_16x16x32_bf16 v[160:163], v[204:207], a[80:83], v[160:163]
buffer_load_dwordx4 v179, s[20:23], s35 offen offset:3072  lds
s_add_u32 m0, s43, 98304
v_mfma_f32_16x16x32_bf16 v[164:167], v[200:203], a[60:63], v[164:167]
s_add_u32 s37, s76, s53
s_add_u32 s35, s37, 0
v_mfma_f32_16x16x32_bf16 v[164:167], v[204:207], a[84:87], v[164:167]
v_cvt_pk_bf16_f32 v219, v150, v151
buffer_store_dwordx4 v[216:219], v184, s[24:27], s41 offen offset:2048 sc1
v_mfma_f32_16x16x32_bf16 v[168:171], v[200:203], a[64:67], v[168:171]
v_mfma_f32_16x16x32_bf16 v[168:171], v[204:207], a[88:91], v[168:171]
v_mfma_f32_16x16x32_bf16 v[172:175], v[200:203], a[68:71], v[172:175]
buffer_load_dwordx4 v176, s[20:23], s35 offen offset:0  lds
v_mfma_f32_16x16x32_bf16 v[172:175], v[204:207], a[92:95], v[172:175]
s_waitcnt lgkmcnt(0)
v_mfma_f32_16x16x32_bf16 v[152:155], v[192:195], a[96:99], v[152:155]
ds_read_b64_tr_b16 v[200:201], v186 offset:24576
v_mfma_f32_16x16x32_bf16 v[152:155], v[196:199], a[120:123], v[152:155]
ds_read_b64_tr_b16 v[202:203], v186 offset:26624
v_mfma_f32_16x16x32_bf16 v[156:159], v[192:195], a[100:103], v[156:159]
ds_read_b64_tr_b16 v[204:205], v186 offset:28672
v_mfma_f32_16x16x32_bf16 v[156:159], v[196:199], a[124:127], v[156:159]
ds_read_b64_tr_b16 v[206:207], v186 offset:30720
buffer_load_dwordx4 v177, s[20:23], s35 offen offset:1024  lds
v_mfma_f32_16x16x32_bf16 v[160:163], v[192:195], a[104:107], v[160:163]
v_mfma_f32_16x16x32_bf16 v[160:163], v[196:199], a[128:131], v[160:163]
v_mfma_f32_16x16x32_bf16 v[164:167], v[192:195], a[108:111], v[164:167]
v_mfma_f32_16x16x32_bf16 v[164:167], v[196:199], a[132:135], v[164:167]
v_mfma_f32_16x16x32_bf16 v[168:171], v[192:195], a[112:115], v[168:171]
buffer_load_dwordx4 v178, s[20:23], s35 offen offset:2048  lds
v_mfma_f32_16x16x32_bf16 v[168:171], v[196:199], a[136:139], v[168:171]
v_mfma_f32_16x16x32_bf16 v[172:175], v[192:195], a[116:119], v[172:175]
v_mfma_f32_16x16x32_bf16 v[172:175], v[196:199], a[140:143], v[172:175]
s_waitcnt vmcnt(22) lgkmcnt(0)
s_barrier
v_mfma_f32_16x16x32_bf16 v[152:155], v[200:203], a[144:147], v[152:155]
ds_read_b64_tr_b16 v[192:193], v180 offset:0
v_mfma_f32_16x16x32_bf16 v[152:155], v[204:207], a[168:171], v[152:155]
ds_read_b64_tr_b16 v[194:195], v180 offset:2048
buffer_load_dwordx4 v179, s[20:23], s35 offen offset:3072  lds
v_mfma_f32_16x16x32_bf16 v[156:159], v[200:203], a[148:151], v[156:159]
ds_read_b64_tr_b16 v[196:197], v180 offset:4096
s_add_u32 m0, s43, 102400
v_mfma_f32_16x16x32_bf16 v[156:159], v[204:207], a[172:175], v[156:159]
ds_read_b64_tr_b16 v[198:199], v180 offset:6144
s_add_u32 s35, s37, 36864
v_mfma_f32_16x16x32_bf16 v[160:163], v[200:203], a[152:155], v[160:163]
v_mfma_f32_16x16x32_bf16 v[160:163], v[204:207], a[176:179], v[160:163]
v_mfma_f32_16x16x32_bf16 v[164:167], v[200:203], a[156:159], v[164:167]
buffer_load_dwordx4 v176, s[20:23], s35 offen offset:0  lds
v_mfma_f32_16x16x32_bf16 v[164:167], v[204:207], a[180:183], v[164:167]
v_mfma_f32_16x16x32_bf16 v[168:171], v[200:203], a[160:163], v[168:171]
v_mfma_f32_16x16x32_bf16 v[168:171], v[204:207], a[184:187], v[168:171]
v_mfma_f32_16x16x32_bf16 v[172:175], v[200:203], a[164:167], v[172:175]
v_mfma_f32_16x16x32_bf16 v[172:175], v[204:207], a[188:191], v[172:175]
buffer_load_dwordx4 v177, s[20:23], s35 offen offset:1024  lds
s_waitcnt lgkmcnt(0)
v_mfma_f32_16x16x32_bf16 v[152:155], v[192:195], a[192:195], v[152:155]
ds_read_b64_tr_b16 v[200:201], v180 offset:8192
v_mfma_f32_16x16x32_bf16 v[152:155], v[196:199], a[216:219], v[152:155]
ds_read_b64_tr_b16 v[202:203], v180 offset:10240
v_mfma_f32_16x16x32_bf16 v[156:159], v[192:195], a[196:199], v[156:159]
ds_read_b64_tr_b16 v[204:205], v180 offset:12288
v_mfma_f32_16x16x32_bf16 v[156:159], v[196:199], a[220:223], v[156:159]
ds_read_b64_tr_b16 v[206:207], v180 offset:14336
v_mfma_f32_16x16x32_bf16 v[160:163], v[192:195], a[200:203], v[160:163]
buffer_load_dwordx4 v178, s[20:23], s35 offen offset:2048  lds
v_mfma_f32_16x16x32_bf16 v[160:163], v[196:199], a[224:227], v[160:163]
v_mfma_f32_16x16x32_bf16 v[164:167], v[192:195], a[204:207], v[164:167]
v_mfma_f32_16x16x32_bf16 v[164:167], v[196:199], a[228:231], v[164:167]
v_mfma_f32_16x16x32_bf16 v[168:171], v[192:195], a[208:211], v[168:171]
v_mfma_f32_16x16x32_bf16 v[168:171], v[196:199], a[232:235], v[168:171]
buffer_load_dwordx4 v179, s[20:23], s35 offen offset:3072  lds
s_add_u32 m0, s43, 131072
v_mfma_f32_16x16x32_bf16 v[172:175], v[192:195], a[212:215], v[172:175]
s_add_u32 s37, s76, s53
s_add_u32 s35, s37, 294912
v_mfma_f32_16x16x32_bf16 v[172:175], v[196:199], a[236:239], v[172:175]
s_waitcnt lgkmcnt(0)
v_mfma_f32_16x16x32_bf16 v[152:155], v[200:203], a[240:243], v[152:155]
ds_read_b64_tr_b16 v[192:193], v180 offset:16384
v_mfma_f32_16x16x32_bf16 v[152:155], v[204:207], v[8:11], v[152:155]
ds_read_b64_tr_b16 v[194:195], v180 offset:18432
v_mfma_f32_16x16x32_bf16 v[156:159], v[200:203], a[244:247], v[156:159]
ds_read_b64_tr_b16 v[196:197], v180 offset:20480
buffer_load_dwordx4 v176, s[20:23], s35 offen offset:0  lds
v_mfma_f32_16x16x32_bf16 v[156:159], v[204:207], v[12:15], v[156:159]
ds_read_b64_tr_b16 v[198:199], v180 offset:22528
v_mfma_f32_16x16x32_bf16 v[160:163], v[200:203], a[248:251], v[160:163]
v_mfma_f32_16x16x32_bf16 v[160:163], v[204:207], v[16:19], v[160:163]
v_mfma_f32_16x16x32_bf16 v[164:167], v[200:203], a[252:255], v[164:167]
v_mfma_f32_16x16x32_bf16 v[164:167], v[204:207], v[20:23], v[164:167]
buffer_load_dwordx4 v177, s[20:23], s35 offen offset:1024  lds
v_mfma_f32_16x16x32_bf16 v[168:171], v[200:203], v[0:3], v[168:171]
v_mfma_f32_16x16x32_bf16 v[168:171], v[204:207], v[24:27], v[168:171]
v_mfma_f32_16x16x32_bf16 v[172:175], v[200:203], v[4:7], v[172:175]
v_mfma_f32_16x16x32_bf16 v[172:175], v[204:207], v[28:31], v[172:175]
s_waitcnt lgkmcnt(0)
v_mfma_f32_16x16x32_bf16 v[152:155], v[192:195], v[32:35], v[152:155]
ds_read_b64_tr_b16 v[200:201], v180 offset:24576
buffer_load_dwordx4 v178, s[20:23], s35 offen offset:2048  lds
v_mfma_f32_16x16x32_bf16 v[152:155], v[196:199], v[56:59], v[152:155]
ds_read_b64_tr_b16 v[202:203], v180 offset:26624
v_mfma_f32_16x16x32_bf16 v[156:159], v[192:195], v[36:39], v[156:159]
ds_read_b64_tr_b16 v[204:205], v180 offset:28672
v_mfma_f32_16x16x32_bf16 v[156:159], v[196:199], v[60:63], v[156:159]
ds_read_b64_tr_b16 v[206:207], v180 offset:30720
v_mfma_f32_16x16x32_bf16 v[160:163], v[192:195], v[40:43], v[160:163]
v_mfma_f32_16x16x32_bf16 v[160:163], v[196:199], v[64:67], v[160:163]
buffer_load_dwordx4 v179, s[20:23], s35 offen offset:3072  lds
s_add_u32 m0, s43, 135168
v_mfma_f32_16x16x32_bf16 v[164:167], v[192:195], v[44:47], v[164:167]
s_add_u32 s35, s37, 331776
v_mfma_f32_16x16x32_bf16 v[164:167], v[196:199], v[68:71], v[164:167]
v_mfma_f32_16x16x32_bf16 v[168:171], v[192:195], v[48:51], v[168:171]
v_mfma_f32_16x16x32_bf16 v[168:171], v[196:199], v[72:75], v[168:171]
v_mfma_f32_16x16x32_bf16 v[172:175], v[192:195], v[52:55], v[172:175]
buffer_load_dwordx4 v176, s[20:23], s35 offen offset:0  lds
v_mfma_f32_16x16x32_bf16 v[172:175], v[196:199], v[76:79], v[172:175]
s_waitcnt vmcnt(24) lgkmcnt(0)
s_barrier
v_mfma_f32_16x16x32_bf16 v[152:155], v[200:203], v[80:83], v[152:155]
ds_read_b64_tr_b16 v[192:193], v185 offset:0
v_mfma_f32_16x16x32_bf16 v[152:155], v[204:207], v[104:107], v[152:155]
ds_read_b64_tr_b16 v[194:195], v185 offset:2048
v_mfma_f32_16x16x32_bf16 v[156:159], v[200:203], v[84:87], v[156:159]
ds_read_b64_tr_b16 v[196:197], v185 offset:4096
v_mfma_f32_16x16x32_bf16 v[156:159], v[204:207], v[108:111], v[156:159]
ds_read_b64_tr_b16 v[198:199], v185 offset:6144
buffer_load_dwordx4 v177, s[20:23], s35 offen offset:1024  lds
v_mfma_f32_16x16x32_bf16 v[160:163], v[200:203], v[88:91], v[160:163]
v_mfma_f32_16x16x32_bf16 v[160:163], v[204:207], v[112:115], v[160:163]
v_mfma_f32_16x16x32_bf16 v[164:167], v[200:203], v[92:95], v[164:167]
v_mfma_f32_16x16x32_bf16 v[164:167], v[204:207], v[116:119], v[164:167]
v_mfma_f32_16x16x32_bf16 v[168:171], v[200:203], v[96:99], v[168:171]
buffer_load_dwordx4 v178, s[20:23], s35 offen offset:2048  lds
v_mfma_f32_16x16x32_bf16 v[168:171], v[204:207], v[120:123], v[168:171]
v_mfma_f32_16x16x32_bf16 v[172:175], v[200:203], v[100:103], v[172:175]
v_mfma_f32_16x16x32_bf16 v[172:175], v[204:207], v[124:127], v[172:175]
s_waitcnt lgkmcnt(0)
v_mfma_f32_16x16x32_bf16 v[128:131], v[192:195], a[0:3], 0
ds_read_b64_tr_b16 v[200:201], v185 offset:8192
v_mfma_f32_16x16x32_bf16 v[128:131], v[196:199], a[24:27], v[128:131]
ds_read_b64_tr_b16 v[202:203], v185 offset:10240
buffer_load_dwordx4 v179, s[20:23], s35 offen offset:3072  lds
v_mfma_f32_16x16x32_bf16 v[132:135], v[192:195], a[4:7], 0
ds_read_b64_tr_b16 v[204:205], v185 offset:12288
s_add_u32 m0, s43, 0
v_mfma_f32_16x16x32_bf16 v[132:135], v[196:199], a[28:31], v[132:135]
ds_read_b64_tr_b16 v[206:207], v185 offset:14336
s_add_u32 s37, s76, s54
v_mfma_f32_16x16x32_bf16 v[136:139], v[192:195], a[8:11], 0
s_add_u32 s35, s37, 0
v_mfma_f32_16x16x32_bf16 v[136:139], v[196:199], a[32:35], v[136:139]
s_mul_i32 s41, s51, 96
s_add_u32 s41, s41, s42
v_mfma_f32_16x16x32_bf16 v[140:143], v[192:195], a[12:15], 0
buffer_load_dwordx4 v176, s[20:23], s35 offen offset:0  lds
v_cvt_pk_bf16_f32 v220, v152, v153
v_mfma_f32_16x16x32_bf16 v[140:143], v[196:199], a[36:39], v[140:143]
v_cvt_pk_bf16_f32 v221, v154, v155
v_cvt_pk_bf16_f32 v222, v156, v157
v_mfma_f32_16x16x32_bf16 v[144:147], v[192:195], a[16:19], 0
v_cvt_pk_bf16_f32 v223, v158, v159
buffer_store_dwordx4 v[220:223], v184, s[24:27], s41 offen offset:0 sc1
v_mfma_f32_16x16x32_bf16 v[144:147], v[196:199], a[40:43], v[144:147]
v_mfma_f32_16x16x32_bf16 v[148:151], v[192:195], a[20:23], 0
v_cvt_pk_bf16_f32 v224, v160, v161
v_cvt_pk_bf16_f32 v225, v162, v163
v_mfma_f32_16x16x32_bf16 v[148:151], v[196:199], a[44:47], v[148:151]
buffer_load_dwordx4 v177, s[20:23], s35 offen offset:1024  lds
s_waitcnt lgkmcnt(0)
v_mfma_f32_16x16x32_bf16 v[128:131], v[200:203], a[48:51], v[128:131]
ds_read_b64_tr_b16 v[192:193], v185 offset:16384
v_cvt_pk_bf16_f32 v226, v164, v165
v_mfma_f32_16x16x32_bf16 v[128:131], v[204:207], a[72:75], v[128:131]
ds_read_b64_tr_b16 v[194:195], v185 offset:18432
v_cvt_pk_bf16_f32 v227, v166, v167
v_mfma_f32_16x16x32_bf16 v[132:135], v[200:203], a[52:55], v[132:135]
ds_read_b64_tr_b16 v[196:197], v185 offset:20480
buffer_store_dwordx4 v[224:227], v184, s[24:27], s41 offen offset:1024 sc1
v_mfma_f32_16x16x32_bf16 v[132:135], v[204:207], a[76:79], v[132:135]
ds_read_b64_tr_b16 v[198:199], v185 offset:22528
v_cvt_pk_bf16_f32 v228, v168, v169
v_mfma_f32_16x16x32_bf16 v[136:139], v[200:203], a[56:59], v[136:139]
buffer_load_dwordx4 v178, s[20:23], s35 offen offset:2048  lds
v_cvt_pk_bf16_f32 v229, v170, v171
v_mfma_f32_16x16x32_bf16 v[136:139], v[204:207], a[80:83], v[136:139]
v_cvt_pk_bf16_f32 v230, v172, v173
v_cvt_pk_bf16_f32 v231, v174, v175
v_mfma_f32_16x16x32_bf16 v[140:143], v[200:203], a[60:63], v[140:143]
buffer_store_dwordx4 v[228:231], v184, s[24:27], s41 offen offset:2048 sc1
v_mfma_f32_16x16x32_bf16 v[140:143], v[204:207], a[84:87], v[140:143]
v_mfma_f32_16x16x32_bf16 v[144:147], v[200:203], a[64:67], v[144:147]
v_mfma_f32_16x16x32_bf16 v[144:147], v[204:207], a[88:91], v[144:147]
buffer_load_dwordx4 v179, s[20:23], s35 offen offset:3072  lds
s_add_u32 m0, s43, 4096
v_mfma_f32_16x16x32_bf16 v[148:151], v[200:203], a[68:71], v[148:151]
s_add_u32 s35, s37, 36864
v_mfma_f32_16x16x32_bf16 v[148:151], v[204:207], a[92:95], v[148:151]
s_waitcnt lgkmcnt(0)
v_mfma_f32_16x16x32_bf16 v[128:131], v[192:195], a[96:99], v[128:131]
ds_read_b64_tr_b16 v[200:201], v185 offset:24576
v_mfma_f32_16x16x32_bf16 v[128:131], v[196:199], a[120:123], v[128:131]
ds_read_b64_tr_b16 v[202:203], v185 offset:26624
v_mfma_f32_16x16x32_bf16 v[132:135], v[192:195], a[100:103], v[132:135]
ds_read_b64_tr_b16 v[204:205], v185 offset:28672
buffer_load_dwordx4 v176, s[20:23], s35 offen offset:0  lds
v_mfma_f32_16x16x32_bf16 v[132:135], v[196:199], a[124:127], v[132:135]
ds_read_b64_tr_b16 v[206:207], v185 offset:30720
v_mfma_f32_16x16x32_bf16 v[136:139], v[192:195], a[104:107], v[136:139]
v_mfma_f32_16x16x32_bf16 v[136:139], v[196:199], a[128:131], v[136:139]
v_mfma_f32_16x16x32_bf16 v[140:143], v[192:195], a[108:111], v[140:143]
v_mfma_f32_16x16x32_bf16 v[140:143], v[196:199], a[132:135], v[140:143]
buffer_load_dwordx4 v177, s[20:23], s35 offen offset:1024  lds
v_mfma_f32_16x16x32_bf16 v[144:147], v[192:195], a[112:115], v[144:147]
v_mfma_f32_16x16x32_bf16 v[144:147], v[196:199], a[136:139], v[144:147]
v_mfma_f32_16x16x32_bf16 v[148:151], v[192:195], a[116:119], v[148:151]
v_mfma_f32_16x16x32_bf16 v[148:151], v[196:199], a[140:143], v[148:151]
s_waitcnt vmcnt(26) lgkmcnt(0)
s_barrier
v_mfma_f32_16x16x32_bf16 v[128:131], v[200:203], a[144:147], v[128:131]
ds_read_b64_tr_b16 v[192:193], v180 offset:32768
buffer_load_dwordx4 v178, s[20:23], s35 offen offset:2048  lds
v_mfma_f32_16x16x32_bf16 v[128:131], v[204:207], a[168:171], v[128:131]
ds_read_b64_tr_b16 v[194:195], v180 offset:34816
v_mfma_f32_16x16x32_bf16 v[132:135], v[200:203], a[148:151], v[132:135]
ds_read_b64_tr_b16 v[196:197], v180 offset:36864
v_mfma_f32_16x16x32_bf16 v[132:135], v[204:207], a[172:175], v[132:135]
ds_read_b64_tr_b16 v[198:199], v180 offset:38912
v_mfma_f32_16x16x32_bf16 v[136:139], v[200:203], a[152:155], v[136:139]
v_mfma_f32_16x16x32_bf16 v[136:139], v[204:207], a[176:179], v[136:139]
buffer_load_dwordx4 v179, s[20:23], s35 offen offset:3072  lds
s_add_u32 m0, s43, 65536
v_mfma_f32_16x16x32_bf16 v[140:143], v[200:203], a[156:159], v[140:143]
s_add_u32 s37, s76, s54
s_add_u32 s35, s37, 294912
v_mfma_f32_16x16x32_bf16 v[140:143], v[204:207], a[180:183], v[140:143]
v_mfma_f32_16x16x32_bf16 v[144:147], v[200:203], a[160:163], v[144:147]
v_mfma_f32_16x16x32_bf16 v[144:147], v[204:207], a[184:187], v[144:147]
v_mfma_f32_16x16x32_bf16 v[148:151], v[200:203], a[164:167], v[148:151]
buffer_load_dwordx4 v176, s[20:23], s35 offen offset:0  lds
v_mfma_f32_16x16x32_bf16 v[148:151], v[204:207], a[188:191], v[148:151]
s_waitcnt lgkmcnt(0)
v_mfma_f32_16x16x32_bf16 v[128:131], v[192:195], a[192:195], v[128:131]
ds_read_b64_tr_b16 v[200:201], v180 offset:40960
v_mfma_f32_16x16x32_bf16 v[128:131], v[196:199], a[216:219], v[128:131]
ds_read_b64_tr_b16 v[202:203], v180 offset:43008
v_mfma_f32_16x16x32_bf16 v[132:135], v[192:195], a[196:199], v[132:135]
ds_read_b64_tr_b16 v[204:205], v180 offset:45056
v_mfma_f32_16x16x32_bf16 v[132:135], v[196:199], a[220:223], v[132:135]
ds_read_b64_tr_b16 v[206:207], v180 offset:47104
buffer_load_dwordx4 v177, s[20:23], s35 offen offset:1024  lds
v_mfma_f32_16x16x32_bf16 v[136:139], v[192:195], a[200:203], v[136:139]
v_mfma_f32_16x16x32_bf16 v[136:139], v[196:199], a[224:227], v[136:139]
v_mfma_f32_16x16x32_bf16 v[140:143], v[192:195], a[204:207], v[140:143]
v_mfma_f32_16x16x32_bf16 v[140:143], v[196:199], a[228:231], v[140:143]
v_mfma_f32_16x16x32_bf16 v[144:147], v[192:195], a[208:211], v[144:147]
buffer_load_dwordx4 v178, s[20:23], s35 offen offset:2048  lds
v_mfma_f32_16x16x32_bf16 v[144:147], v[196:199], a[232:235], v[144:147]
v_mfma_f32_16x16x32_bf16 v[148:151], v[192:195], a[212:215], v[148:151]
v_mfma_f32_16x16x32_bf16 v[148:151], v[196:199], a[236:239], v[148:151]
s_waitcnt lgkmcnt(0)
v_mfma_f32_16x16x32_bf16 v[128:131], v[200:203], a[240:243], v[128:131]
ds_read_b64_tr_b16 v[192:193], v180 offset:49152
v_mfma_f32_16x16x32_bf16 v[128:131], v[204:207], v[8:11], v[128:131]
ds_read_b64_tr_b16 v[194:195], v180 offset:51200
buffer_load_dwordx4 v179, s[20:23], s35 offen offset:3072  lds
v_mfma_f32_16x16x32_bf16 v[132:135], v[200:203], a[244:247], v[132:135]
ds_read_b64_tr_b16 v[196:197], v180 offset:53248
s_add_u32 m0, s43, 69632
v_mfma_f32_16x16x32_bf16 v[132:135], v[204:207], v[12:15], v[132:135]
ds_read_b64_tr_b16 v[198:199], v180 offset:55296
s_add_u32 s35, s37, 331776
v_mfma_f32_16x16x32_bf16 v[136:139], v[200:203], a[248:251], v[136:139]
v_mfma_f32_16x16x32_bf16 v[136:139], v[204:207], v[16:19], v[136:139]
v_mfma_f32_16x16x32_bf16 v[140:143], v[200:203], a[252:255], v[140:143]
buffer_load_dwordx4 v176, s[20:23], s35 offen offset:0  lds
v_mfma_f32_16x16x32_bf16 v[140:143], v[204:207], v[20:23], v[140:143]
v_mfma_f32_16x16x32_bf16 v[144:147], v[200:203], v[0:3], v[144:147]
v_mfma_f32_16x16x32_bf16 v[144:147], v[204:207], v[24:27], v[144:147]
v_mfma_f32_16x16x32_bf16 v[148:151], v[200:203], v[4:7], v[148:151]
v_mfma_f32_16x16x32_bf16 v[148:151], v[204:207], v[28:31], v[148:151]
buffer_load_dwordx4 v177, s[20:23], s35 offen offset:1024  lds
s_waitcnt lgkmcnt(0)
v_mfma_f32_16x16x32_bf16 v[128:131], v[192:195], v[32:35], v[128:131]
ds_read_b64_tr_b16 v[200:201], v180 offset:57344
v_mfma_f32_16x16x32_bf16 v[128:131], v[196:199], v[56:59], v[128:131]
ds_read_b64_tr_b16 v[202:203], v180 offset:59392
v_mfma_f32_16x16x32_bf16 v[132:135], v[192:195], v[36:39], v[132:135]
ds_read_b64_tr_b16 v[204:205], v180 offset:61440
v_mfma_f32_16x16x32_bf16 v[132:135], v[196:199], v[60:63], v[132:135]
ds_read_b64_tr_b16 v[206:207], v180 offset:63488
v_mfma_f32_16x16x32_bf16 v[136:139], v[192:195], v[40:43], v[136:139]
buffer_load_dwordx4 v178, s[20:23], s35 offen offset:2048  lds
v_mfma_f32_16x16x32_bf16 v[136:139], v[196:199], v[64:67], v[136:139]
v_mfma_f32_16x16x32_bf16 v[140:143], v[192:195], v[44:47], v[140:143]
v_mfma_f32_16x16x32_bf16 v[140:143], v[196:199], v[68:71], v[140:143]
v_mfma_f32_16x16x32_bf16 v[144:147], v[192:195], v[48:51], v[144:147]
v_mfma_f32_16x16x32_bf16 v[144:147], v[196:199], v[72:75], v[144:147]
buffer_load_dwordx4 v179, s[20:23], s35 offen offset:3072  lds
v_mfma_f32_16x16x32_bf16 v[148:151], v[192:195], v[52:55], v[148:151]
s_add_u32 m0, s43, 32768
s_add_u32 s37, s76, s55
v_mfma_f32_16x16x32_bf16 v[148:151], v[196:199], v[76:79], v[148:151]
s_waitcnt vmcnt(27) lgkmcnt(0)
s_barrier
v_mfma_f32_16x16x32_bf16 v[128:131], v[200:203], v[80:83], v[128:131]
ds_read_b64_tr_b16 v[192:193], v185 offset:32768
s_add_u32 s35, s37, 0
v_mfma_f32_16x16x32_bf16 v[128:131], v[204:207], v[104:107], v[128:131]
ds_read_b64_tr_b16 v[194:195], v185 offset:34816
v_mfma_f32_16x16x32_bf16 v[132:135], v[200:203], v[84:87], v[132:135]
ds_read_b64_tr_b16 v[196:197], v185 offset:36864
buffer_load_dwordx4 v176, s[20:23], s35 offen offset:0  lds
v_mfma_f32_16x16x32_bf16 v[132:135], v[204:207], v[108:111], v[132:135]
ds_read_b64_tr_b16 v[198:199], v185 offset:38912
v_mfma_f32_16x16x32_bf16 v[136:139], v[200:203], v[88:91], v[136:139]
v_mfma_f32_16x16x32_bf16 v[136:139], v[204:207], v[112:115], v[136:139]
v_mfma_f32_16x16x32_bf16 v[140:143], v[200:203], v[92:95], v[140:143]
v_mfma_f32_16x16x32_bf16 v[140:143], v[204:207], v[116:119], v[140:143]
buffer_load_dwordx4 v177, s[20:23], s35 offen offset:1024  lds
v_mfma_f32_16x16x32_bf16 v[144:147], v[200:203], v[96:99], v[144:147]
v_mfma_f32_16x16x32_bf16 v[144:147], v[204:207], v[120:123], v[144:147]
v_mfma_f32_16x16x32_bf16 v[148:151], v[200:203], v[100:103], v[148:151]
v_mfma_f32_16x16x32_bf16 v[148:151], v[204:207], v[124:127], v[148:151]
s_waitcnt lgkmcnt(0)
v_mfma_f32_16x16x32_bf16 v[152:155], v[192:195], a[0:3], 0
ds_read_b64_tr_b16 v[200:201], v185 offset:40960
buffer_load_dwordx4 v178, s[20:23], s35 offen offset:2048  lds
v_mfma_f32_16x16x32_bf16 v[152:155], v[196:199], a[24:27], v[152:155]
ds_read_b64_tr_b16 v[202:203], v185 offset:43008
v_mfma_f32_16x16x32_bf16 v[156:159], v[192:195], a[4:7], 0
ds_read_b64_tr_b16 v[204:205], v185 offset:45056
v_mfma_f32_16x16x32_bf16 v[156:159], v[196:199], a[28:31], v[156:159]
ds_read_b64_tr_b16 v[206:207], v185 offset:47104
v_mfma_f32_16x16x32_bf16 v[160:163], v[192:195], a[8:11], 0
v_mfma_f32_16x16x32_bf16 v[160:163], v[196:199], a[32:35], v[160:163]
buffer_load_dwordx4 v179, s[20:23], s35 offen offset:3072  lds
s_add_u32 m0, s43, 36864
v_mfma_f32_16x16x32_bf16 v[164:167], v[192:195], a[12:15], 0
s_add_u32 s35, s37, 36864
v_mfma_f32_16x16x32_bf16 v[164:167], v[196:199], a[36:39], v[164:167]
s_mul_i32 s41, s52, 96
s_add_u32 s41, s41, s42
v_mfma_f32_16x16x32_bf16 v[168:171], v[192:195], a[16:19], 0
v_cvt_pk_bf16_f32 v208, v128, v129
v_cvt_pk_bf16_f32 v209, v130, v131
v_mfma_f32_16x16x32_bf16 v[168:171], v[196:199], a[40:43], v[168:171]
v_cvt_pk_bf16_f32 v210, v132, v133
v_cvt_pk_bf16_f32 v211, v134, v135
v_mfma_f32_16x16x32_bf16 v[172:175], v[192:195], a[20:23], 0
buffer_load_dwordx4 v176, s[20:23], s35 offen offset:0  lds
buffer_store_dwordx4 v[208:211], v184, s[24:27], s41 offen offset:0 sc1
v_mfma_f32_16x16x32_bf16 v[172:175], v[196:199], a[44:47], v[172:175]
v_cvt_pk_bf16_f32 v212, v136, v137
s_waitcnt lgkmcnt(0)
v_mfma_f32_16x16x32_bf16 v[152:155], v[200:203], a[48:51], v[152:155]
ds_read_b64_tr_b16 v[192:193], v185 offset:49152
v_cvt_pk_bf16_f32 v213, v138, v139
v_mfma_f32_16x16x32_bf16 v[152:155], v[204:207], a[72:75], v[152:155]
ds_read_b64_tr_b16 v[194:195], v185 offset:51200
v_cvt_pk_bf16_f32 v214, v140, v141
v_mfma_f32_16x16x32_bf16 v[156:159], v[200:203], a[52:55], v[156:159]
ds_read_b64_tr_b16 v[196:197], v185 offset:53248
v_cvt_pk_bf16_f32 v215, v142, v143
v_mfma_f32_16x16x32_bf16 v[156:159], v[204:207], a[76:79], v[156:159]
ds_read_b64_tr_b16 v[198:199], v185 offset:55296
buffer_load_dwordx4 v177, s[20:23], s35 offen offset:1024  lds
v_mfma_f32_16x16x32_bf16 v[160:163], v[200:203], a[56:59], v[160:163]
buffer_store_dwordx4 v[212:215], v184, s[24:27], s41 offen offset:1024 sc1
v_cvt_pk_bf16_f32 v216, v144, v145
v_mfma_f32_16x16x32_bf16 v[160:163], v[204:207], a[80:83], v[160:163]
v_cvt_pk_bf16_f32 v217, v146, v147
v_cvt_pk_bf16_f32 v218, v148, v149
v_mfma_f32_16x16x32_bf16 v[164:167], v[200:203], a[60:63], v[164:167]
v_cvt_pk_bf16_f32 v219, v150, v151
buffer_store_dwordx4 v[216:219], v184, s[24:27], s41 offen offset:2048 sc1
v_mfma_f32_16x16x32_bf16 v[164:167], v[204:207], a[84:87], v[164:167]
v_mfma_f32_16x16x32_bf16 v[168:171], v[200:203], a[64:67], v[168:171]
buffer_load_dwordx4 v178, s[20:23], s35 offen offset:2048  lds
v_mfma_f32_16x16x32_bf16 v[168:171], v[204:207], a[88:91], v[168:171]
v_mfma_f32_16x16x32_bf16 v[172:175], v[200:203], a[68:71], v[172:175]
v_mfma_f32_16x16x32_bf16 v[172:175], v[204:207], a[92:95], v[172:175]
s_waitcnt lgkmcnt(0)
v_mfma_f32_16x16x32_bf16 v[152:155], v[192:195], a[96:99], v[152:155]
ds_read_b64_tr_b16 v[200:201], v185 offset:57344
v_mfma_f32_16x16x32_bf16 v[152:155], v[196:199], a[120:123], v[152:155]
ds_read_b64_tr_b16 v[202:203], v185 offset:59392
buffer_load_dwordx4 v179, s[20:23], s35 offen offset:3072  lds
v_mfma_f32_16x16x32_bf16 v[156:159], v[192:195], a[100:103], v[156:159]
ds_read_b64_tr_b16 v[204:205], v185 offset:61440
v_mfma_f32_16x16x32_bf16 v[156:159], v[196:199], a[124:127], v[156:159]
ds_read_b64_tr_b16 v[206:207], v185 offset:63488
v_mfma_f32_16x16x32_bf16 v[160:163], v[192:195], a[104:107], v[160:163]
v_mfma_f32_16x16x32_bf16 v[160:163], v[196:199], a[128:131], v[160:163]
v_mfma_f32_16x16x32_bf16 v[164:167], v[192:195], a[108:111], v[164:167]
v_mfma_f32_16x16x32_bf16 v[164:167], v[196:199], a[132:135], v[164:167]
v_mfma_f32_16x16x32_bf16 v[168:171], v[192:195], a[112:115], v[168:171]
v_mfma_f32_16x16x32_bf16 v[168:171], v[196:199], a[136:139], v[168:171]
v_mfma_f32_16x16x32_bf16 v[172:175], v[192:195], a[116:119], v[172:175]
s_add_u32 m0, s43, 98304
s_add_u32 s37, s76, s55
v_mfma_f32_16x16x32_bf16 v[172:175], v[196:199], a[140:143], v[172:175]
s_waitcnt vmcnt(30) lgkmcnt(0)
s_barrier
s_add_u32 s35, s37, 294912
v_mfma_f32_16x16x32_bf16 v[152:155], v[200:203], a[144:147], v[152:155]
ds_read_b64_tr_b16 v[192:193], v186 offset:0
buffer_load_dwordx4 v176, s[20:23], s35 offen offset:0  lds
v_mfma_f32_16x16x32_bf16 v[152:155], v[204:207], a[168:171], v[152:155]
ds_read_b64_tr_b16 v[194:195], v186 offset:2048
v_mfma_f32_16x16x32_bf16 v[156:159], v[200:203], a[148:151], v[156:159]
ds_read_b64_tr_b16 v[196:197], v186 offset:4096
v_mfma_f32_16x16x32_bf16 v[156:159], v[204:207], a[172:175], v[156:159]
ds_read_b64_tr_b16 v[198:199], v186 offset:6144
v_mfma_f32_16x16x32_bf16 v[160:163], v[200:203], a[152:155], v[160:163]
v_mfma_f32_16x16x32_bf16 v[160:163], v[204:207], a[176:179], v[160:163]
buffer_load_dwordx4 v177, s[20:23], s35 offen offset:1024  lds
v_mfma_f32_16x16x32_bf16 v[164:167], v[200:203], a[156:159], v[164:167]
v_mfma_f32_16x16x32_bf16 v[164:167], v[204:207], a[180:183], v[164:167]
v_mfma_f32_16x16x32_bf16 v[168:171], v[200:203], a[160:163], v[168:171]
v_mfma_f32_16x16x32_bf16 v[168:171], v[204:207], a[184:187], v[168:171]
v_mfma_f32_16x16x32_bf16 v[172:175], v[200:203], a[164:167], v[172:175]
buffer_load_dwordx4 v178, s[20:23], s35 offen offset:2048  lds
v_mfma_f32_16x16x32_bf16 v[172:175], v[204:207], a[188:191], v[172:175]
s_waitcnt lgkmcnt(0)
v_mfma_f32_16x16x32_bf16 v[152:155], v[192:195], a[192:195], v[152:155]
ds_read_b64_tr_b16 v[200:201], v186 offset:8192
v_mfma_f32_16x16x32_bf16 v[152:155], v[196:199], a[216:219], v[152:155]
ds_read_b64_tr_b16 v[202:203], v186 offset:10240
v_mfma_f32_16x16x32_bf16 v[156:159], v[192:195], a[196:199], v[156:159]
ds_read_b64_tr_b16 v[204:205], v186 offset:12288
v_mfma_f32_16x16x32_bf16 v[156:159], v[196:199], a[220:223], v[156:159]
ds_read_b64_tr_b16 v[206:207], v186 offset:14336
buffer_load_dwordx4 v179, s[20:23], s35 offen offset:3072  lds
v_mfma_f32_16x16x32_bf16 v[160:163], v[192:195], a[200:203], v[160:163]
s_add_u32 m0, s43, 102400
s_add_u32 s35, s37, 331776
v_mfma_f32_16x16x32_bf16 v[160:163], v[196:199], a[224:227], v[160:163]
v_mfma_f32_16x16x32_bf16 v[164:167], v[192:195], a[204:207], v[164:167]
v_mfma_f32_16x16x32_bf16 v[164:167], v[196:199], a[228:231], v[164:167]
v_mfma_f32_16x16x32_bf16 v[168:171], v[192:195], a[208:211], v[168:171]
buffer_load_dwordx4 v176, s[20:23], s35 offen offset:0  lds
v_mfma_f32_16x16x32_bf16 v[168:171], v[196:199], a[232:235], v[168:171]
v_mfma_f32_16x16x32_bf16 v[172:175], v[192:195], a[212:215], v[172:175]
v_mfma_f32_16x16x32_bf16 v[172:175], v[196:199], a[236:239], v[172:175]
s_waitcnt lgkmcnt(0)
v_mfma_f32_16x16x32_bf16 v[152:155], v[200:203], a[240:243], v[152:155]
ds_read_b64_tr_b16 v[192:193], v186 offset:16384
v_mfma_f32_16x16x32_bf16 v[152:155], v[204:207], v[8:11], v[152:155]
ds_read_b64_tr_b16 v[194:195], v186 offset:18432
buffer_load_dwordx4 v177, s[20:23], s35 offen offset:1024  lds
v_mfma_f32_16x16x32_bf16 v[156:159], v[200:203], a[244:247], v[156:159]
ds_read_b64_tr_b16 v[196:197], v186 offset:20480
v_mfma_f32_16x16x32_bf16 v[156:159], v[204:207], v[12:15], v[156:159]
ds_read_b64_tr_b16 v[198:199], v186 offset:22528
v_mfma_f32_16x16x32_bf16 v[160:163], v[200:203], a[248:251], v[160:163]
v_mfma_f32_16x16x32_bf16 v[160:163], v[204:207], v[16:19], v[160:163]
v_mfma_f32_16x16x32_bf16 v[164:167], v[200:203], a[252:255], v[164:167]
buffer_load_dwordx4 v178, s[20:23], s35 offen offset:2048  lds
v_mfma_f32_16x16x32_bf16 v[164:167], v[204:207], v[20:23], v[164:167]
v_mfma_f32_16x16x32_bf16 v[168:171], v[200:203], v[0:3], v[168:171]
v_mfma_f32_16x16x32_bf16 v[168:171], v[204:207], v[24:27], v[168:171]
v_mfma_f32_16x16x32_bf16 v[172:175], v[200:203], v[4:7], v[172:175]
v_mfma_f32_16x16x32_bf16 v[172:175], v[204:207], v[28:31], v[172:175]
buffer_load_dwordx4 v179, s[20:23], s35 offen offset:3072  lds
s_waitcnt lgkmcnt(0)
v_mfma_f32_16x16x32_bf16 v[152:155], v[192:195], v[32:35], v[152:155]
ds_read_b64_tr_b16 v[200:201], v186 offset:24576
v_mfma_f32_16x16x32_bf16 v[152:155], v[196:199], v[56:59], v[152:155]
ds_read_b64_tr_b16 v[202:203], v186 offset:26624
v_mfma_f32_16x16x32_bf16 v[156:159], v[192:195], v[36:39], v[156:159]
ds_read_b64_tr_b16 v[204:205], v186 offset:28672
v_mfma_f32_16x16x32_bf16 v[156:159], v[196:199], v[60:63], v[156:159]
ds_read_b64_tr_b16 v[206:207], v186 offset:30720
v_mfma_f32_16x16x32_bf16 v[160:163], v[192:195], v[40:43], v[160:163]
v_mfma_f32_16x16x32_bf16 v[160:163], v[196:199], v[64:67], v[160:163]
v_mfma_f32_16x16x32_bf16 v[164:167], v[192:195], v[44:47], v[164:167]
v_mfma_f32_16x16x32_bf16 v[164:167], v[196:199], v[68:71], v[164:167]
v_mfma_f32_16x16x32_bf16 v[168:171], v[192:195], v[48:51], v[168:171]
v_mfma_f32_16x16x32_bf16 v[168:171], v[196:199], v[72:75], v[168:171]
v_mfma_f32_16x16x32_bf16 v[172:175], v[192:195], v[52:55], v[172:175]
s_add_u32 m0, s43, 131072
s_add_u32 s37, s76, s56
v_mfma_f32_16x16x32_bf16 v[172:175], v[196:199], v[76:79], v[172:175]
s_waitcnt vmcnt(27) lgkmcnt(0)
s_barrier
s_add_u32 s35, s37, 0
v_mfma_f32_16x16x32_bf16 v[152:155], v[200:203], v[80:83], v[152:155]
ds_read_b64_tr_b16 v[192:193], v180 offset:0
buffer_load_dwordx4 v176, s[20:23], s35 offen offset:0  lds
v_mfma_f32_16x16x32_bf16 v[152:155], v[204:207], v[104:107], v[152:155]
ds_read_b64_tr_b16 v[194:195], v180 offset:2048
v_mfma_f32_16x16x32_bf16 v[156:159], v[200:203], v[84:87], v[156:159]
ds_read_b64_tr_b16 v[196:197], v180 offset:4096
v_mfma_f32_16x16x32_bf16 v[156:159], v[204:207], v[108:111], v[156:159]
ds_read_b64_tr_b16 v[198:199], v180 offset:6144
v_mfma_f32_16x16x32_bf16 v[160:163], v[200:203], v[88:91], v[160:163]
v_mfma_f32_16x16x32_bf16 v[160:163], v[204:207], v[112:115], v[160:163]
buffer_load_dwordx4 v177, s[20:23], s35 offen offset:1024  lds
v_mfma_f32_16x16x32_bf16 v[164:167], v[200:203], v[92:95], v[164:167]
v_mfma_f32_16x16x32_bf16 v[164:167], v[204:207], v[116:119], v[164:167]
v_mfma_f32_16x16x32_bf16 v[168:171], v[200:203], v[96:99], v[168:171]
v_mfma_f32_16x16x32_bf16 v[168:171], v[204:207], v[120:123], v[168:171]
v_mfma_f32_16x16x32_bf16 v[172:175], v[200:203], v[100:103], v[172:175]
buffer_load_dwordx4 v178, s[20:23], s35 offen offset:2048  lds
v_mfma_f32_16x16x32_bf16 v[172:175], v[204:207], v[124:127], v[172:175]
s_waitcnt lgkmcnt(0)
v_mfma_f32_16x16x32_bf16 v[128:131], v[192:195], a[0:3], 0
ds_read_b64_tr_b16 v[200:201], v180 offset:8192
v_mfma_f32_16x16x32_bf16 v[128:131], v[196:199], a[24:27], v[128:131]
ds_read_b64_tr_b16 v[202:203], v180 offset:10240
v_mfma_f32_16x16x32_bf16 v[132:135], v[192:195], a[4:7], 0
ds_read_b64_tr_b16 v[204:205], v180 offset:12288
v_mfma_f32_16x16x32_bf16 v[132:135], v[196:199], a[28:31], v[132:135]
ds_read_b64_tr_b16 v[206:207], v180 offset:14336
buffer_load_dwordx4 v179, s[20:23], s35 offen offset:3072  lds
v_mfma_f32_16x16x32_bf16 v[136:139], v[192:195], a[8:11], 0
s_add_u32 m0, s43, 135168
s_add_u32 s35, s37, 36864
v_mfma_f32_16x16x32_bf16 v[136:139], v[196:199], a[32:35], v[136:139]
s_mul_i32 s41, s53, 96
s_add_u32 s41, s41, s42
v_mfma_f32_16x16x32_bf16 v[140:143], v[192:195], a[12:15], 0
v_cvt_pk_bf16_f32 v220, v152, v153
v_cvt_pk_bf16_f32 v221, v154, v155
v_mfma_f32_16x16x32_bf16 v[140:143], v[196:199], a[36:39], v[140:143]
v_cvt_pk_bf16_f32 v222, v156, v157
v_cvt_pk_bf16_f32 v223, v158, v159
v_mfma_f32_16x16x32_bf16 v[144:147], v[192:195], a[16:19], 0
buffer_load_dwordx4 v176, s[20:23], s35 offen offset:0  lds
buffer_store_dwordx4 v[220:223], v184, s[24:27], s41 offen offset:0 sc1
v_mfma_f32_16x16x32_bf16 v[144:147], v[196:199], a[40:43], v[144:147]
v_mfma_f32_16x16x32_bf16 v[148:151], v[192:195], a[20:23], 0
v_cvt_pk_bf16_f32 v224, v160, v161
v_cvt_pk_bf16_f32 v225, v162, v163
v_mfma_f32_16x16x32_bf16 v[148:151], v[196:199], a[44:47], v[148:151]
v_cvt_pk_bf16_f32 v226, v164, v165
s_waitcnt lgkmcnt(0)
v_mfma_f32_16x16x32_bf16 v[128:131], v[200:203], a[48:51], v[128:131]
ds_read_b64_tr_b16 v[192:193], v180 offset:16384
v_cvt_pk_bf16_f32 v227, v166, v167
v_mfma_f32_16x16x32_bf16 v[128:131], v[204:207], a[72:75], v[128:131]
ds_read_b64_tr_b16 v[194:195], v180 offset:18432
buffer_load_dwordx4 v177, s[20:23], s35 offen offset:1024  lds
v_mfma_f32_16x16x32_bf16 v[132:135], v[200:203], a[52:55], v[132:135]
ds_read_b64_tr_b16 v[196:197], v180 offset:20480
buffer_store_dwordx4 v[224:227], v184, s[24:27], s41 offen offset:1024 sc1
v_mfma_f32_16x16x32_bf16 v[132:135], v[204:207], a[76:79], v[132:135]
ds_read_b64_tr_b16 v[198:199], v180 offset:22528
v_cvt_pk_bf16_f32 v228, v168, v169
v_mfma_f32_16x16x32_bf16 v[136:139], v[200:203], a[56:59], v[136:139]
v_cvt_pk_bf16_f32 v229, v170, v171
v_cvt_pk_bf16_f32 v230, v172, v173
v_mfma_f32_16x16x32_bf16 v[136:139], v[204:207], a[80:83], v[136:139]
v_cvt_pk_bf16_f32 v231, v174, v175
buffer_store_dwordx4 v[228:231], v184, s[24:27], s41 offen offset:2048 sc1
v_mfma_f32_16x16x32_bf16 v[140:143], v[200:203], a[60:63], v[140:143]
buffer_load_dwordx4 v178, s[20:23], s35 offen offset:2048  lds
v_mfma_f32_16x16x32_bf16 v[140:143], v[204:207], a[84:87], v[140:143]
v_mfma_f32_16x16x32_bf16 v[144:147], v[200:203], a[64:67], v[144:147]
v_mfma_f32_16x16x32_bf16 v[144:147], v[204:207], a[88:91], v[144:147]
v_mfma_f32_16x16x32_bf16 v[148:151], v[200:203], a[68:71], v[148:151]
v_mfma_f32_16x16x32_bf16 v[148:151], v[204:207], a[92:95], v[148:151]
buffer_load_dwordx4 v179, s[20:23], s35 offen offset:3072  lds
s_waitcnt lgkmcnt(0)
v_mfma_f32_16x16x32_bf16 v[128:131], v[192:195], a[96:99], v[128:131]
ds_read_b64_tr_b16 v[200:201], v180 offset:24576
v_mfma_f32_16x16x32_bf16 v[128:131], v[196:199], a[120:123], v[128:131]
ds_read_b64_tr_b16 v[202:203], v180 offset:26624
v_mfma_f32_16x16x32_bf16 v[132:135], v[192:195], a[100:103], v[132:135]
ds_read_b64_tr_b16 v[204:205], v180 offset:28672
v_mfma_f32_16x16x32_bf16 v[132:135], v[196:199], a[124:127], v[132:135]
ds_read_b64_tr_b16 v[206:207], v180 offset:30720
v_mfma_f32_16x16x32_bf16 v[136:139], v[192:195], a[104:107], v[136:139]
v_mfma_f32_16x16x32_bf16 v[136:139], v[196:199], a[128:131], v[136:139]
v_mfma_f32_16x16x32_bf16 v[140:143], v[192:195], a[108:111], v[140:143]
v_mfma_f32_16x16x32_bf16 v[140:143], v[196:199], a[132:135], v[140:143]
v_mfma_f32_16x16x32_bf16 v[144:147], v[192:195], a[112:115], v[144:147]
v_mfma_f32_16x16x32_bf16 v[144:147], v[196:199], a[136:139], v[144:147]
v_mfma_f32_16x16x32_bf16 v[148:151], v[192:195], a[116:119], v[148:151]
s_add_u32 m0, s43, 0
s_add_u32 s37, s76, s56
v_mfma_f32_16x16x32_bf16 v[148:151], v[196:199], a[140:143], v[148:151]
s_waitcnt vmcnt(30) lgkmcnt(0)
s_barrier
s_add_u32 s35, s37, 294912
v_mfma_f32_16x16x32_bf16 v[128:131], v[200:203], a[144:147], v[128:131]
ds_read_b64_tr_b16 v[192:193], v185 offset:0
buffer_load_dwordx4 v176, s[20:23], s35 offen offset:0  lds
v_mfma_f32_16x16x32_bf16 v[128:131], v[204:207], a[168:171], v[128:131]
ds_read_b64_tr_b16 v[194:195], v185 offset:2048
v_mfma_f32_16x16x32_bf16 v[132:135], v[200:203], a[148:151], v[132:135]
ds_read_b64_tr_b16 v[196:197], v185 offset:4096
v_mfma_f32_16x16x32_bf16 v[132:135], v[204:207], a[172:175], v[132:135]
ds_read_b64_tr_b16 v[198:199], v185 offset:6144
v_mfma_f32_16x16x32_bf16 v[136:139], v[200:203], a[152:155], v[136:139]
v_mfma_f32_16x16x32_bf16 v[136:139], v[204:207], a[176:179], v[136:139]
buffer_load_dwordx4 v177, s[20:23], s35 offen offset:1024  lds
v_mfma_f32_16x16x32_bf16 v[140:143], v[200:203], a[156:159], v[140:143]
v_mfma_f32_16x16x32_bf16 v[140:143], v[204:207], a[180:183], v[140:143]
v_mfma_f32_16x16x32_bf16 v[144:147], v[200:203], a[160:163], v[144:147]
v_mfma_f32_16x16x32_bf16 v[144:147], v[204:207], a[184:187], v[144:147]
v_mfma_f32_16x16x32_bf16 v[148:151], v[200:203], a[164:167], v[148:151]
buffer_load_dwordx4 v178, s[20:23], s35 offen offset:2048  lds
v_mfma_f32_16x16x32_bf16 v[148:151], v[204:207], a[188:191], v[148:151]
s_waitcnt lgkmcnt(0)
v_mfma_f32_16x16x32_bf16 v[128:131], v[192:195], a[192:195], v[128:131]
ds_read_b64_tr_b16 v[200:201], v185 offset:8192
v_mfma_f32_16x16x32_bf16 v[128:131], v[196:199], a[216:219], v[128:131]
ds_read_b64_tr_b16 v[202:203], v185 offset:10240
v_mfma_f32_16x16x32_bf16 v[132:135], v[192:195], a[196:199], v[132:135]
ds_read_b64_tr_b16 v[204:205], v185 offset:12288
v_mfma_f32_16x16x32_bf16 v[132:135], v[196:199], a[220:223], v[132:135]
ds_read_b64_tr_b16 v[206:207], v185 offset:14336
buffer_load_dwordx4 v179, s[20:23], s35 offen offset:3072  lds
v_mfma_f32_16x16x32_bf16 v[136:139], v[192:195], a[200:203], v[136:139]
s_add_u32 m0, s43, 4096
s_add_u32 s35, s37, 331776
v_mfma_f32_16x16x32_bf16 v[136:139], v[196:199], a[224:227], v[136:139]
v_mfma_f32_16x16x32_bf16 v[140:143], v[192:195], a[204:207], v[140:143]
v_mfma_f32_16x16x32_bf16 v[140:143], v[196:199], a[228:231], v[140:143]
v_mfma_f32_16x16x32_bf16 v[144:147], v[192:195], a[208:211], v[144:147]
buffer_load_dwordx4 v176, s[20:23], s35 offen offset:0  lds
v_mfma_f32_16x16x32_bf16 v[144:147], v[196:199], a[232:235], v[144:147]
v_mfma_f32_16x16x32_bf16 v[148:151], v[192:195], a[212:215], v[148:151]
v_mfma_f32_16x16x32_bf16 v[148:151], v[196:199], a[236:239], v[148:151]
s_waitcnt lgkmcnt(0)
v_mfma_f32_16x16x32_bf16 v[128:131], v[200:203], a[240:243], v[128:131]
ds_read_b64_tr_b16 v[192:193], v185 offset:16384
v_mfma_f32_16x16x32_bf16 v[128:131], v[204:207], v[8:11], v[128:131]
ds_read_b64_tr_b16 v[194:195], v185 offset:18432
buffer_load_dwordx4 v177, s[20:23], s35 offen offset:1024  lds
v_mfma_f32_16x16x32_bf16 v[132:135], v[200:203], a[244:247], v[132:135]
ds_read_b64_tr_b16 v[196:197], v185 offset:20480
v_mfma_f32_16x16x32_bf16 v[132:135], v[204:207], v[12:15], v[132:135]
ds_read_b64_tr_b16 v[198:199], v185 offset:22528
v_mfma_f32_16x16x32_bf16 v[136:139], v[200:203], a[248:251], v[136:139]
v_mfma_f32_16x16x32_bf16 v[136:139], v[204:207], v[16:19], v[136:139]
v_mfma_f32_16x16x32_bf16 v[140:143], v[200:203], a[252:255], v[140:143]
buffer_load_dwordx4 v178, s[20:23], s35 offen offset:2048  lds
v_mfma_f32_16x16x32_bf16 v[140:143], v[204:207], v[20:23], v[140:143]
v_mfma_f32_16x16x32_bf16 v[144:147], v[200:203], v[0:3], v[144:147]
v_mfma_f32_16x16x32_bf16 v[144:147], v[204:207], v[24:27], v[144:147]
v_mfma_f32_16x16x32_bf16 v[148:151], v[200:203], v[4:7], v[148:151]
v_mfma_f32_16x16x32_bf16 v[148:151], v[204:207], v[28:31], v[148:151]
buffer_load_dwordx4 v179, s[20:23], s35 offen offset:3072  lds
s_waitcnt lgkmcnt(0)
v_mfma_f32_16x16x32_bf16 v[128:131], v[192:195], v[32:35], v[128:131]
ds_read_b64_tr_b16 v[200:201], v185 offset:24576
v_mfma_f32_16x16x32_bf16 v[128:131], v[196:199], v[56:59], v[128:131]
ds_read_b64_tr_b16 v[202:203], v185 offset:26624
v_mfma_f32_16x16x32_bf16 v[132:135], v[192:195], v[36:39], v[132:135]
ds_read_b64_tr_b16 v[204:205], v185 offset:28672
v_mfma_f32_16x16x32_bf16 v[132:135], v[196:199], v[60:63], v[132:135]
ds_read_b64_tr_b16 v[206:207], v185 offset:30720
v_mfma_f32_16x16x32_bf16 v[136:139], v[192:195], v[40:43], v[136:139]
v_mfma_f32_16x16x32_bf16 v[136:139], v[196:199], v[64:67], v[136:139]
v_mfma_f32_16x16x32_bf16 v[140:143], v[192:195], v[44:47], v[140:143]
v_mfma_f32_16x16x32_bf16 v[140:143], v[196:199], v[68:71], v[140:143]
v_mfma_f32_16x16x32_bf16 v[144:147], v[192:195], v[48:51], v[144:147]
v_mfma_f32_16x16x32_bf16 v[144:147], v[196:199], v[72:75], v[144:147]
v_mfma_f32_16x16x32_bf16 v[148:151], v[192:195], v[52:55], v[148:151]
v_mfma_f32_16x16x32_bf16 v[148:151], v[196:199], v[76:79], v[148:151]
s_waitcnt vmcnt(27) lgkmcnt(0)
s_barrier
v_mfma_f32_16x16x32_bf16 v[128:131], v[200:203], v[80:83], v[128:131]
ds_read_b64_tr_b16 v[192:193], v180 offset:32768
s_waitcnt vmcnt(10)
v_mov_b32 v234, 6
buffer_store_dword v234, v241, s[24:27], s19 offen sc1
v_mfma_f32_16x16x32_bf16 v[128:131], v[204:207], v[104:107], v[128:131]
ds_read_b64_tr_b16 v[194:195], v180 offset:34816
v_mfma_f32_16x16x32_bf16 v[132:135], v[200:203], v[84:87], v[132:135]
ds_read_b64_tr_b16 v[196:197], v180 offset:36864
v_mfma_f32_16x16x32_bf16 v[132:135], v[204:207], v[108:111], v[132:135]
ds_read_b64_tr_b16 v[198:199], v180 offset:38912
v_mfma_f32_16x16x32_bf16 v[136:139], v[200:203], v[88:91], v[136:139]
v_mfma_f32_16x16x32_bf16 v[136:139], v[204:207], v[112:115], v[136:139]
v_mfma_f32_16x16x32_bf16 v[140:143], v[200:203], v[92:95], v[140:143]
v_mfma_f32_16x16x32_bf16 v[140:143], v[204:207], v[116:119], v[140:143]
v_mfma_f32_16x16x32_bf16 v[144:147], v[200:203], v[96:99], v[144:147]
v_mfma_f32_16x16x32_bf16 v[144:147], v[204:207], v[120:123], v[144:147]
v_mfma_f32_16x16x32_bf16 v[148:151], v[200:203], v[100:103], v[148:151]
v_mfma_f32_16x16x32_bf16 v[148:151], v[204:207], v[124:127], v[148:151]
s_waitcnt lgkmcnt(0)
v_mfma_f32_16x16x32_bf16 v[152:155], v[192:195], a[0:3], 0
ds_read_b64_tr_b16 v[200:201], v180 offset:40960
v_mfma_f32_16x16x32_bf16 v[152:155], v[196:199], a[24:27], v[152:155]
ds_read_b64_tr_b16 v[202:203], v180 offset:43008
v_mfma_f32_16x16x32_bf16 v[156:159], v[192:195], a[4:7], 0
ds_read_b64_tr_b16 v[204:205], v180 offset:45056
v_mfma_f32_16x16x32_bf16 v[156:159], v[196:199], a[28:31], v[156:159]
ds_read_b64_tr_b16 v[206:207], v180 offset:47104
v_mfma_f32_16x16x32_bf16 v[160:163], v[192:195], a[8:11], 0
v_mfma_f32_16x16x32_bf16 v[160:163], v[196:199], a[32:35], v[160:163]
s_mul_i32 s41, s54, 96
s_add_u32 s41, s41, s42
v_mfma_f32_16x16x32_bf16 v[164:167], v[192:195], a[12:15], 0
v_cvt_pk_bf16_f32 v208, v128, v129
v_cvt_pk_bf16_f32 v209, v130, v131
v_mfma_f32_16x16x32_bf16 v[164:167], v[196:199], a[36:39], v[164:167]
v_cvt_pk_bf16_f32 v210, v132, v133
v_cvt_pk_bf16_f32 v211, v134, v135
v_mfma_f32_16x16x32_bf16 v[168:171], v[192:195], a[16:19], 0
buffer_store_dwordx4 v[208:211], v184, s[24:27], s41 offen offset:0 sc1
v_mfma_f32_16x16x32_bf16 v[168:171], v[196:199], a[40:43], v[168:171]
v_mfma_f32_16x16x32_bf16 v[172:175], v[192:195], a[20:23], 0
v_cvt_pk_bf16_f32 v212, v136, v137
v_cvt_pk_bf16_f32 v213, v138, v139
v_mfma_f32_16x16x32_bf16 v[172:175], v[196:199], a[44:47], v[172:175]
v_cvt_pk_bf16_f32 v214, v140, v141
s_waitcnt lgkmcnt(0)
v_mfma_f32_16x16x32_bf16 v[152:155], v[200:203], a[48:51], v[152:155]
ds_read_b64_tr_b16 v[192:193], v180 offset:49152
v_cvt_pk_bf16_f32 v215, v142, v143
v_mfma_f32_16x16x32_bf16 v[152:155], v[204:207], a[72:75], v[152:155]
ds_read_b64_tr_b16 v[194:195], v180 offset:51200
buffer_store_dwordx4 v[212:215], v184, s[24:27], s41 offen offset:1024 sc1
v_mfma_f32_16x16x32_bf16 v[156:159], v[200:203], a[52:55], v[156:159]
ds_read_b64_tr_b16 v[196:197], v180 offset:53248
v_mfma_f32_16x16x32_bf16 v[156:159], v[204:207], a[76:79], v[156:159]
ds_read_b64_tr_b16 v[198:199], v180 offset:55296
v_cvt_pk_bf16_f32 v216, v144, v145
v_mfma_f32_16x16x32_bf16 v[160:163], v[200:203], a[56:59], v[160:163]
v_cvt_pk_bf16_f32 v217, v146, v147
v_cvt_pk_bf16_f32 v218, v148, v149
v_mfma_f32_16x16x32_bf16 v[160:163], v[204:207], a[80:83], v[160:163]
v_cvt_pk_bf16_f32 v219, v150, v151
buffer_store_dwordx4 v[216:219], v184, s[24:27], s41 offen offset:2048 sc1
v_mfma_f32_16x16x32_bf16 v[164:167], v[200:203], a[60:63], v[164:167]
v_mfma_f32_16x16x32_bf16 v[164:167], v[204:207], a[84:87], v[164:167]
v_mfma_f32_16x16x32_bf16 v[168:171], v[200:203], a[64:67], v[168:171]
v_mfma_f32_16x16x32_bf16 v[168:171], v[204:207], a[88:91], v[168:171]
v_mfma_f32_16x16x32_bf16 v[172:175], v[200:203], a[68:71], v[172:175]
v_mfma_f32_16x16x32_bf16 v[172:175], v[204:207], a[92:95], v[172:175]
s_waitcnt lgkmcnt(0)
v_mfma_f32_16x16x32_bf16 v[152:155], v[192:195], a[96:99], v[152:155]
ds_read_b64_tr_b16 v[200:201], v180 offset:57344
v_mfma_f32_16x16x32_bf16 v[152:155], v[196:199], a[120:123], v[152:155]
ds_read_b64_tr_b16 v[202:203], v180 offset:59392
v_mfma_f32_16x16x32_bf16 v[156:159], v[192:195], a[100:103], v[156:159]
ds_read_b64_tr_b16 v[204:205], v180 offset:61440
v_mfma_f32_16x16x32_bf16 v[156:159], v[196:199], a[124:127], v[156:159]
ds_read_b64_tr_b16 v[206:207], v180 offset:63488
v_mfma_f32_16x16x32_bf16 v[160:163], v[192:195], a[104:107], v[160:163]
v_mfma_f32_16x16x32_bf16 v[160:163], v[196:199], a[128:131], v[160:163]
v_mfma_f32_16x16x32_bf16 v[164:167], v[192:195], a[108:111], v[164:167]
v_mfma_f32_16x16x32_bf16 v[164:167], v[196:199], a[132:135], v[164:167]
v_mfma_f32_16x16x32_bf16 v[168:171], v[192:195], a[112:115], v[168:171]
v_mfma_f32_16x16x32_bf16 v[168:171], v[196:199], a[136:139], v[168:171]
buffer_load_dword v244, v240, s[24:27], s18 offen sc1
v_mfma_f32_16x16x32_bf16 v[172:175], v[192:195], a[116:119], v[172:175]
v_mfma_f32_16x16x32_bf16 v[172:175], v[196:199], a[140:143], v[172:175]
s_waitcnt lgkmcnt(0)
s_barrier
v_mfma_f32_16x16x32_bf16 v[152:155], v[200:203], a[144:147], v[152:155]
ds_read_b64_tr_b16 v[192:193], v185 offset:32768
v_mfma_f32_16x16x32_bf16 v[152:155], v[204:207], a[168:171], v[152:155]
ds_read_b64_tr_b16 v[194:195], v185 offset:34816
v_mfma_f32_16x16x32_bf16 v[156:159], v[200:203], a[148:151], v[156:159]
ds_read_b64_tr_b16 v[196:197], v185 offset:36864
v_mfma_f32_16x16x32_bf16 v[156:159], v[204:207], a[172:175], v[156:159]
ds_read_b64_tr_b16 v[198:199], v185 offset:38912
v_mfma_f32_16x16x32_bf16 v[160:163], v[200:203], a[152:155], v[160:163]
v_mfma_f32_16x16x32_bf16 v[160:163], v[204:207], a[176:179], v[160:163]
v_mfma_f32_16x16x32_bf16 v[164:167], v[200:203], a[156:159], v[164:167]
v_mfma_f32_16x16x32_bf16 v[164:167], v[204:207], a[180:183], v[164:167]
v_mfma_f32_16x16x32_bf16 v[168:171], v[200:203], a[160:163], v[168:171]
v_mfma_f32_16x16x32_bf16 v[168:171], v[204:207], a[184:187], v[168:171]
v_mfma_f32_16x16x32_bf16 v[172:175], v[200:203], a[164:167], v[172:175]
v_mfma_f32_16x16x32_bf16 v[172:175], v[204:207], a[188:191], v[172:175]
s_waitcnt lgkmcnt(0)
v_mfma_f32_16x16x32_bf16 v[152:155], v[192:195], a[192:195], v[152:155]
ds_read_b64_tr_b16 v[200:201], v185 offset:40960
v_mfma_f32_16x16x32_bf16 v[152:155], v[196:199], a[216:219], v[152:155]
ds_read_b64_tr_b16 v[202:203], v185 offset:43008
v_mfma_f32_16x16x32_bf16 v[156:159], v[192:195], a[196:199], v[156:159]
ds_read_b64_tr_b16 v[204:205], v185 offset:45056
v_mfma_f32_16x16x32_bf16 v[156:159], v[196:199], a[220:223], v[156:159]
ds_read_b64_tr_b16 v[206:207], v185 offset:47104
v_mfma_f32_16x16x32_bf16 v[160:163], v[192:195], a[200:203], v[160:163]
s_waitcnt vmcnt(1)
v_mov_b32 v234, 7
buffer_store_dword v234, v241, s[24:27], s19 offen sc1
v_mfma_f32_16x16x32_bf16 v[160:163], v[196:199], a[224:227], v[160:163]
v_mfma_f32_16x16x32_bf16 v[164:167], v[192:195], a[204:207], v[164:167]
v_mfma_f32_16x16x32_bf16 v[164:167], v[196:199], a[228:231], v[164:167]
v_mfma_f32_16x16x32_bf16 v[168:171], v[192:195], a[208:211], v[168:171]
v_mfma_f32_16x16x32_bf16 v[168:171], v[196:199], a[232:235], v[168:171]
v_mfma_f32_16x16x32_bf16 v[172:175], v[192:195], a[212:215], v[172:175]
v_mfma_f32_16x16x32_bf16 v[172:175], v[196:199], a[236:239], v[172:175]
s_waitcnt lgkmcnt(0)
v_mfma_f32_16x16x32_bf16 v[152:155], v[200:203], a[240:243], v[152:155]
ds_read_b64_tr_b16 v[192:193], v185 offset:49152
v_mfma_f32_16x16x32_bf16 v[152:155], v[204:207], v[8:11], v[152:155]
ds_read_b64_tr_b16 v[194:195], v185 offset:51200
v_mfma_f32_16x16x32_bf16 v[156:159], v[200:203], a[244:247], v[156:159]
ds_read_b64_tr_b16 v[196:197], v185 offset:53248
v_mfma_f32_16x16x32_bf16 v[156:159], v[204:207], v[12:15], v[156:159]
ds_read_b64_tr_b16 v[198:199], v185 offset:55296
v_mfma_f32_16x16x32_bf16 v[160:163], v[200:203], a[248:251], v[160:163]
v_mfma_f32_16x16x32_bf16 v[160:163], v[204:207], v[16:19], v[160:163]
v_mfma_f32_16x16x32_bf16 v[164:167], v[200:203], a[252:255], v[164:167]
v_mfma_f32_16x16x32_bf16 v[164:167], v[204:207], v[20:23], v[164:167]
v_mfma_f32_16x16x32_bf16 v[168:171], v[200:203], v[0:3], v[168:171]
v_mfma_f32_16x16x32_bf16 v[168:171], v[204:207], v[24:27], v[168:171]
v_mfma_f32_16x16x32_bf16 v[172:175], v[200:203], v[4:7], v[172:175]
v_mfma_f32_16x16x32_bf16 v[172:175], v[204:207], v[28:31], v[172:175]
s_waitcnt lgkmcnt(0)
v_mfma_f32_16x16x32_bf16 v[152:155], v[192:195], v[32:35], v[152:155]
ds_read_b64_tr_b16 v[200:201], v185 offset:57344
v_mfma_f32_16x16x32_bf16 v[152:155], v[196:199], v[56:59], v[152:155]
ds_read_b64_tr_b16 v[202:203], v185 offset:59392
v_mfma_f32_16x16x32_bf16 v[156:159], v[192:195], v[36:39], v[156:159]
ds_read_b64_tr_b16 v[204:205], v185 offset:61440
v_mfma_f32_16x16x32_bf16 v[156:159], v[196:199], v[60:63], v[156:159]
ds_read_b64_tr_b16 v[206:207], v185 offset:63488
v_mfma_f32_16x16x32_bf16 v[160:163], v[192:195], v[40:43], v[160:163]
v_mfma_f32_16x16x32_bf16 v[160:163], v[196:199], v[64:67], v[160:163]
v_mfma_f32_16x16x32_bf16 v[164:167], v[192:195], v[44:47], v[164:167]
v_mfma_f32_16x16x32_bf16 v[164:167], v[196:199], v[68:71], v[164:167]
v_mfma_f32_16x16x32_bf16 v[168:171], v[192:195], v[48:51], v[168:171]
v_mfma_f32_16x16x32_bf16 v[168:171], v[196:199], v[72:75], v[168:171]
v_mfma_f32_16x16x32_bf16 v[172:175], v[192:195], v[52:55], v[172:175]
v_mfma_f32_16x16x32_bf16 v[172:175], v[196:199], v[76:79], v[172:175]
s_waitcnt lgkmcnt(0)
s_barrier
v_mfma_f32_16x16x32_bf16 v[152:155], v[200:203], v[80:83], v[152:155]
ds_read_b64_tr_b16 v[192:193], v186 offset:0
v_mfma_f32_16x16x32_bf16 v[152:155], v[204:207], v[104:107], v[152:155]
ds_read_b64_tr_b16 v[194:195], v186 offset:2048
v_mfma_f32_16x16x32_bf16 v[156:159], v[200:203], v[84:87], v[156:159]
ds_read_b64_tr_b16 v[196:197], v186 offset:4096
v_mfma_f32_16x16x32_bf16 v[156:159], v[204:207], v[108:111], v[156:159]
ds_read_b64_tr_b16 v[198:199], v186 offset:6144
v_mfma_f32_16x16x32_bf16 v[160:163], v[200:203], v[88:91], v[160:163]
v_mfma_f32_16x16x32_bf16 v[160:163], v[204:207], v[112:115], v[160:163]
v_mfma_f32_16x16x32_bf16 v[164:167], v[200:203], v[92:95], v[164:167]
v_mfma_f32_16x16x32_bf16 v[164:167], v[204:207], v[116:119], v[164:167]
v_mfma_f32_16x16x32_bf16 v[168:171], v[200:203], v[96:99], v[168:171]
v_mfma_f32_16x16x32_bf16 v[168:171], v[204:207], v[120:123], v[168:171]
v_mfma_f32_16x16x32_bf16 v[172:175], v[200:203], v[100:103], v[172:175]
v_mfma_f32_16x16x32_bf16 v[172:175], v[204:207], v[124:127], v[172:175]
s_waitcnt lgkmcnt(0)
v_mfma_f32_16x16x32_bf16 v[128:131], v[192:195], a[0:3], 0
ds_read_b64_tr_b16 v[200:201], v186 offset:8192
v_mfma_f32_16x16x32_bf16 v[128:131], v[196:199], a[24:27], v[128:131]
ds_read_b64_tr_b16 v[202:203], v186 offset:10240
v_mfma_f32_16x16x32_bf16 v[132:135], v[192:195], a[4:7], 0
ds_read_b64_tr_b16 v[204:205], v186 offset:12288
v_mfma_f32_16x16x32_bf16 v[132:135], v[196:199], a[28:31], v[132:135]
ds_read_b64_tr_b16 v[206:207], v186 offset:14336
v_mfma_f32_16x16x32_bf16 v[136:139], v[192:195], a[8:11], 0
v_mfma_f32_16x16x32_bf16 v[136:139], v[196:199], a[32:35], v[136:139]
s_mul_i32 s41, s55, 96
s_add_u32 s41, s41, s42
v_mfma_f32_16x16x32_bf16 v[140:143], v[192:195], a[12:15], 0
v_cvt_pk_bf16_f32 v220, v152, v153
v_cvt_pk_bf16_f32 v221, v154, v155
v_mfma_f32_16x16x32_bf16 v[140:143], v[196:199], a[36:39], v[140:143]
v_cvt_pk_bf16_f32 v222, v156, v157
v_cvt_pk_bf16_f32 v223, v158, v159
v_mfma_f32_16x16x32_bf16 v[144:147], v[192:195], a[16:19], 0
buffer_store_dwordx4 v[220:223], v184, s[24:27], s41 offen offset:0 sc1
v_mfma_f32_16x16x32_bf16 v[144:147], v[196:199], a[40:43], v[144:147]
v_mfma_f32_16x16x32_bf16 v[148:151], v[192:195], a[20:23], 0
v_cvt_pk_bf16_f32 v224, v160, v161
v_cvt_pk_bf16_f32 v225, v162, v163
v_mfma_f32_16x16x32_bf16 v[148:151], v[196:199], a[44:47], v[148:151]
v_cvt_pk_bf16_f32 v226, v164, v165
s_waitcnt lgkmcnt(0)
v_mfma_f32_16x16x32_bf16 v[128:131], v[200:203], a[48:51], v[128:131]
ds_read_b64_tr_b16 v[192:193], v186 offset:16384
v_cvt_pk_bf16_f32 v227, v166, v167
v_mfma_f32_16x16x32_bf16 v[128:131], v[204:207], a[72:75], v[128:131]
ds_read_b64_tr_b16 v[194:195], v186 offset:18432
buffer_store_dwordx4 v[224:227], v184, s[24:27], s41 offen offset:1024 sc1
v_mfma_f32_16x16x32_bf16 v[132:135], v[200:203], a[52:55], v[132:135]
ds_read_b64_tr_b16 v[196:197], v186 offset:20480
v_mfma_f32_16x16x32_bf16 v[132:135], v[204:207], a[76:79], v[132:135]
ds_read_b64_tr_b16 v[198:199], v186 offset:22528
v_cvt_pk_bf16_f32 v228, v168, v169
v_mfma_f32_16x16x32_bf16 v[136:139], v[200:203], a[56:59], v[136:139]
v_cvt_pk_bf16_f32 v229, v170, v171
v_cvt_pk_bf16_f32 v230, v172, v173
v_mfma_f32_16x16x32_bf16 v[136:139], v[204:207], a[80:83], v[136:139]
v_cvt_pk_bf16_f32 v231, v174, v175
buffer_store_dwordx4 v[228:231], v184, s[24:27], s41 offen offset:2048 sc1
v_mfma_f32_16x16x32_bf16 v[140:143], v[200:203], a[60:63], v[140:143]
v_mfma_f32_16x16x32_bf16 v[140:143], v[204:207], a[84:87], v[140:143]
s_waitcnt vmcnt(4)
v_cmp_lt_u32 vcc, v244, v232
s_nop 0
s_cmp_eq_u64 vcc, 0
s_cselect_b32 s57, s8, 2146435072
s_cselect_b32 s58, s9, 2146435072
s_cselect_b32 s59, s10, 2146435072
s_cselect_b32 s60, s11, 2146435072
s_cselect_b32 s61, s12, 2146435072
s_cselect_b32 s62, s15, 2146435072
v_mfma_f32_16x16x32_bf16 v[144:147], v[200:203], a[64:67], v[144:147]
v_mfma_f32_16x16x32_bf16 v[144:147], v[204:207], a[88:91], v[144:147]
buffer_load_dwordx4 a[0:3], v184, s[24:27], s57 offen offset:0 sc1
v_mfma_f32_16x16x32_bf16 v[148:151], v[200:203], a[68:71], v[148:151]
v_mfma_f32_16x16x32_bf16 v[148:151], v[204:207], a[92:95], v[148:151]
buffer_load_dwordx4 a[4:7], v184, s[24:27], s57 offen offset:1024 sc1
s_waitcnt lgkmcnt(0)
v_mfma_f32_16x16x32_bf16 v[128:131], v[192:195], a[96:99], v[128:131]
ds_read_b64_tr_b16 v[200:201], v186 offset:24576
v_mfma_f32_16x16x32_bf16 v[128:131], v[196:199], a[120:123], v[128:131]
ds_read_b64_tr_b16 v[202:203], v186 offset:26624
buffer_load_dwordx4 a[8:11], v184, s[24:27], s57 offen offset:2048 sc1
v_mfma_f32_16x16x32_bf16 v[132:135], v[192:195], a[100:103], v[132:135]
ds_read_b64_tr_b16 v[204:205], v186 offset:28672
v_mfma_f32_16x16x32_bf16 v[132:135], v[196:199], a[124:127], v[132:135]
ds_read_b64_tr_b16 v[206:207], v186 offset:30720
buffer_load_dwordx4 a[12:15], v184, s[24:27], s58 offen offset:0 sc1
v_mfma_f32_16x16x32_bf16 v[136:139], v[192:195], a[104:107], v[136:139]
v_mfma_f32_16x16x32_bf16 v[136:139], v[196:199], a[128:131], v[136:139]
buffer_load_dwordx4 a[16:19], v184, s[24:27], s58 offen offset:1024 sc1
v_mfma_f32_16x16x32_bf16 v[140:143], v[192:195], a[108:111], v[140:143]
v_mfma_f32_16x16x32_bf16 v[140:143], v[196:199], a[132:135], v[140:143]
buffer_load_dwordx4 a[20:23], v184, s[24:27], s58 offen offset:2048 sc1
v_mfma_f32_16x16x32_bf16 v[144:147], v[192:195], a[112:115], v[144:147]
v_mfma_f32_16x16x32_bf16 v[144:147], v[196:199], a[136:139], v[144:147]
buffer_load_dwordx4 a[24:27], v184, s[24:27], s59 offen offset:0 sc1
v_mfma_f32_16x16x32_bf16 v[148:151], v[192:195], a[116:119], v[148:151]
v_mfma_f32_16x16x32_bf16 v[148:151], v[196:199], a[140:143], v[148:151]
s_waitcnt lgkmcnt(0)
s_barrier
buffer_load_dwordx4 a[28:31], v184, s[24:27], s59 offen offset:1024 sc1
v_mfma_f32_16x16x32_bf16 v[128:131], v[200:203], a[144:147], v[128:131]
ds_read_b64_tr_b16 v[192:193], v180 offset:0
v_mfma_f32_16x16x32_bf16 v[128:131], v[204:207], a[168:171], v[128:131]
ds_read_b64_tr_b16 v[194:195], v180 offset:2048
buffer_load_dwordx4 a[32:35], v184, s[24:27], s59 offen offset:2048 sc1
v_mfma_f32_16x16x32_bf16 v[132:135], v[200:203], a[148:151], v[132:135]
ds_read_b64_tr_b16 v[196:197], v180 offset:4096
v_mfma_f32_16x16x32_bf16 v[132:135], v[204:207], a[172:175], v[132:135]
ds_read_b64_tr_b16 v[198:199], v180 offset:6144
buffer_load_dwordx4 a[36:39], v184, s[24:27], s60 offen offset:0 sc1
v_mfma_f32_16x16x32_bf16 v[136:139], v[200:203], a[152:155], v[136:139]
v_mfma_f32_16x16x32_bf16 v[136:139], v[204:207], a[176:179], v[136:139]
buffer_load_dwordx4 a[40:43], v184, s[24:27], s60 offen offset:1024 sc1
v_mfma_f32_16x16x32_bf16 v[140:143], v[200:203], a[156:159], v[140:143]
v_mfma_f32_16x16x32_bf16 v[140:143], v[204:207], a[180:183], v[140:143]
v_mfma_f32_16x16x32_bf16 v[144:147], v[200:203], a[160:163], v[144:147]
v_mfma_f32_16x16x32_bf16 v[144:147], v[204:207], a[184:187], v[144:147]
v_mfma_f32_16x16x32_bf16 v[148:151], v[200:203], a[164:167], v[148:151]
v_mfma_f32_16x16x32_bf16 v[148:151], v[204:207], a[188:191], v[148:151]
s_waitcnt lgkmcnt(0)
v_mfma_f32_16x16x32_bf16 v[128:131], v[192:195], a[192:195], v[128:131]
ds_read_b64_tr_b16 v[200:201], v180 offset:8192
v_mfma_f32_16x16x32_bf16 v[128:131], v[196:199], a[216:219], v[128:131]
ds_read_b64_tr_b16 v[202:203], v180 offset:10240
v_mfma_f32_16x16x32_bf16 v[132:135], v[192:195], a[196:199], v[132:135]
ds_read_b64_tr_b16 v[204:205], v180 offset:12288
buffer_load_dwordx4 a[44:47], v184, s[24:27], s60 offen offset:2048 sc1
v_mfma_f32_16x16x32_bf16 v[132:135], v[196:199], a[220:223], v[132:135]
ds_read_b64_tr_b16 v[206:207], v180 offset:14336
v_mfma_f32_16x16x32_bf16 v[136:139], v[192:195], a[200:203], v[136:139]
v_mfma_f32_16x16x32_bf16 v[136:139], v[196:199], a[224:227], v[136:139]
v_mfma_f32_16x16x32_bf16 v[140:143], v[192:195], a[204:207], v[140:143]
v_mfma_f32_16x16x32_bf16 v[140:143], v[196:199], a[228:231], v[140:143]
v_mfma_f32_16x16x32_bf16 v[144:147], v[192:195], a[208:211], v[144:147]
v_mfma_f32_16x16x32_bf16 v[144:147], v[196:199], a[232:235], v[144:147]
v_mfma_f32_16x16x32_bf16 v[148:151], v[192:195], a[212:215], v[148:151]
v_mfma_f32_16x16x32_bf16 v[148:151], v[196:199], a[236:239], v[148:151]
buffer_load_dwordx4 a[48:51], v184, s[24:27], s61 offen offset:0 sc1
s_waitcnt vmcnt(13)
v_mov_b32 v234, 8
buffer_store_dword v234, v241, s[24:27], s19 offen sc1
s_waitcnt lgkmcnt(0)
v_mfma_f32_16x16x32_bf16 v[128:131], v[200:203], a[240:243], v[128:131]
ds_read_b64_tr_b16 v[192:193], v180 offset:16384
v_mfma_f32_16x16x32_bf16 v[128:131], v[204:207], v[8:11], v[128:131]
ds_read_b64_tr_b16 v[194:195], v180 offset:18432
v_mfma_f32_16x16x32_bf16 v[132:135], v[200:203], a[244:247], v[132:135]
ds_read_b64_tr_b16 v[196:197], v180 offset:20480
v_mfma_f32_16x16x32_bf16 v[132:135], v[204:207], v[12:15], v[132:135]
ds_read_b64_tr_b16 v[198:199], v180 offset:22528
v_mfma_f32_16x16x32_bf16 v[136:139], v[200:203], a[248:251], v[136:139]
v_mfma_f32_16x16x32_bf16 v[136:139], v[204:207], v[16:19], v[136:139]
v_mfma_f32_16x16x32_bf16 v[140:143], v[200:203], a[252:255], v[140:143]
v_mfma_f32_16x16x32_bf16 v[140:143], v[204:207], v[20:23], v[140:143]
v_mfma_f32_16x16x32_bf16 v[144:147], v[200:203], v[0:3], v[144:147]
buffer_load_dwordx4 a[52:55], v184, s[24:27], s61 offen offset:1024 sc1
v_mfma_f32_16x16x32_bf16 v[144:147], v[204:207], v[24:27], v[144:147]
v_mfma_f32_16x16x32_bf16 v[148:151], v[200:203], v[4:7], v[148:151]
v_mfma_f32_16x16x32_bf16 v[148:151], v[204:207], v[28:31], v[148:151]
s_waitcnt lgkmcnt(0)
v_mfma_f32_16x16x32_bf16 v[128:131], v[192:195], v[32:35], v[128:131]
ds_read_b64_tr_b16 v[200:201], v180 offset:24576
v_mfma_f32_16x16x32_bf16 v[128:131], v[196:199], v[56:59], v[128:131]
ds_read_b64_tr_b16 v[202:203], v180 offset:26624
v_mfma_f32_16x16x32_bf16 v[132:135], v[192:195], v[36:39], v[132:135]
ds_read_b64_tr_b16 v[204:205], v180 offset:28672
v_mfma_f32_16x16x32_bf16 v[132:135], v[196:199], v[60:63], v[132:135]
ds_read_b64_tr_b16 v[206:207], v180 offset:30720
v_mfma_f32_16x16x32_bf16 v[136:139], v[192:195], v[40:43], v[136:139]
v_mfma_f32_16x16x32_bf16 v[136:139], v[196:199], v[64:67], v[136:139]
buffer_load_dwordx4 a[56:59], v184, s[24:27], s61 offen offset:2048 sc1
v_mfma_f32_16x16x32_bf16 v[140:143], v[192:195], v[44:47], v[140:143]
v_mfma_f32_16x16x32_bf16 v[140:143], v[196:199], v[68:71], v[140:143]
v_mfma_f32_16x16x32_bf16 v[144:147], v[192:195], v[48:51], v[144:147]
v_mfma_f32_16x16x32_bf16 v[144:147], v[196:199], v[72:75], v[144:147]
v_mfma_f32_16x16x32_bf16 v[148:151], v[192:195], v[52:55], v[148:151]
v_mfma_f32_16x16x32_bf16 v[148:151], v[196:199], v[76:79], v[148:151]
s_waitcnt lgkmcnt(0)
v_mfma_f32_16x16x32_bf16 v[128:131], v[200:203], v[80:83], v[128:131]
v_mfma_f32_16x16x32_bf16 v[128:131], v[204:207], v[104:107], v[128:131]
v_mfma_f32_16x16x32_bf16 v[132:135], v[200:203], v[84:87], v[132:135]
v_mfma_f32_16x16x32_bf16 v[132:135], v[204:207], v[108:111], v[132:135]
v_mfma_f32_16x16x32_bf16 v[136:139], v[200:203], v[88:91], v[136:139]
v_mfma_f32_16x16x32_bf16 v[136:139], v[204:207], v[112:115], v[136:139]
v_mfma_f32_16x16x32_bf16 v[140:143], v[200:203], v[92:95], v[140:143]
v_mfma_f32_16x16x32_bf16 v[140:143], v[204:207], v[116:119], v[140:143]
v_mfma_f32_16x16x32_bf16 v[144:147], v[200:203], v[96:99], v[144:147]
v_mfma_f32_16x16x32_bf16 v[144:147], v[204:207], v[120:123], v[144:147]
buffer_load_dword v244, v240, s[24:27], s18 offen sc1
v_mfma_f32_16x16x32_bf16 v[148:151], v[200:203], v[100:103], v[148:151]
v_mfma_f32_16x16x32_bf16 v[148:151], v[204:207], v[124:127], v[148:151]
buffer_load_dwordx4 a[60:63], v184, s[24:27], s62 offen sc1
s_add_u32 s65, s62, 110592
buffer_load_dwordx4 a[64:67], v184, s[24:27], s65 offen sc1
s_add_u32 s65, s62, 221184
buffer_load_dwordx4 a[68:71], v184, s[24:27], s65 offen sc1
s_add_u32 s65, s62, 331776
buffer_load_dwordx4 a[72:75], v184, s[24:27], s65 offen sc1
buffer_load_dwordx4 a[76:79], v235, s[24:27], s62 offen sc1
s_add_u32 s65, s62, 110592
buffer_load_dwordx4 a[80:83], v235, s[24:27], s65 offen sc1
s_add_u32 s65, s62, 221184
buffer_load_dwordx4 a[84:87], v235, s[24:27], s65 offen sc1
s_add_u32 s65, s62, 331776
buffer_load_dwordx4 a[88:91], v235, s[24:27], s65 offen sc1
s_cmp_eq_u32 s57, 2146435072
s_cbranch_scc1 L_lateA
L_gotA:
s_waitcnt vmcnt(8)
v_cmp_lt_u32 vcc, v244, v233
s_nop 0
s_cmp_eq_u64 vcc, 0
s_cbranch_scc0 L_spinB
L_gotB:
buffer_load_dwordx4 v[0:3], v184, s[24:27], s13 offen offset:0 sc1
buffer_load_dwordx4 v[4:7], v184, s[24:27], s13 offen offset:1024 sc1
buffer_load_dwordx4 v[8:11], v184, s[24:27], s13 offen offset:2048 sc1
buffer_load_dwordx4 v[12:15], v184, s[24:27], s14 offen offset:0 sc1
buffer_load_dwordx4 v[16:19], v184, s[24:27], s14 offen offset:1024 sc1
buffer_load_dwordx4 v[20:23], v184, s[24:27], s14 offen offset:2048 sc1
v_accvgpr_read_b32 v32, a0
v_accvgpr_read_b32 v33, a1
v_accvgpr_read_b32 v34, a2
v_accvgpr_read_b32 v35, a3
v_accvgpr_read_b32 v36, a4
v_accvgpr_read_b32 v37, a5
v_accvgpr_read_b32 v38, a6
v_accvgpr_read_b32 v39, a7
v_accvgpr_read_b32 v40, a8
v_accvgpr_read_b32 v41, a9
v_accvgpr_read_b32 v42, a10
v_accvgpr_read_b32 v43, a11
v_dot2_f32_bf16 v128, v32, s63, v128
v_dot2_f32_bf16 v129, v32, s64, v129
v_dot2_f32_bf16 v130, v33, s63, v130
v_dot2_f32_bf16 v131, v33, s64, v131
v_dot2_f32_bf16 v132, v34, s63, v132
v_dot2_f32_bf16 v133, v34, s64, v133
v_dot2_f32_bf16 v134, v35, s63, v134
v_dot2_f32_bf16 v135, v35, s64, v135
v_dot2_f32_bf16 v136, v36, s63, v136
v_dot2_f32_bf16 v137, v36, s64, v137
v_dot2_f32_bf16 v138, v37, s63, v138
v_dot2_f32_bf16 v139, v37, s64, v139
v_dot2_f32_bf16 v140, v38, s63, v140
v_dot2_f32_bf16 v141, v38, s64, v141
v_dot2_f32_bf16 v142, v39, s63, v142
v_dot2_f32_bf16 v143, v39, s64, v143
v_dot2_f32_bf16 v144, v40, s63, v144
v_dot2_f32_bf16 v145, v40, s64, v145
v_dot2_f32_bf16 v146, v41, s63, v146
v_dot2_f32_bf16 v147, v41, s64, v147
v_dot2_f32_bf16 v148, v42, s63, v148
v_dot2_f32_bf16 v149, v42, s64, v149
v_dot2_f32_bf16 v150, v43, s63, v150
v_dot2_f32_bf16 v151, v43, s64, v151
v_accvgpr_read_b32 v44, a12
v_accvgpr_read_b32 v45, a13
v_accvgpr_read_b32 v46, a14
v_accvgpr_read_b32 v47, a15
v_accvgpr_read_b32 v48, a16
v_accvgpr_read_b32 v49, a17
v_accvgpr_read_b32 v50, a18
v_accvgpr_read_b32 v51, a19
v_accvgpr_read_b32 v52, a20
v_accvgpr_read_b32 v53, a21
v_accvgpr_read_b32 v54, a22
v_accvgpr_read_b32 v55, a23
v_dot2_f32_bf16 v128, v44, s63, v128
v_dot2_f32_bf16 v129, v44, s64, v129
v_dot2_f32_bf16 v130, v45, s63, v130
v_dot2_f32_bf16 v131, v45, s64, v131
v_dot2_f32_bf16 v132, v46, s63, v132
v_dot2_f32_bf16 v133, v46, s64, v133
v_dot2_f32_bf16 v134, v47, s63, v134
v_dot2_f32_bf16 v135, v47, s64, v135
v_dot2_f32_bf16 v136, v48, s63, v136
v_dot2_f32_bf16 v137, v48, s64, v137
v_dot2_f32_bf16 v138, v49, s63, v138
v_dot2_f32_bf16 v139, v49, s64, v139
v_dot2_f32_bf16 v140, v50, s63, v140
v_dot2_f32_bf16 v141, v50, s64, v141
v_dot2_f32_bf16 v142, v51, s63, v142
v_dot2_f32_bf16 v143, v51, s64, v143
v_dot2_f32_bf16 v144, v52, s63, v144
v_dot2_f32_bf16 v145, v52, s64, v145
v_dot2_f32_bf16 v146, v53, s63, v146
v_dot2_f32_bf16 v147, v53, s64, v147
v_dot2_f32_bf16 v148, v54, s63, v148
v_dot2_f32_bf16 v149, v54, s64, v149
v_dot2_f32_bf16 v150, v55, s63, v150
v_dot2_f32_bf16 v151, v55, s64, v151
v_accvgpr_read_b32 v32, a24
v_accvgpr_read_b32 v33, a25
v_accvgpr_read_b32 v34, a26
v_accvgpr_read_b32 v35, a27
v_accvgpr_read_b32 v36, a28
v_accvgpr_read_b32 v37, a29
v_accvgpr_read_b32 v38, a30
v_accvgpr_read_b32 v39, a31
v_accvgpr_read_b32 v40, a32
v_accvgpr_read_b32 v41, a33
v_accvgpr_read_b32 v42, a34
v_accvgpr_read_b32 v43, a35
v_dot2_f32_bf16 v128, v32, s63, v128
v_dot2_f32_bf16 v129, v32, s64, v129
v_dot2_f32_bf16 v130, v33, s63, v130
v_dot2_f32_bf16 v131, v33, s64, v131
v_dot2_f32_bf16 v132, v34, s63, v132
v_dot2_f32_bf16 v133, v34, s64, v133
v_dot2_f32_bf16 v134, v35, s63, v134
v_dot2_f32_bf16 v135, v35, s64, v135
v_dot2_f32_bf16 v136, v36, s63, v136
v_dot2_f32_bf16 v137, v36, s64, v137
v_dot2_f32_bf16 v138, v37, s63, v138
v_dot2_f32_bf16 v139, v37, s64, v139
v_dot2_f32_bf16 v140, v38, s63, v140
v_dot2_f32_bf16 v141, v38, s64, v141
v_dot2_f32_bf16 v142, v39, s63, v142
v_dot2_f32_bf16 v143, v39, s64, v143
v_dot2_f32_bf16 v144, v40, s63, v144
v_dot2_f32_bf16 v145, v40, s64, v145
v_dot2_f32_bf16 v146, v41, s63, v146
v_dot2_f32_bf16 v147, v41, s64, v147
v_dot2_f32_bf16 v148, v42, s63, v148
v_dot2_f32_bf16 v149, v42, s64, v149
v_dot2_f32_bf16 v150, v43, s63, v150
v_dot2_f32_bf16 v151, v43, s64, v151
v_accvgpr_read_b32 v44, a36
v_accvgpr_read_b32 v45, a37
v_accvgpr_read_b32 v46, a38
v_accvgpr_read_b32 v47, a39
v_accvgpr_read_b32 v48, a40
v_accvgpr_read_b32 v49, a41
v_accvgpr_read_b32 v50, a42
v_accvgpr_read_b32 v51, a43
v_accvgpr_read_b32 v52, a44
v_accvgpr_read_b32 v53, a45
v_accvgpr_read_b32 v54, a46
v_accvgpr_read_b32 v55, a47
v_dot2_f32_bf16 v128, v44, s63, v128
v_dot2_f32_bf16 v129, v44, s64, v129
v_dot2_f32_bf16 v130, v45, s63, v130
v_dot2_f32_bf16 v131, v45, s64, v131
v_dot2_f32_bf16 v132, v46, s63, v132
v_dot2_f32_bf16 v133, v46, s64, v133
v_dot2_f32_bf16 v134, v47, s63, v134
v_dot2_f32_bf16 v135, v47, s64, v135
v_dot2_f32_bf16 v136, v48, s63, v136
v_dot2_f32_bf16 v137, v48, s64, v137
v_dot2_f32_bf16 v138, v49, s63, v138
v_dot2_f32_bf16 v139, v49, s64, v139
v_dot2_f32_bf16 v140, v50, s63, v140
v_dot2_f32_bf16 v141, v50, s64, v141
v_dot2_f32_bf16 v142, v51, s63, v142
v_dot2_f32_bf16 v143, v51, s64, v143
v_dot2_f32_bf16 v144, v52, s63, v144
v_dot2_f32_bf16 v145, v52, s64, v145
v_dot2_f32_bf16 v146, v53, s63, v146
v_dot2_f32_bf16 v147, v53, s64, v147
v_dot2_f32_bf16 v148, v54, s63, v148
v_dot2_f32_bf16 v149, v54, s64, v149
v_dot2_f32_bf16 v150, v55, s63, v150
v_dot2_f32_bf16 v151, v55, s64, v151
v_accvgpr_read_b32 v32, a48
v_accvgpr_read_b32 v33, a49
v_accvgpr_read_b32 v34, a50
v_accvgpr_read_b32 v35, a51
v_accvgpr_read_b32 v36, a52
v_accvgpr_read_b32 v37, a53
v_accvgpr_read_b32 v38, a54
v_accvgpr_read_b32 v39, a55
v_accvgpr_read_b32 v40, a56
v_accvgpr_read_b32 v41, a57
v_accvgpr_read_b32 v42, a58
v_accvgpr_read_b32 v43, a59
v_dot2_f32_bf16 v128, v32, s63, v128
v_dot2_f32_bf16 v129, v32, s64, v129
v_dot2_f32_bf16 v130, v33, s63, v130
v_dot2_f32_bf16 v131, v33, s64, v131
v_dot2_f32_bf16 v132, v34, s63, v132
v_dot2_f32_bf16 v133, v34, s64, v133
v_dot2_f32_bf16 v134, v35, s63, v134
v_dot2_f32_bf16 v135, v35, s64, v135
v_dot2_f32_bf16 v136, v36, s63, v136
v_dot2_f32_bf16 v137, v36, s64, v137
v_dot2_f32_bf16 v138, v37, s63, v138
v_dot2_f32_bf16 v139, v37, s64, v139
v_dot2_f32_bf16 v140, v38, s63, v140
v_dot2_f32_bf16 v141, v38, s64, v141
v_dot2_f32_bf16 v142, v39, s63, v142
v_dot2_f32_bf16 v143, v39, s64, v143
v_dot2_f32_bf16 v144, v40, s63, v144
v_dot2_f32_bf16 v145, v40, s64, v145
v_dot2_f32_bf16 v146, v41, s63, v146
v_dot2_f32_bf16 v147, v41, s64, v147
v_dot2_f32_bf16 v148, v42, s63, v148
v_dot2_f32_bf16 v149, v42, s64, v149
v_dot2_f32_bf16 v150, v43, s63, v150
v_dot2_f32_bf16 v151, v43, s64, v151
s_waitcnt vmcnt(13)
v_accvgpr_read_b32 v64, a60
v_accvgpr_read_b32 v65, a61
v_accvgpr_read_b32 v66, a62
v_accvgpr_read_b32 v67, a63
v_dot2_f32_bf16 v80, v64, s63, 0
v_dot2_f32_bf16 v81, v64, s64, 0
v_dot2_f32_bf16 v82, v65, s63, 0
v_dot2_f32_bf16 v83, v65, s64, 0
v_dot2_f32_bf16 v84, v66, s63, 0
v_dot2_f32_bf16 v85, v66, s64, 0
v_dot2_f32_bf16 v86, v67, s63, 0
v_dot2_f32_bf16 v87, v67, s64, 0
s_waitcnt vmcnt(12)
v_accvgpr_read_b32 v68, a64
v_accvgpr_read_b32 v69, a65
v_accvgpr_read_b32 v70, a66
v_accvgpr_read_b32 v71, a67
v_dot2_f32_bf16 v80, v68, s63, v80
v_dot2_f32_bf16 v81, v68, s64, v81
v_dot2_f32_bf16 v82, v69, s63, v82
v_dot2_f32_bf16 v83, v69, s64, v83
v_dot2_f32_bf16 v84, v70, s63, v84
v_dot2_f32_bf16 v85, v70, s64, v85
v_dot2_f32_bf16 v86, v71, s63, v86
v_dot2_f32_bf16 v87, v71, s64, v87
s_waitcnt vmcnt(11)
v_accvgpr_read_b32 v64, a68
v_accvgpr_read_b32 v65, a69
v_accvgpr_read_b32 v66, a70
v_accvgpr_read_b32 v67, a71
v_dot2_f32_bf16 v80, v64, s63, v80
v_dot2_f32_bf16 v81, v64, s64, v81
v_dot2_f32_bf16 v82, v65, s63, v82
v_dot2_f32_bf16 v83, v65, s64, v83
v_dot2_f32_bf16 v84, v66, s63, v84
v_dot2_f32_bf16 v85, v66, s64, v85
v_dot2_f32_bf16 v86, v67, s63, v86
v_dot2_f32_bf16 v87, v67, s64, v87
s_waitcnt vmcnt(10)
v_accvgpr_read_b32 v68, a72
v_accvgpr_read_b32 v69, a73
v_accvgpr_read_b32 v70, a74
v_accvgpr_read_b32 v71, a75
v_dot2_f32_bf16 v80, v68, s63, v80
v_dot2_f32_bf16 v81, v68, s64, v81
v_dot2_f32_bf16 v82, v69, s63, v82
v_dot2_f32_bf16 v83, v69, s64, v83
v_dot2_f32_bf16 v84, v70, s63, v84
v_dot2_f32_bf16 v85, v70, s64, v85
v_dot2_f32_bf16 v86, v71, s63, v86
v_dot2_f32_bf16 v87, v71, s64, v87
s_waitcnt vmcnt(9)
v_accvgpr_read_b32 v64, a76
v_accvgpr_read_b32 v65, a77
v_accvgpr_read_b32 v66, a78
v_accvgpr_read_b32 v67, a79
v_dot2_f32_bf16 v80, v64, s63, v80
v_dot2_f32_bf16 v81, v64, s64, v81
v_dot2_f32_bf16 v82, v65, s63, v82
v_dot2_f32_bf16 v83, v65, s64, v83
v_dot2_f32_bf16 v84, v66, s63, v84
v_dot2_f32_bf16 v85, v66, s64, v85
v_dot2_f32_bf16 v86, v67, s63, v86
v_dot2_f32_bf16 v87, v67, s64, v87
s_waitcnt vmcnt(8)
v_accvgpr_read_b32 v68, a80
v_accvgpr_read_b32 v69, a81
v_accvgpr_read_b32 v70, a82
v_accvgpr_read_b32 v71, a83
v_dot2_f32_bf16 v80, v68, s63, v80
v_dot2_f32_bf16 v81, v68, s64, v81
v_dot2_f32_bf16 v82, v69, s63, v82
v_dot2_f32_bf16 v83, v69, s64, v83
v_dot2_f32_bf16 v84, v70, s63, v84
v_dot2_f32_bf16 v85, v70, s64, v85
v_dot2_f32_bf16 v86, v71, s63, v86
v_dot2_f32_bf16 v87, v71, s64, v87
s_waitcnt vmcnt(7)
v_accvgpr_read_b32 v64, a84
v_accvgpr_read_b32 v65, a85
v_accvgpr_read_b32 v66, a86
v_accvgpr_read_b32 v67, a87
v_dot2_f32_bf16 v80, v64, s63, v80
v_dot2_f32_bf16 v81, v64, s64, v81
v_dot2_f32_bf16 v82, v65, s63, v82
v_dot2_f32_bf16 v83, v65, s64, v83
v_dot2_f32_bf16 v84, v66, s63, v84
v_dot2_f32_bf16 v85, v66, s64, v85
v_dot2_f32_bf16 v86, v67, s63, v86
v_dot2_f32_bf16 v87, v67, s64, v87
s_waitcnt vmcnt(6)
v_accvgpr_read_b32 v68, a88
v_accvgpr_read_b32 v69, a89
v_accvgpr_read_b32 v70, a90
v_accvgpr_read_b32 v71, a91
v_dot2_f32_bf16 v80, v68, s63, v80
v_dot2_f32_bf16 v81, v68, s64, v81
v_dot2_f32_bf16 v82, v69, s63, v82
v_dot2_f32_bf16 v83, v69, s64, v83
v_dot2_f32_bf16 v84, v70, s63, v84
v_dot2_f32_bf16 v85, v70, s64, v85
v_dot2_f32_bf16 v86, v71, s63, v86
v_dot2_f32_bf16 v87, v71, s64, v87
v_cvt_pk_bf16_f32 v88, v80, v81
v_cvt_pk_bf16_f32 v89, v82, v83
v_cvt_pk_bf16_f32 v90, v84, v85
v_cvt_pk_bf16_f32 v91, v86, v87
s_nop 0
v_permlane16_swap_b32 v88, v90
v_permlane16_swap_b32 v89, v91
buffer_store_dwordx4 v[88:91], v242, s[4:7], s17 offen
s_waitcnt vmcnt(6)
v_dot2_f32_bf16 v128, v0, s63, v128
v_dot2_f32_bf16 v129, v0, s64, v129
v_dot2_f32_bf16 v130, v1, s63, v130
v_dot2_f32_bf16 v131, v1, s64, v131
v_dot2_f32_bf16 v132, v2, s63, v132
v_dot2_f32_bf16 v133, v2, s64, v133
v_dot2_f32_bf16 v134, v3, s63, v134
v_dot2_f32_bf16 v135, v3, s64, v135
s_waitcnt vmcnt(3)
v_dot2_f32_bf16 v128, v12, s63, v128
v_dot2_f32_bf16 v129, v12, s64, v129
v_dot2_f32_bf16 v130, v13, s63, v130
v_dot2_f32_bf16 v131, v13, s64, v131
v_dot2_f32_bf16 v132, v14, s63, v132
v_dot2_f32_bf16 v133, v14, s64, v133
v_dot2_f32_bf16 v134, v15, s63, v134
v_dot2_f32_bf16 v135, v15, s64, v135
v_cvt_pk_bf16_f32 v92, v128, v129
v_cvt_pk_bf16_f32 v93, v130, v131
v_cvt_pk_bf16_f32 v94, v132, v133
v_cvt_pk_bf16_f32 v95, v134, v135
s_nop 0
v_permlane16_swap_b32 v92, v94
v_permlane16_swap_b32 v93, v95
buffer_store_dwordx4 v[92:95], v242, s[4:7], s16 offen
s_add_u32 s16, s16, 73728
v_dot2_f32_bf16 v136, v4, s63, v136
v_dot2_f32_bf16 v137, v4, s64, v137
v_dot2_f32_bf16 v138, v5, s63, v138
v_dot2_f32_bf16 v139, v5, s64, v139
v_dot2_f32_bf16 v140, v6, s63, v140
v_dot2_f32_bf16 v141, v6, s64, v141
v_dot2_f32_bf16 v142, v7, s63, v142
v_dot2_f32_bf16 v143, v7, s64, v143
s_waitcnt vmcnt(3)
v_dot2_f32_bf16 v136, v16, s63, v136
v_dot2_f32_bf16 v137, v16, s64, v137
v_dot2_f32_bf16 v138, v17, s63, v138
v_dot2_f32_bf16 v139, v17, s64, v139
v_dot2_f32_bf16 v140, v18, s63, v140
v_dot2_f32_bf16 v141, v18, s64, v141
v_dot2_f32_bf16 v142, v19, s63, v142
v_dot2_f32_bf16 v143, v19, s64, v143
v_cvt_pk_bf16_f32 v96, v136, v137
v_cvt_pk_bf16_f32 v97, v138, v139
v_cvt_pk_bf16_f32 v98, v140, v141
v_cvt_pk_bf16_f32 v99, v142, v143
s_nop 0
v_permlane16_swap_b32 v96, v98
v_permlane16_swap_b32 v97, v99
buffer_store_dwordx4 v[96:99], v242, s[4:7], s16 offen
s_add_u32 s16, s16, 73728
v_dot2_f32_bf16 v144, v8, s63, v144
v_dot2_f32_bf16 v145, v8, s64, v145
v_dot2_f32_bf16 v146, v9, s63, v146
v_dot2_f32_bf16 v147, v9, s64, v147
v_dot2_f32_bf16 v148, v10, s63, v148
v_dot2_f32_bf16 v149, v10, s64, v149
v_dot2_f32_bf16 v150, v11, s63, v150
v_dot2_f32_bf16 v151, v11, s64, v151
s_waitcnt vmcnt(3)
v_dot2_f32_bf16 v144, v20, s63, v144
v_dot2_f32_bf16 v145, v20, s64, v145
v_dot2_f32_bf16 v146, v21, s63, v146
v_dot2_f32_bf16 v147, v21, s64, v147
v_dot2_f32_bf16 v148, v22, s63, v148
v_dot2_f32_bf16 v149, v22, s64, v149
v_dot2_f32_bf16 v150, v23, s63, v150
v_dot2_f32_bf16 v151, v23, s64, v151
v_cvt_pk_bf16_f32 v100, v144, v145
v_cvt_pk_bf16_f32 v101, v146, v147
v_cvt_pk_bf16_f32 v102, v148, v149
v_cvt_pk_bf16_f32 v103, v150, v151
s_nop 0
v_permlane16_swap_b32 v100, v102
v_permlane16_swap_b32 v101, v103
buffer_store_dwordx4 v[100:103], v242, s[4:7], s16 offen
L_end:
s_endpgm
L_flag:
v_mov_b32 v168, 1
s_mov_b64 exec, 1
buffer_store_dword v168, off, s[24:27], s47 sc1
s_waitcnt vmcnt(0)
s_mov_b64 exec, -1
s_branch L_flagged
L_redo:
s_waitcnt vmcnt(0) lgkmcnt(0)
s_barrier
s_mov_b32 s77, 3
s_nop 15
s_branch L_restart
L_count:
v_mov_b32 v168, 1
s_mov_b64 exec, 1
buffer_atomic_add v168, off, s[96:99], s44 offset:32 sc1
s_mov_b64 exec, -1
s_branch L_counted
L_cntwait:
s_mov_b32 s94, 0x40000
L_cntwait_l:
buffer_load_dword v188, off, s[96:99], s44 offset:32 sc1
s_waitcnt vmcnt(0)
v_readfirstlane_b32 s34, v188
s_nop 0
s_cmp_ge_u32 s34, 8
s_cbranch_scc1 L_cntok
s_sub_u32 s94, s94, 1
s_cmp_lg_u32 s94, 0
s_cbranch_scc1 L_cntwait_l
s_branch L_cntok
L_spinB:
s_mov_b32 s94, 0x40000
L_spinB_l:
buffer_load_dword v244, v240, s[24:27], s18 offen sc1
s_waitcnt vmcnt(0)
v_cmp_lt_u32 vcc, v244, v233
s_nop 0
s_cmp_eq_u64 vcc, 0
s_cbranch_scc1 L_gotB
s_sub_u32 s94, s94, 1
s_cmp_lg_u32 s94, 0
s_cbranch_scc1 L_spinB_l
s_branch L_gotB
L_lateA:
s_mov_b32 s94, 0x40000
L_lateA_l:
buffer_load_dword v244, v240, s[24:27], s18 offen sc1
s_waitcnt vmcnt(0)
v_cmp_lt_u32 vcc, v244, v232
s_nop 0
s_cmp_eq_u64 vcc, 0
s_cbranch_scc1 L_lateA2
s_sub_u32 s94, s94, 1
s_cmp_lg_u32 s94, 0
s_cbranch_scc1 L_lateA_l
s_branch L_lateA2
L_lateA2:
buffer_load_dwordx4 a[0:3], v184, s[24:27], s8 offen offset:0 sc1
buffer_load_dwordx4 a[4:7], v184, s[24:27], s8 offen offset:1024 sc1
buffer_load_dwordx4 a[8:11], v184, s[24:27], s8 offen offset:2048 sc1
buffer_load_dwordx4 a[12:15], v184, s[24:27], s9 offen offset:0 sc1
buffer_load_dwordx4 a[16:19], v184, s[24:27], s9 offen offset:1024 sc1
buffer_load_dwordx4 a[20:23], v184, s[24:27], s9 offen offset:2048 sc1
buffer_load_dwordx4 a[24:27], v184, s[24:27], s10 offen offset:0 sc1
buffer_load_dwordx4 a[28:31], v184, s[24:27], s10 offen offset:1024 sc1
buffer_load_dwordx4 a[32:35], v184, s[24:27], s10 offen offset:2048 sc1
buffer_load_dwordx4 a[36:39], v184, s[24:27], s11 offen offset:0 sc1
buffer_load_dwordx4 a[40:43], v184, s[24:27], s11 offen offset:1024 sc1
buffer_load_dwordx4 a[44:47], v184, s[24:27], s11 offen offset:2048 sc1
buffer_load_dwordx4 a[48:51], v184, s[24:27], s12 offen offset:0 sc1
buffer_load_dwordx4 a[52:55], v184, s[24:27], s12 offen offset:1024 sc1
buffer_load_dwordx4 a[56:59], v184, s[24:27], s12 offen offset:2048 sc1
buffer_load_dwordx4 a[60:63], v184, s[24:27], s15 offen sc1
s_add_u32 s65, s15, 110592
buffer_load_dwordx4 a[64:67], v184, s[24:27], s65 offen sc1
s_add_u32 s65, s15, 221184
buffer_load_dwordx4 a[68:71], v184, s[24:27], s65 offen sc1
s_add_u32 s65, s15, 331776
buffer_load_dwordx4 a[72:75], v184, s[24:27], s65 offen sc1
buffer_load_dwordx4 a[76:79], v235, s[24:27], s15 offen sc1
s_add_u32 s65, s15, 110592
buffer_load_dwordx4 a[80:83], v235, s[24:27], s65 offen sc1
s_add_u32 s65, s15, 221184
buffer_load_dwordx4 a[84:87], v235, s[24:27], s65 offen sc1
s_add_u32 s65, s15, 331776
buffer_load_dwordx4 a[88:91], v235, s[24:27], s65 offen sc1
s_waitcnt vmcnt(0)
s_branch L_gotA
L_maxpass:
s_waitcnt vmcnt(0) lgkmcnt(0)
v_lshlrev_b32 v174, 8, v253
v_add_u32 v170, 0, v253
v_xor_b32 v170, v170, v254
v_lshl_add_u32 v170, v170, 4, v174
v_add_u32 v171, 4, v253
v_xor_b32 v171, v171, v254
v_lshl_add_u32 v171, v171, 4, v174
v_add_u32 v172, 8, v253
v_xor_b32 v172, v172, v254
v_lshl_add_u32 v172, v172, 4, v174
v_add_u32 v173, 12, v253
v_xor_b32 v173, v173, v254
v_lshl_add_u32 v173, v173, 4, v174
v_mov_b32 v144, 0xff800000
v_mov_b32 v148, 0xff800000
v_mov_b32 v152, 0xff800000
v_mov_b32 v156, 0xff800000
v_mov_b32 v160, 0xff800000
v_mov_b32 v164, 0xff800000
s_mov_b32 s94, 0
L_mloop:
s_add_u32 m0, s46, 24576
s_add_u32 s34, s45, s94
buffer_load_dwordx4 v170, s[16:19], s34 offen offset:0 lds
buffer_load_dwordx4 v171, s[16:19], s34 offen offset:1024 lds
buffer_load_dwordx4 v172, s[16:19], s34 offen offset:2048 lds
buffer_load_dwordx4 v173, s[16:19], s34 offen offset:3072 lds
s_waitcnt vmcnt(0)
s_barrier
ds_read_b128 v[192:195], v228 offset:57344
ds_read_b128 v[196:199], v228 offset:61440
ds_read_b128 v[200:203], v229 offset:57344
ds_read_b128 v[204:207], v229 offset:61440
ds_read_b128 v[208:211], v230 offset:57344
ds_read_b128 v[212:215], v230 offset:61440
ds_read_b128 v[216:219], v231 offset:57344
ds_read_b128 v[220:223], v231 offset:61440
s_waitcnt lgkmcnt(0)
s_barrier
v_mfma_f32_16x16x32_bf16 v[96:99], v[192:195], v[0:3], 0
v_mfma_f32_16x16x32_bf16 v[96:99], v[200:203], v[24:27], v[96:99]
v_mfma_f32_16x16x32_bf16 v[96:99], v[208:211], v[48:51], v[96:99]
v_mfma_f32_16x16x32_bf16 v[96:99], v[216:219], v[72:75], v[96:99]
v_mfma_f32_16x16x32_bf16 v[104:107], v[192:195], v[4:7], 0
v_mfma_f32_16x16x32_bf16 v[104:107], v[200:203], v[28:31], v[104:107]
v_mfma_f32_16x16x32_bf16 v[104:107], v[208:211], v[52:55], v[104:107]
v_mfma_f32_16x16x32_bf16 v[104:107], v[216:219], v[76:79], v[104:107]
v_mfma_f32_16x16x32_bf16 v[100:103], v[196:199], v[0:3], 0
v_mfma_f32_16x16x32_bf16 v[100:103], v[204:207], v[24:27], v[100:103]
v_mfma_f32_16x16x32_bf16 v[100:103], v[212:215], v[48:51], v[100:103]
v_mfma_f32_16x16x32_bf16 v[100:103], v[220:223], v[72:75], v[100:103]
v_mfma_f32_16x16x32_bf16 v[108:111], v[196:199], v[4:7], 0
v_mfma_f32_16x16x32_bf16 v[108:111], v[204:207], v[28:31], v[108:111]
v_mfma_f32_16x16x32_bf16 v[108:111], v[212:215], v[52:55], v[108:111]
v_mfma_f32_16x16x32_bf16 v[108:111], v[220:223], v[76:79], v[108:111]
v_max3_f32 v144, v144, v96, v97
v_max3_f32 v144, v144, v98, v99
s_nop 1
v_max3_f32 v144, v144, v100, v101
v_max3_f32 v144, v144, v102, v103
v_max3_f32 v148, v148, v104, v105
v_max3_f32 v148, v148, v106, v107
v_max3_f32 v148, v148, v108, v109
v_max3_f32 v148, v148, v110, v111
v_mfma_f32_16x16x32_bf16 v[96:99], v[192:195], v[8:11], 0
v_mfma_f32_16x16x32_bf16 v[96:99], v[200:203], v[32:35], v[96:99]
v_mfma_f32_16x16x32_bf16 v[96:99], v[208:211], v[56:59], v[96:99]
v_mfma_f32_16x16x32_bf16 v[96:99], v[216:219], v[80:83], v[96:99]
v_mfma_f32_16x16x32_bf16 v[104:107], v[192:195], v[12:15], 0
v_mfma_f32_16x16x32_bf16 v[104:107], v[200:203], v[36:39], v[104:107]
v_mfma_f32_16x16x32_bf16 v[104:107], v[208:211], v[60:63], v[104:107]
v_mfma_f32_16x16x32_bf16 v[104:107], v[216:219], v[84:87], v[104:107]
v_mfma_f32_16x16x32_bf16 v[100:103], v[196:199], v[8:11], 0
v_mfma_f32_16x16x32_bf16 v[100:103], v[204:207], v[32:35], v[100:103]
v_mfma_f32_16x16x32_bf16 v[100:103], v[212:215], v[56:59], v[100:103]
v_mfma_f32_16x16x32_bf16 v[100:103], v[220:223], v[80:83], v[100:103]
v_mfma_f32_16x16x32_bf16 v[108:111], v[196:199], v[12:15], 0
v_mfma_f32_16x16x32_bf16 v[108:111], v[204:207], v[36:39], v[108:111]
v_mfma_f32_16x16x32_bf16 v[108:111], v[212:215], v[60:63], v[108:111]
v_mfma_f32_16x16x32_bf16 v[108:111], v[220:223], v[84:87], v[108:111]
v_max3_f32 v152, v152, v96, v97
v_max3_f32 v152, v152, v98, v99
s_nop 1
v_max3_f32 v152, v152, v100, v101
v_max3_f32 v152, v152, v102, v103
v_max3_f32 v156, v156, v104, v105
v_max3_f32 v156, v156, v106, v107
v_max3_f32 v156, v156, v108, v109
v_max3_f32 v156, v156, v110, v111
v_mfma_f32_16x16x32_bf16 v[96:99], v[192:195], v[16:19], 0
v_mfma_f32_16x16x32_bf16 v[96:99], v[200:203], v[40:43], v[96:99]
v_mfma_f32_16x16x32_bf16 v[96:99], v[208:211], v[64:67], v[96:99]
v_mfma_f32_16x16x32_bf16 v[96:99], v[216:219], v[88:91], v[96:99]
v_mfma_f32_16x16x32_bf16 v[104:107], v[192:195], v[20:23], 0
v_mfma_f32_16x16x32_bf16 v[104:107], v[200:203], v[44:47], v[104:107]
v_mfma_f32_16x16x32_bf16 v[104:107], v[208:211], v[68:71], v[104:107]
v_mfma_f32_16x16x32_bf16 v[104:107], v[216:219], v[92:95], v[104:107]
v_mfma_f32_16x16x32_bf16 v[100:103], v[196:199], v[16:19], 0
v_mfma_f32_16x16x32_bf16 v[100:103], v[204:207], v[40:43], v[100:103]
v_mfma_f32_16x16x32_bf16 v[100:103], v[212:215], v[64:67], v[100:103]
v_mfma_f32_16x16x32_bf16 v[100:103], v[220:223], v[88:91], v[100:103]
v_mfma_f32_16x16x32_bf16 v[108:111], v[196:199], v[20:23], 0
v_mfma_f32_16x16x32_bf16 v[108:111], v[204:207], v[44:47], v[108:111]
v_mfma_f32_16x16x32_bf16 v[108:111], v[212:215], v[68:71], v[108:111]
v_mfma_f32_16x16x32_bf16 v[108:111], v[220:223], v[92:95], v[108:111]
v_max3_f32 v160, v160, v96, v97
v_max3_f32 v160, v160, v98, v99
s_nop 1
v_max3_f32 v160, v160, v100, v101
v_max3_f32 v160, v160, v102, v103
v_max3_f32 v164, v164, v104, v105
v_max3_f32 v164, v164, v106, v107
v_max3_f32 v164, v164, v108, v109
v_max3_f32 v164, v164, v110, v111
s_add_u32 s94, s94, 8192
s_cmp_lt_u32 s94, 262144
s_cbranch_scc1 L_mloop
v_mov_b32 v168, v144
v_mov_b32 v169, v168
s_nop 1
v_permlane16_swap_b32 v168, v169
v_max_f32 v168, v168, v169
v_mov_b32 v169, v168
s_nop 1
v_permlane32_swap_b32 v168, v169
v_max_f32 v168, v168, v169
v_sub_f32 v144, 0, v168
v_sub_f32 v145, 0, v168
v_sub_f32 v146, 0, v168
v_sub_f32 v147, 0, v168
v_mov_b32 v168, v148
v_mov_b32 v169, v168
s_nop 1
v_permlane16_swap_b32 v168, v169
v_max_f32 v168, v168, v169
v_mov_b32 v169, v168
s_nop 1
v_permlane32_swap_b32 v168, v169
v_max_f32 v168, v168, v169
v_sub_f32 v148, 0, v168
v_sub_f32 v149, 0, v168
v_sub_f32 v150, 0, v168
v_sub_f32 v151, 0, v168
v_mov_b32 v168, v152
v_mov_b32 v169, v168
s_nop 1
v_permlane16_swap_b32 v168, v169
v_max_f32 v168, v168, v169
v_mov_b32 v169, v168
s_nop 1
v_permlane32_swap_b32 v168, v169
v_max_f32 v168, v168, v169
v_sub_f32 v152, 0, v168
v_sub_f32 v153, 0, v168
v_sub_f32 v154, 0, v168
v_sub_f32 v155, 0, v168
v_mov_b32 v168, v156
v_mov_b32 v169, v168
s_nop 1
v_permlane16_swap_b32 v168, v169
v_max_f32 v168, v168, v169
v_mov_b32 v169, v168
s_nop 1
v_permlane32_swap_b32 v168, v169
v_max_f32 v168, v168, v169
v_sub_f32 v156, 0, v168
v_sub_f32 v157, 0, v168
v_sub_f32 v158, 0, v168
v_sub_f32 v159, 0, v168
v_mov_b32 v168, v160
v_mov_b32 v169, v168
s_nop 1
v_permlane16_swap_b32 v168, v169
v_max_f32 v168, v168, v169
v_mov_b32 v169, v168
s_nop 1
v_permlane32_swap_b32 v168, v169
v_max_f32 v168, v168, v169
v_sub_f32 v160, 0, v168
v_sub_f32 v161, 0, v168
v_sub_f32 v162, 0, v168
v_sub_f32 v163, 0, v168
v_mov_b32 v168, v164
v_mov_b32 v169, v168
s_nop 1
v_permlane16_swap_b32 v168, v169
v_max_f32 v168, v168, v169
v_mov_b32 v169, v168
s_nop 1
v_permlane32_swap_b32 v168, v169
v_max_f32 v168, v168, v169
v_sub_f32 v164, 0, v168
v_sub_f32 v165, 0, v168
v_sub_f32 v166, 0, v168
v_sub_f32 v167, 0, v168
ds_read_b128 v[192:195], v224 offset:57344
ds_read_b128 v[196:199], v228 offset:0
ds_read_b128 v[200:203], v225 offset:57344
ds_read_b128 v[204:207], v229 offset:0
ds_read_b128 v[208:211], v226 offset:57344
ds_read_b128 v[212:215], v230 offset:0
ds_read_b128 v[216:219], v227 offset:57344
ds_read_b128 v[220:223], v231 offset:0
s_waitcnt lgkmcnt(0)
s_branch L_maxdone
L_codeend:
.section .rodata,"a"
.p2align 6
.amdhsa_kernel concat_heads__gqa_block_cached__gqa_block_cached__near_ridge_kernel
  .amdhsa_next_free_vgpr 512
  .amdhsa_next_free_sgpr 102
  .amdhsa_accum_offset 256
  .amdhsa_group_segment_fixed_size 0
  .amdhsa_kernarg_size 104
  .amdhsa_user_sgpr_count 2
  .amdhsa_user_sgpr_kernarg_segment_ptr 1
  .amdhsa_system_sgpr_workgroup_id_x 1
  .amdhsa_float_denorm_mode_32 3
.end_amdhsa_kernel
```
